```python
import torch

def _softmax(x, axis=-1):
    return torch.softmax(x, dim=axis)
def _gelu(x):
    return torch.nn.functional.gelu(x, approximate="tanh")
def _silu(x):
    return torch.nn.functional.silu(x)
def _sigmoid(x):
    return torch.sigmoid(x)
def _layernorm(x, axis=-1, eps=1e-5):
    m = x.mean(dim=axis, keepdim=True)
    v = x.var(dim=axis, keepdim=True, unbiased=False)
    return (x - m) / torch.sqrt(v + eps)
def _scatter_add(tgt, idx, src, axis=0):
    return tgt.clone().index_add_(axis, idx, src)
def _segment_sum(src, seg, n):
    out = torch.zeros((n,) + src.shape[1:], dtype=src.dtype)
    return out.index_add_(0, seg, src)
def _pad(x, pw):
    flat = tuple(v for pair in reversed(pw) for v in pair)
    return torch.nn.functional.pad(x, flat)

kernel_name = 'recurrent_scan__gqa_block_cached__glu_gated_glu__prompt'

def setup_inputs():

    _w = (lambda a: (lambda t: t.to(torch.bfloat16) if t.is_floating_point() else t)(torch.as_tensor(a)))
    def _A_setup():
        B, Sq, D = 1, 2048, 512
        Hq, Hkv, Sk, Dh = 32, 32, 2048, 128
        assert Hq % Hkv == 0, (Hq, Hkv)
        return {
            "x": _w((lambda *s: torch.randn(*s, dtype=torch.bfloat16) * 0.05)(B, Sq, D)),
            "k_cache": _w((lambda *s: torch.randn(*s, dtype=torch.bfloat16) * 1.6)(B, Hkv, Sk, Dh)),
            "v_cache": _w((lambda *s: torch.randn(*s, dtype=torch.bfloat16) * 0.2)(B, Hkv, Sk, Dh)),
            "wq": _w((lambda *s: torch.randn(*s, dtype=torch.bfloat16) * 1.6)(D, Hq * Dh) * (D ** -0.5)),
            "wo": _w((lambda *s: torch.randn(*s, dtype=torch.bfloat16) * 0.2)(Hq * Dh, D) * ((Hq * Dh) ** -0.5)),
        }
    _A_in = _A_setup()

    def _B_setup():
        B, S, D, F = 1, 2048, 512, 1376
        return {
            "x": _w((lambda *s: torch.randn(*s, dtype=torch.bfloat16) * 0.05)(B, S, D)),
            "w_gate": _w((lambda *s: torch.randn(*s, dtype=torch.bfloat16) * 0.2)(D, F)),
            "w_up": _w((lambda *s: torch.randn(*s, dtype=torch.bfloat16) * 0.1)(D, F)),
            "w_down": _w((lambda *s: torch.randn(*s, dtype=torch.bfloat16) * 0.1)(F, D)),
        }
    _B_in = _B_setup()

    return {
        "A_x": _A_in["x"],
        "A_k_cache": _A_in["k_cache"],
        "A_v_cache": _A_in["v_cache"],
        "A_wq": _A_in["wq"],
        "A_wo": _A_in["wo"],
        "B_x": _B_in["x"],
        "B_w_gate": _B_in["w_gate"],
        "B_w_up": _B_in["w_up"],
        "B_w_down": _B_in["w_down"],
    }

def reference(A_x, A_k_cache, A_v_cache, A_wq, A_wo, B_x, B_w_gate, B_w_up, B_w_down):
    def _A_ref(x, k_cache, v_cache, wq, wo):
        B, Sq, D = x.shape
        Hq, Dh = 32, 128
        Hkv = k_cache.shape[1]
        rep = Hq // Hkv
        q = (lambda x, *d: x.permute(*d))((x @ wq).reshape(B, Sq, Hq, Dh), 0, 2, 1, 3)
        k = (lambda x, n, axis: torch.repeat_interleave(x, n, dim=axis))(k_cache, rep, axis=1)
        v = (lambda x, n, axis: torch.repeat_interleave(x, n, dim=axis))(v_cache, rep, axis=1)
        scores = torch.einsum("bhqd,bhkd->bhqk", q, k) * (Dh ** -0.5)
        p = _softmax(scores, axis=-1)
        o = torch.einsum("bhqk,bhkd->bhqd", p, v)
        return (lambda x, *d: x.permute(*d))(o, 0, 2, 1, 3).reshape(B, Sq, Hq * Dh) @ wo

    def _B_ref(x, w_gate, w_up, w_down):
        g = torch.einsum("bsd,df->bsf", x, w_gate)
        u = torch.einsum("bsd,df->bsf", x, w_up)
        h = _sigmoid(g) * u
        return torch.einsum("bsf,fd->bsd", h, w_down)

    x = A_x
    xn = _layernorm(x, axis=-1)
    s = _A_ref(xn, A_k_cache, A_v_cache, A_wq, A_wo)
    g = _silu(_B_ref(xn, B_w_gate, B_w_up, B_w_down))
    return x + s * g
```

```asm
; @launch grid=(256,1,1) block=(256,1,1) lds=163840
.amdgcn_target "amdgcn-amd-amdhsa--gfx950"
.text
.globl recurrent_scan__gqa_block_cached__glu_gated_glu__prompt_kernel
.p2align 8
.type recurrent_scan__gqa_block_cached__glu_gated_glu__prompt_kernel,@function
recurrent_scan__gqa_block_cached__glu_gated_glu__prompt_kernel:
    s_cmp_ge_u32 s2, 256
    s_cbranch_scc1 K1_END
    s_load_dwordx16 s[64:79], s[0:1], 0
    s_load_dwordx8 s[80:87], s[0:1], 64
    v_lshrrev_b32 v1, 6, v0
    v_and_b32 v126, 63, v0
    v_readfirstlane_b32 s3, v1
    s_and_b32 s6, s2, 7
    s_lshr_b32 s7, s2, 3
    s_lshl_b32 s4, s6, 2
    s_and_b32 s56, s7, 3
    s_add_u32 s4, s4, s56
    s_lshr_b32 s5, s7, 2
    s_getpc_b64 s[32:33]
KPC:
    s_mov_b32 s34, K1_END-KPC
    s_mov_b32 s35, 0x00020000
    s_lshl_b32 s56, s7, 2
    s_add_u32 s56, s56, s3
    s_lshl_b32 s56, s56, 7
    v_lshlrev_b32 v12, 14, v126
    buffer_load_dword v16, v12, s[32:35], s56 offen
    v_and_b32 v1, 15, v126
    v_lshrrev_b32 v2, 4, v126
    v_lshrrev_b32 v3, 2, v1
    v_and_b32 v4, 3, v126
    v_lshrrev_b32 v5, 3, v126
    v_and_b32 v6, 7, v126
    v_lshlrev_b32 v118, 4, v126
    v_lshlrev_b32 v7, 1, v2
    v_xor_b32 v7, v7, v1
    s_lshl_b32 s6, s3, 4
    v_add_u32 v8, s6, v2
    v_lshlrev_b32 v9, 13, v8
    v_xor_b32 v10, 0, v7
    v_lshl_add_u32 v10, v10, 4, v9
    v_add_u32 v104, 0, v10
    v_xor_b32 v10, 0, v7
    v_lshl_add_u32 v10, v10, 4, v9
    v_add_u32 v105, 31744, v10
    v_xor_b32 v10, 8, v7
    v_lshl_add_u32 v10, v10, 4, v9
    v_add_u32 v106, 63488, v10
    v_xor_b32 v10, 8, v7
    v_lshl_add_u32 v10, v10, 4, v9
    v_add_u32 v107, 95232, v10
    v_lshrrev_b32 v7, 1, v5
    v_xor_b32 v7, v7, v6
    v_lshlrev_b32 v8, 10, v5
    v_xor_b32 v9, 0, v7
    v_lshl_add_u32 v9, v9, 4, v8
    v_add_u32 v100, 0, v9
    v_xor_b32 v9, 4, v7
    v_lshl_add_u32 v9, v9, 4, v8
    v_add_u32 v101, 7168, v9
    v_xor_b32 v9, 0, v7
    v_lshl_add_u32 v9, v9, 4, v8
    v_add_u32 v102, 14336, v9
    v_xor_b32 v9, 4, v7
    v_lshl_add_u32 v9, v9, 4, v8
    v_add_u32 v103, 21504, v9
    s_lshl_b32 s49, s3, 13
    s_lshl_b32 s52, s3, 12
    s_add_u32 s50, s52, 65536
    s_add_u32 s51, s52, 81920
    s_and_b32 s6, s5, 7
    s_mul_i32 s6, s6, 1
    s_lshl_b32 s44, s6, 7
    s_add_u32 s45, s44, 32768
    s_lshl_b32 s46, s6, 19
    s_mul_i32 s47, s6, 176128
    s_lshl_b32 s57, s5, 5
    s_add_u32 s57, s57, s4
    s_lshl_b32 s57, s57, 2
    s_add_u32 s57, s57, s3
    s_lshl_b32 s58, s57, 11
    s_waitcnt lgkmcnt(0)
    s_lshl_b32 s6, s4, 8
    s_add_u32 s20, s70, s6
    s_addc_u32 s21, s71, 0
    s_sub_u32 s22, 4194304, s6
    s_mov_b32 s23, 0x00020000
    s_add_u32 m0, s50, 0
    s_nop 0
    buffer_load_dwordx4 v104, s[20:23], s46 offen offset:0 lds
    buffer_load_dwordx4 v105, s[20:23], s46 offen offset:1024 lds
    buffer_load_dwordx4 v106, s[20:23], s46 offen offset:2048 lds
    buffer_load_dwordx4 v107, s[20:23], s46 offen offset:3072 lds
    s_lshl_b32 s6, s5, 2
    s_add_u32 s6, s6, s3
    s_lshl_b32 s7, s6, 16
    s_add_u32 s16, s64, s7
    s_addc_u32 s17, s65, 0
    s_mov_b32 s18, 65536
    s_mov_b32 s19, 0x00020000
    s_add_u32 m0, s49, 0
    s_nop 0
    buffer_load_dwordx4 v100, s[16:19], s44 offen offset:0 lds
    buffer_load_dwordx4 v101, s[16:19], s44 offen offset:1024 lds
    buffer_load_dwordx4 v102, s[16:19], s44 offen offset:2048 lds
    buffer_load_dwordx4 v103, s[16:19], s44 offen offset:3072 lds
    s_add_u32 m0, s49, 4096
    s_nop 0
    buffer_load_dwordx4 v100, s[16:19], s45 offen offset:0 lds
    buffer_load_dwordx4 v101, s[16:19], s45 offen offset:1024 lds
    buffer_load_dwordx4 v102, s[16:19], s45 offen offset:2048 lds
    buffer_load_dwordx4 v103, s[16:19], s45 offen offset:3072 lds
    s_add_u32 s44, s44, 128
    s_and_b32 s44, s44, 1023
    s_add_u32 s45, s44, 32768
    s_and_b32 s6, s3, 1
    s_mul_i32 s6, s6, 88064
    s_movk_i32 s7, 2752
    v_subrev_u32 v9, 0, v126
    v_cmp_gt_u32 vcc, 48, v9
    v_mul_u32_u24 v10, 171, v9
    v_lshrrev_b32 v10, 10, v10
    v_mul_u32_u24 v11, 6, v10
    v_sub_u32 v11, v9, v11
    v_lshlrev_b32 v11, 4, v11
    v_mad_u32_u24 v11, v10, s7, v11
    v_add_u32 v11, s6, v11
    v_mov_b32 v10, 0x40000000
    v_cndmask_b32 v11, v10, v11, vcc
    v_add_u32 v108, 0, v11
    v_add_u32 v110, 41984, v11
    v_subrev_u32 v9, 8, v126
    v_cmp_gt_u32 vcc, 48, v9
    v_mul_u32_u24 v10, 171, v9
    v_lshrrev_b32 v10, 10, v10
    v_mul_u32_u24 v11, 6, v10
    v_sub_u32 v11, v9, v11
    v_lshlrev_b32 v11, 4, v11
    v_mad_u32_u24 v11, v10, s7, v11
    v_add_u32 v11, s6, v11
    v_mov_b32 v10, 0x40000000
    v_cndmask_b32 v11, v10, v11, vcc
    v_add_u32 v109, 20992, v11
    v_add_u32 v111, 62976, v11
    s_cmp_ge_u32 s3, 2
    s_cselect_b32 s76, s78, s76
    s_cselect_b32 s77, s79, s77
    s_mul_i32 s6, s4, 96
    s_add_u32 s24, s76, s6
    s_addc_u32 s25, s77, 0
    s_sub_u32 s26, 1409024, s6
    s_mov_b32 s27, 0x00020000
    s_cmp_ge_u32 s4, 29
    s_cselect_b32 s26, 0, s26
    s_mov_b32 s36, s64
    s_mov_b32 s37, s65
    s_mov_b32 s38, 2097152
    s_mov_b32 s39, 0x00020000
    v_lshrrev_b32 v7, 1, v1
    v_lshlrev_b32 v8, 7, v1
    v_add_u32 v8, s49, v8
    v_add_u32 v9, 0, v2
    v_xor_b32 v9, v9, v7
    v_lshl_add_u32 v112, v9, 4, v8
    v_add_u32 v9, 4, v2
    v_xor_b32 v9, v9, v7
    v_lshl_add_u32 v113, v9, 4, v8
    v_lshl_add_u32 v7, v2, 3, v3
    v_lshlrev_b32 v8, 8, v7
    v_lshl_add_u32 v8, v4, 3, v8
    v_add_u32 v8, 65536, v8
    v_and_b32 v10, 1, v2
    v_lshl_add_u32 v11, v10, 2, v3
    v_xor_b32 v9, 0, v11
    v_lshl_add_u32 v88, v9, 5, v8
    v_xor_b32 v9, 1, v11
    v_lshl_add_u32 v89, v9, 5, v8
    v_xor_b32 v9, 2, v11
    v_lshl_add_u32 v90, v9, 5, v8
    v_xor_b32 v9, 3, v11
    v_lshl_add_u32 v91, v9, 5, v8
    v_xor_b32 v9, 4, v11
    v_lshl_add_u32 v92, v9, 5, v8
    v_xor_b32 v9, 5, v11
    v_lshl_add_u32 v93, v9, 5, v8
    v_xor_b32 v9, 6, v11
    v_lshl_add_u32 v94, v9, 5, v8
    v_xor_b32 v9, 7, v11
    v_lshl_add_u32 v95, v9, 5, v8
    s_lshl_b32 s6, s3, 1
    v_xor_b32 v9, s6, v11
    v_lshl_add_u32 v114, v9, 5, v8
    v_xor_b32 v9, 1, v9
    v_lshl_add_u32 v115, v9, 5, v8
    v_mul_u32_u24 v8, 96, v3
    v_lshl_add_u32 v8, v4, 3, v8
    v_lshl_add_u32 v8, v2, 10, v8
    v_lshl_add_u32 v8, v10, 7, v8
    s_and_b32 s6, s4, 1
    s_lshl_b32 s7, s6, 5
    s_add_u32 s7, s7, 81920
    v_add_u32 v116, s7, v8
    s_lshl_b32 s6, s6, 6
    s_sub_u32 s6, 81984, s6
    v_add_u32 v127, s6, v8
    s_lshl_b32 s56, s3, 5
    s_add_u32 s7, s7, s56
    s_cmp_ge_u32 s3, 2
    s_cselect_b32 s7, s6, s7
    v_add_u32 v117, s7, v8
    v_mov_b32 v96, 0x3f803f80
    v_mov_b32 v97, 0x3f803f80
    v_mov_b32 v98, 0x3f803f80
    v_mov_b32 v99, 0x3f803f80
    s_mov_b32 s88, s86
    s_mov_b32 s89, s87
    s_mov_b32 s90, 268435456
    s_mov_b32 s91, 0x00020000
    s_movk_i32 s86, 256
    s_mov_b32 s87, 0x00020000
    v_mov_b32 v10, 0x40000000
    v_lshlrev_b32 v9, 4, v1
    v_cmp_eq_u32 vcc, 0, v2
    v_cmp_eq_u32 s[6:7], 0, v126
    v_mov_b32 v12, 0
    v_cndmask_b32 v80, v10, v9, vcc
    v_cndmask_b32 v81, v10, v12, s[6:7]
    v_cmp_eq_u32 vcc, 0, v0
    v_mov_b32 v48, 0
    v_mov_b32 v49, 0
    v_mov_b32 v50, 0
    v_mov_b32 v51, 0
    v_cndmask_b32 v82, v10, v12, vcc
    v_mov_b32 v83, v81
    s_memrealtime s[6:7]
    s_lshl_b32 s56, s2, 8
    s_waitcnt lgkmcnt(0)
    s_or_b32 s6, s6, 1
    v_mov_b32 v13, s6
    buffer_store_dword v13, v82, s[84:87], s56 offen sc1
    s_lshl_b32 s63, s2, 7
    s_add_u32 s63, s63, 149946368
    s_lshl_b32 s57, s57, 4
    s_add_u32 s57, s57, 148897792
    v_and_b32 v119, 1, v126
    v_mul_u32_u24 v119, 0xaaaa, v119
    v_add_u32 v119, 0x4444, v119
    v_lshl_or_b32 v119, v119, 16, v119
    v_accvgpr_write_b32 a96, 0
    v_accvgpr_write_b32 a97, 0
    v_accvgpr_write_b32 a98, 0
    v_accvgpr_write_b32 a99, 0
    v_accvgpr_write_b32 a100, 0
    v_accvgpr_write_b32 a101, 0
    v_accvgpr_write_b32 a102, 0
    v_accvgpr_write_b32 a103, 0
    v_accvgpr_write_b32 a104, 0
    v_accvgpr_write_b32 a105, 0
    v_accvgpr_write_b32 a106, 0
    v_accvgpr_write_b32 a107, 0
    v_accvgpr_write_b32 a108, 0
    v_accvgpr_write_b32 a109, 0
    v_accvgpr_write_b32 a110, 0
    v_accvgpr_write_b32 a111, 0
    s_add_u32 m0, s51, 0
    s_nop 0
    buffer_load_dwordx4 v108, s[24:27], s47 offen offset:0 lds
    buffer_load_dwordx4 v109, s[24:27], s47 offen offset:1024 lds
    buffer_load_dwordx4 v110, s[24:27], s47 offen offset:2048 lds
    buffer_load_dwordx4 v111, s[24:27], s47 offen offset:3072 lds
    s_add_u32 s46, s46, 524288
    s_and_b32 s46, s46, 4194303
    s_lshr_b32 s47, s46, 19
    s_mul_i32 s47, s47, 176128
    s_waitcnt vmcnt(5)
    s_barrier
    ds_read_b128 v[0:3], v112 offset:0
    ds_read_b128 v[4:7], v113 offset:0
    ds_read_b128 v[8:11], v112 offset:2048
    s_add_u32 m0, s50, 32768
    ds_read_b128 v[12:15], v113 offset:2048
    ds_read_b128 v[16:19], v112 offset:4096
    ds_read_b128 v[20:23], v113 offset:4096
    buffer_load_dwordx4 v104, s[20:23], s46 offen offset:0 lds
    ds_read_b128 v[24:27], v112 offset:6144
    ds_read_b128 v[28:31], v113 offset:6144
    ds_read_b64_tr_b16 a[128:129], v88 offset:0
    buffer_load_dwordx4 v105, s[20:23], s46 offen offset:1024 lds
    ds_read_b64_tr_b16 a[130:131], v88 offset:1024
    ds_read_b64_tr_b16 a[132:133], v88 offset:8192
    ds_read_b64_tr_b16 a[134:135], v88 offset:9216
    buffer_load_dwordx4 v106, s[20:23], s46 offen offset:2048 lds
    ds_read_b64_tr_b16 a[136:137], v89 offset:0
    ds_read_b64_tr_b16 a[138:139], v89 offset:1024
    ds_read_b64_tr_b16 a[140:141], v89 offset:8192
    buffer_load_dwordx4 v107, s[20:23], s46 offen offset:3072 lds
    ds_read_b64_tr_b16 a[142:143], v89 offset:9216
    ds_read_b64_tr_b16 a[144:145], v90 offset:0
    ds_read_b64_tr_b16 a[146:147], v90 offset:1024
    s_add_u32 m0, s51, 32768
    ds_read_b64_tr_b16 a[148:149], v90 offset:8192
    ds_read_b64_tr_b16 a[150:151], v90 offset:9216
    ds_read_b64_tr_b16 a[152:153], v91 offset:0
    buffer_load_dwordx4 v108, s[24:27], s47 offen offset:0 lds
    ds_read_b64_tr_b16 a[154:155], v91 offset:1024
    ds_read_b64_tr_b16 a[156:157], v91 offset:8192
    ds_read_b64_tr_b16 a[158:159], v91 offset:9216
    buffer_load_dwordx4 v109, s[24:27], s47 offen offset:1024 lds
    ds_read_b64_tr_b16 a[160:161], v92 offset:0
    ds_read_b64_tr_b16 a[162:163], v92 offset:1024
    ds_read_b64_tr_b16 a[164:165], v92 offset:8192
    buffer_load_dwordx4 v110, s[24:27], s47 offen offset:2048 lds
    ds_read_b64_tr_b16 a[166:167], v92 offset:9216
    ds_read_b64_tr_b16 a[168:169], v93 offset:0
    ds_read_b64_tr_b16 a[170:171], v93 offset:1024
    buffer_load_dwordx4 v111, s[24:27], s47 offen offset:3072 lds
    ds_read_b64_tr_b16 a[172:173], v93 offset:8192
    ds_read_b64_tr_b16 a[174:175], v93 offset:9216
    ds_read_b64_tr_b16 a[176:177], v94 offset:0
    s_add_u32 s46, s46, 524288
    ds_read_b64_tr_b16 a[178:179], v94 offset:1024
    ds_read_b64_tr_b16 a[180:181], v94 offset:8192
    ds_read_b64_tr_b16 a[182:183], v94 offset:9216
    s_and_b32 s46, s46, 4194303
    ds_read_b64_tr_b16 a[184:185], v95 offset:0
    ds_read_b64_tr_b16 a[186:187], v95 offset:1024
    ds_read_b64_tr_b16 a[188:189], v95 offset:8192
    s_lshr_b32 s47, s46, 19
    ds_read_b64_tr_b16 a[190:191], v95 offset:9216
    s_mul_i32 s47, s47, 176128
    s_waitcnt lgkmcnt(15)
    v_mfma_f32_16x16x32_bf16 v[128:131], a[128:131], v[0:3], 0
    v_mfma_f32_16x16x32_bf16 v[128:131], a[132:135], v[4:7], v[128:131]
    v_mfma_f32_16x16x32_bf16 v[132:135], a[132:135], v[12:15], 0
    s_add_u32 m0, s49, 32768
    v_mfma_f32_16x16x32_bf16 v[132:135], a[128:131], v[8:11], v[132:135]
    buffer_load_dwordx4 v100, s[16:19], s44 offen offset:0 lds
    v_mfma_f32_16x16x32_bf16 v[136:139], a[128:131], v[16:19], 0
    v_mfma_f32_16x16x32_bf16 v[136:139], a[132:135], v[20:23], v[136:139]
    v_mfma_f32_16x16x32_bf16 v[140:143], a[132:135], v[28:31], 0
    v_mfma_f32_16x16x32_bf16 v[140:143], a[128:131], v[24:27], v[140:143]
    s_waitcnt lgkmcnt(0)
    v_mfma_f32_16x16x32_bf16 v[156:159], a[136:139], v[24:27], 0
    v_mfma_f32_16x16x32_bf16 v[156:159], a[140:143], v[28:31], v[156:159]
    buffer_load_dwordx4 v101, s[16:19], s44 offen offset:1024 lds
    v_mfma_f32_16x16x32_bf16 v[152:155], a[140:143], v[20:23], 0
    v_mfma_f32_16x16x32_bf16 v[152:155], a[136:139], v[16:19], v[152:155]
    v_mfma_f32_16x16x32_bf16 v[148:151], a[136:139], v[8:11], 0
    v_mfma_f32_16x16x32_bf16 v[148:151], a[140:143], v[12:15], v[148:151]
    buffer_load_dwordx4 v102, s[16:19], s44 offen offset:2048 lds
    v_mfma_f32_16x16x32_bf16 v[144:147], a[140:143], v[4:7], 0
    v_mfma_f32_16x16x32_bf16 v[144:147], a[136:139], v[0:3], v[144:147]
    s_waitcnt vmcnt(11)
    s_barrier
    v_mfma_f32_16x16x32_bf16 v[160:163], a[144:147], v[0:3], 0
    ds_read_b64_tr_b16 a[112:113], v114 offset:0
    ds_read_b64_tr_b16 a[114:115], v114 offset:1024
    v_mfma_f32_16x16x32_bf16 v[160:163], a[148:151], v[4:7], v[160:163]
    ds_read_b64_tr_b16 a[116:117], v114 offset:8192
    ds_read_b64_tr_b16 a[118:119], v114 offset:9216
    v_mfma_f32_16x16x32_bf16 v[164:167], a[148:151], v[12:15], 0
    ds_read_b64_tr_b16 a[120:121], v115 offset:0
    ds_read_b64_tr_b16 a[122:123], v115 offset:1024
    v_mfma_f32_16x16x32_bf16 v[164:167], a[144:147], v[8:11], v[164:167]
    buffer_load_dwordx4 v103, s[16:19], s44 offen offset:3072 lds
    v_mfma_f32_16x16x32_bf16 v[168:171], a[144:147], v[16:19], 0
    ds_read_b64_tr_b16 a[124:125], v115 offset:8192
    ds_read_b64_tr_b16 a[126:127], v115 offset:9216
    v_mfma_f32_16x16x32_bf16 v[168:171], a[148:151], v[20:23], v[168:171]
    ds_read_b64_tr_b16 a[240:241], v117 offset:0
    ds_read_b64_tr_b16 a[242:243], v117 offset:384
    v_mfma_f32_16x16x32_bf16 v[172:175], a[148:151], v[28:31], 0
    ds_read_b64_tr_b16 a[244:245], v117 offset:4096
    ds_read_b64_tr_b16 a[246:247], v117 offset:4480
    v_mfma_f32_16x16x32_bf16 v[172:175], a[144:147], v[24:27], v[172:175]
    s_add_u32 m0, s49, 36864
    v_mfma_f32_16x16x32_bf16 v[188:191], a[152:155], v[24:27], 0
    ds_read_b64_tr_b16 a[248:249], v117 offset:8192
    ds_read_b64_tr_b16 a[250:251], v117 offset:8576
    v_mfma_f32_16x16x32_bf16 v[188:191], a[156:159], v[28:31], v[188:191]
    ds_read_b64_tr_b16 a[252:253], v117 offset:12288
    ds_read_b64_tr_b16 a[254:255], v117 offset:12672
    v_mfma_f32_16x16x32_bf16 v[184:187], a[156:159], v[20:23], 0
    ds_read_b64_tr_b16 a[192:193], v116 offset:0
    ds_read_b64_tr_b16 a[194:195], v116 offset:384
    v_mfma_f32_16x16x32_bf16 v[184:187], a[152:155], v[16:19], v[184:187]
    buffer_load_dwordx4 v100, s[16:19], s45 offen offset:0 lds
    v_mfma_f32_16x16x32_bf16 v[180:183], a[152:155], v[8:11], 0
    ds_read_b64_tr_b16 a[196:197], v116 offset:4096
    ds_read_b64_tr_b16 a[198:199], v116 offset:4480
    v_mfma_f32_16x16x32_bf16 v[180:183], a[156:159], v[12:15], v[180:183]
    ds_read_b64_tr_b16 a[200:201], v116 offset:32
    ds_read_b64_tr_b16 a[202:203], v116 offset:416
    v_mfma_f32_16x16x32_bf16 v[176:179], a[156:159], v[4:7], 0
    ds_read_b64_tr_b16 a[204:205], v116 offset:4128
    ds_read_b64_tr_b16 a[206:207], v116 offset:4512
    v_mfma_f32_16x16x32_bf16 v[176:179], a[152:155], v[0:3], v[176:179]
    buffer_load_dwordx4 v101, s[16:19], s45 offen offset:1024 lds
    v_mfma_f32_16x16x32_bf16 v[192:195], a[160:163], v[0:3], 0
    ds_read_b64_tr_b16 a[208:209], v127 offset:0
    ds_read_b64_tr_b16 a[210:211], v127 offset:384
    v_mfma_f32_16x16x32_bf16 v[192:195], a[164:167], v[4:7], v[192:195]
    ds_read_b64_tr_b16 a[212:213], v127 offset:4096
    ds_read_b64_tr_b16 a[214:215], v127 offset:4480
    v_mfma_f32_16x16x32_bf16 v[196:199], a[164:167], v[12:15], 0
    ds_read_b64_tr_b16 a[216:217], v116 offset:8192
    ds_read_b64_tr_b16 a[218:219], v116 offset:8576
    v_mfma_f32_16x16x32_bf16 v[196:199], a[160:163], v[8:11], v[196:199]
    buffer_load_dwordx4 v102, s[16:19], s45 offen offset:2048 lds
    v_mfma_f32_16x16x32_bf16 v[200:203], a[160:163], v[16:19], 0
    ds_read_b64_tr_b16 a[220:221], v116 offset:12288
    ds_read_b64_tr_b16 a[222:223], v116 offset:12672
    v_mfma_f32_16x16x32_bf16 v[200:203], a[164:167], v[20:23], v[200:203]
    ds_read_b64_tr_b16 a[224:225], v116 offset:8224
    ds_read_b64_tr_b16 a[226:227], v116 offset:8608
    v_mfma_f32_16x16x32_bf16 v[204:207], a[164:167], v[28:31], 0
    ds_read_b64_tr_b16 a[228:229], v116 offset:12320
    ds_read_b64_tr_b16 a[230:231], v116 offset:12704
    v_mfma_f32_16x16x32_bf16 v[204:207], a[160:163], v[24:27], v[204:207]
    buffer_load_dwordx4 v103, s[16:19], s45 offen offset:3072 lds
    v_mfma_f32_16x16x32_bf16 v[220:223], a[168:171], v[24:27], 0
    ds_read_b64_tr_b16 a[232:233], v127 offset:8192
    ds_read_b64_tr_b16 a[234:235], v127 offset:8576
    v_mfma_f32_16x16x32_bf16 v[220:223], a[172:175], v[28:31], v[220:223]
    ds_read_b64_tr_b16 a[236:237], v127 offset:12288
    ds_read_b64_tr_b16 a[238:239], v127 offset:12672
    v_mfma_f32_16x16x32_bf16 v[216:219], a[172:175], v[20:23], 0
    s_add_u32 s44, s44, 128
    s_and_b32 s44, s44, 1023
    v_mfma_f32_16x16x32_bf16 v[216:219], a[168:171], v[16:19], v[216:219]
    s_add_u32 s45, s44, 32768
    v_mfma_f32_16x16x32_bf16 v[212:215], a[168:171], v[8:11], 0
    v_mfma_f32_16x16x32_bf16 v[212:215], a[172:175], v[12:15], v[212:215]
    buffer_load_dwordx4 v[64:67], v118, s[36:39], s58 offen
    v_mfma_f32_16x16x32_bf16 v[208:211], a[172:175], v[4:7], 0
    v_mfma_f32_16x16x32_bf16 v[208:211], a[168:171], v[0:3], v[208:211]
    s_waitcnt vmcnt(9) lgkmcnt(0)
    s_barrier
    v_mfma_f32_16x16x32_bf16 v[224:227], a[176:179], v[0:3], 0
    ds_read_b64_tr_b16 a[128:129], v88 offset:32768
    ds_read_b64_tr_b16 a[130:131], v88 offset:33792
    v_mfma_f32_16x16x32_bf16 v[224:227], a[180:183], v[4:7], v[224:227]
    ds_read_b64_tr_b16 a[132:133], v88 offset:40960
    ds_read_b64_tr_b16 a[134:135], v88 offset:41984
    v_mfma_f32_16x16x32_bf16 v[228:231], a[180:183], v[12:15], 0
    ds_read_b64_tr_b16 a[136:137], v89 offset:32768
    ds_read_b64_tr_b16 a[138:139], v89 offset:33792
    v_mfma_f32_16x16x32_bf16 v[228:231], a[176:179], v[8:11], v[228:231]
    buffer_load_dwordx4 v[68:71], v118, s[36:39], s58 offen offset:1024
    v_mfma_f32_16x16x32_bf16 v[232:235], a[176:179], v[16:19], 0
    ds_read_b64_tr_b16 a[140:141], v89 offset:40960
    ds_read_b64_tr_b16 a[142:143], v89 offset:41984
    v_mfma_f32_16x16x32_bf16 v[232:235], a[180:183], v[20:23], v[232:235]
    ds_read_b64_tr_b16 a[144:145], v90 offset:32768
    ds_read_b64_tr_b16 a[146:147], v90 offset:33792
    v_mfma_f32_16x16x32_bf16 v[236:239], a[180:183], v[28:31], 0
    ds_read_b64_tr_b16 a[148:149], v90 offset:40960
    ds_read_b64_tr_b16 a[150:151], v90 offset:41984
    v_mfma_f32_16x16x32_bf16 v[236:239], a[176:179], v[24:27], v[236:239]
    buffer_load_dword v81, off, s[84:87], 0 sc1
    v_mfma_f32_16x16x32_bf16 v[252:255], a[184:187], v[24:27], 0
    ds_read_b64_tr_b16 a[152:153], v91 offset:32768
    ds_read_b64_tr_b16 a[154:155], v91 offset:33792
    v_mfma_f32_16x16x32_bf16 v[252:255], a[188:191], v[28:31], v[252:255]
    ds_read_b64_tr_b16 a[156:157], v91 offset:40960
    ds_read_b64_tr_b16 a[158:159], v91 offset:41984
    v_mfma_f32_16x16x32_bf16 v[248:251], a[188:191], v[20:23], 0
    ds_read_b64_tr_b16 a[160:161], v92 offset:32768
    ds_read_b64_tr_b16 a[162:163], v92 offset:33792
    v_mfma_f32_16x16x32_bf16 v[248:251], a[184:187], v[16:19], v[248:251]
    s_add_u32 m0, s50, 65536
    s_waitcnt vmcnt(3)
    v_mfma_f32_16x16x32_bf16 v[244:247], a[184:187], v[8:11], 0
    ds_read_b64_tr_b16 a[164:165], v92 offset:40960
    ds_read_b64_tr_b16 a[166:167], v92 offset:41984
    v_mfma_f32_16x16x32_bf16 v[244:247], a[188:191], v[12:15], v[244:247]
    ds_read_b64_tr_b16 a[168:169], v93 offset:32768
    ds_read_b64_tr_b16 a[170:171], v93 offset:33792
    v_mfma_f32_16x16x32_bf16 v[240:243], a[188:191], v[4:7], 0
    ds_read_b64_tr_b16 a[172:173], v93 offset:40960
    ds_read_b64_tr_b16 a[174:175], v93 offset:41984
    v_mfma_f32_16x16x32_bf16 v[240:243], a[184:187], v[0:3], v[240:243]
    buffer_load_dwordx4 v104, s[20:23], s46 offen offset:0 lds
    v_smfmac_f32_16x16x64_bf16 a[96:99], v[96:99], a[112:119], v119
    ds_read_b64_tr_b16 a[176:177], v94 offset:32768
    ds_read_b64_tr_b16 a[178:179], v94 offset:33792
    v_smfmac_f32_16x16x64_bf16 a[100:103], v[96:99], a[120:127], v119
    ds_read_b64_tr_b16 a[180:181], v94 offset:40960
    ds_read_b64_tr_b16 a[182:183], v94 offset:41984
    v_smfmac_f32_16x16x64_bf16 a[104:107], v[96:99], a[240:247], v119
    ds_read_b64_tr_b16 a[184:185], v95 offset:32768
    ds_read_b64_tr_b16 a[186:187], v95 offset:33792
    v_smfmac_f32_16x16x64_bf16 a[108:111], v[96:99], a[248:255], v119
    buffer_load_dwordx4 v105, s[20:23], s46 offen offset:1024 lds
    v_mfma_f32_16x16x32_bf16 a[0:3], a[192:195], v[0:3], 0
    ds_read_b64_tr_b16 a[188:189], v95 offset:40960
    ds_read_b128 v[32:35], v112 offset:32768
    v_mfma_f32_16x16x32_bf16 a[0:3], a[196:199], v[4:7], a[0:3]
    v_mfma_f32_16x16x32_bf16 a[24:27], a[196:199], v[12:15], 0
    ds_read_b64_tr_b16 a[190:191], v95 offset:41984
    ds_read_b128 v[36:39], v113 offset:32768
    v_mfma_f32_16x16x32_bf16 a[24:27], a[192:195], v[8:11], a[24:27]
    buffer_load_dwordx4 v106, s[20:23], s46 offen offset:2048 lds
    v_mfma_f32_16x16x32_bf16 a[48:51], a[192:195], v[16:19], 0
    ds_read_b128 v[40:43], v112 offset:34816
    v_mfma_f32_16x16x32_bf16 a[48:51], a[196:199], v[20:23], a[48:51]
    v_mfma_f32_16x16x32_bf16 a[72:75], a[196:199], v[28:31], 0
    ds_read_b128 v[44:47], v113 offset:34816
    v_mfma_f32_16x16x32_bf16 a[72:75], a[192:195], v[24:27], a[72:75]
    buffer_load_dwordx4 v107, s[20:23], s46 offen offset:3072 lds
    v_mfma_f32_16x16x32_bf16 a[76:79], a[200:203], v[24:27], 0
    ds_read_b64_tr_b16 a[192:193], v116 offset:32768
    s_add_u32 m0, s51, 65536
    v_mfma_f32_16x16x32_bf16 a[76:79], a[204:207], v[28:31], a[76:79]
    ds_read_b128 v[48:51], v112 offset:36864
    v_mfma_f32_16x16x32_bf16 a[52:55], a[204:207], v[20:23], 0
    ds_read_b64_tr_b16 a[194:195], v116 offset:33152
    v_mfma_f32_16x16x32_bf16 a[52:55], a[200:203], v[16:19], a[52:55]
    buffer_load_dwordx4 v108, s[24:27], s47 offen offset:0 lds
    v_mfma_f32_16x16x32_bf16 a[28:31], a[200:203], v[8:11], 0
    ds_read_b64_tr_b16 a[196:197], v116 offset:36864
    ds_read_b128 v[52:55], v113 offset:36864
    v_mfma_f32_16x16x32_bf16 a[28:31], a[204:207], v[12:15], a[28:31]
    v_mfma_f32_16x16x32_bf16 a[4:7], a[204:207], v[4:7], 0
    ds_read_b64_tr_b16 a[198:199], v116 offset:37248
    ds_read_b128 v[56:59], v112 offset:38912
    v_mfma_f32_16x16x32_bf16 a[4:7], a[200:203], v[0:3], a[4:7]
    buffer_load_dwordx4 v109, s[24:27], s47 offen offset:1024 lds
    v_mfma_f32_16x16x32_bf16 a[8:11], a[208:211], v[0:3], 0
    ds_read_b64_tr_b16 a[200:201], v116 offset:32800
    ds_read_b128 v[60:63], v113 offset:38912
    v_mfma_f32_16x16x32_bf16 a[8:11], a[212:215], v[4:7], a[8:11]
    v_mfma_f32_16x16x32_bf16 a[32:35], a[212:215], v[12:15], 0
    ds_read_b64_tr_b16 a[202:203], v116 offset:33184
    v_mfma_f32_16x16x32_bf16 a[32:35], a[208:211], v[8:11], a[32:35]
    buffer_load_dwordx4 v110, s[24:27], s47 offen offset:2048 lds
    v_mfma_f32_16x16x32_bf16 a[56:59], a[208:211], v[16:19], 0
    ds_read_b64_tr_b16 a[204:205], v116 offset:36896
    v_mfma_f32_16x16x32_bf16 a[56:59], a[212:215], v[20:23], a[56:59]
    v_mfma_f32_16x16x32_bf16 a[80:83], a[212:215], v[28:31], 0
    ds_read_b64_tr_b16 a[206:207], v116 offset:37280
    v_mfma_f32_16x16x32_bf16 a[80:83], a[208:211], v[24:27], a[80:83]
    buffer_load_dwordx4 v111, s[24:27], s47 offen offset:3072 lds
    v_mfma_f32_16x16x32_bf16 a[84:87], a[216:219], v[24:27], 0
    ds_read_b64_tr_b16 a[208:209], v127 offset:32768
    s_add_u32 s46, s46, 524288
    v_mfma_f32_16x16x32_bf16 a[84:87], a[220:223], v[28:31], a[84:87]
    s_and_b32 s46, s46, 4194303
    s_lshr_b32 s47, s46, 19
    v_mfma_f32_16x16x32_bf16 a[60:63], a[220:223], v[20:23], 0
    ds_read_b64_tr_b16 a[210:211], v127 offset:33152
    s_mul_i32 s47, s47, 176128
    v_mfma_f32_16x16x32_bf16 a[60:63], a[216:219], v[16:19], a[60:63]
    v_mfma_f32_16x16x32_bf16 a[36:39], a[216:219], v[8:11], 0
    ds_read_b64_tr_b16 a[212:213], v127 offset:36864
    v_mfma_f32_16x16x32_bf16 a[36:39], a[220:223], v[12:15], a[36:39]
    v_mfma_f32_16x16x32_bf16 a[12:15], a[220:223], v[4:7], 0
    ds_read_b64_tr_b16 a[214:215], v127 offset:37248
    v_mfma_f32_16x16x32_bf16 a[12:15], a[216:219], v[0:3], a[12:15]
    v_mfma_f32_16x16x32_bf16 a[16:19], a[224:227], v[0:3], 0
    ds_read_b64_tr_b16 a[216:217], v116 offset:40960
    v_mfma_f32_16x16x32_bf16 a[16:19], a[228:231], v[4:7], a[16:19]
    v_mfma_f32_16x16x32_bf16 a[40:43], a[228:231], v[12:15], 0
    ds_read_b64_tr_b16 a[218:219], v116 offset:41344
    v_mfma_f32_16x16x32_bf16 a[40:43], a[224:227], v[8:11], a[40:43]
    v_mfma_f32_16x16x32_bf16 a[64:67], a[224:227], v[16:19], 0
    ds_read_b64_tr_b16 a[220:221], v116 offset:45056
    v_mfma_f32_16x16x32_bf16 a[64:67], a[228:231], v[20:23], a[64:67]
    v_mfma_f32_16x16x32_bf16 a[88:91], a[228:231], v[28:31], 0
    ds_read_b64_tr_b16 a[222:223], v116 offset:45440
    v_mfma_f32_16x16x32_bf16 a[88:91], a[224:227], v[24:27], a[88:91]
    v_mfma_f32_16x16x32_bf16 a[92:95], a[232:235], v[24:27], 0
    ds_read_b64_tr_b16 a[224:225], v116 offset:40992
    v_mfma_f32_16x16x32_bf16 a[92:95], a[236:239], v[28:31], a[92:95]
    v_mfma_f32_16x16x32_bf16 a[68:71], a[236:239], v[20:23], 0
    ds_read_b64_tr_b16 a[226:227], v116 offset:41376
    v_mfma_f32_16x16x32_bf16 a[68:71], a[232:235], v[16:19], a[68:71]
    v_mfma_f32_16x16x32_bf16 a[44:47], a[232:235], v[8:11], 0
    ds_read_b64_tr_b16 a[228:229], v116 offset:45088
    v_mfma_f32_16x16x32_bf16 a[44:47], a[236:239], v[12:15], a[44:47]
    v_mfma_f32_16x16x32_bf16 a[20:23], a[236:239], v[4:7], 0
    ds_read_b64_tr_b16 a[230:231], v116 offset:45472
    v_mfma_f32_16x16x32_bf16 a[20:23], a[232:235], v[0:3], a[20:23]
    s_waitcnt lgkmcnt(4)
    v_mfma_f32_16x16x32_bf16 v[128:131], a[128:131], v[32:35], v[128:131]
    ds_read_b64_tr_b16 a[232:233], v127 offset:40960
    ds_read_b64_tr_b16 a[234:235], v127 offset:41344
    v_mfma_f32_16x16x32_bf16 v[128:131], a[132:135], v[36:39], v[128:131]
    ds_read_b64_tr_b16 a[236:237], v127 offset:45056
    ds_read_b64_tr_b16 a[238:239], v127 offset:45440
    v_mfma_f32_16x16x32_bf16 v[132:135], a[132:135], v[44:47], v[132:135]
    v_add_u32 v88, 0x10000, v88
    v_add_u32 v89, 0x10000, v89
    v_mfma_f32_16x16x32_bf16 v[132:135], a[128:131], v[40:43], v[132:135]
    v_add_u32 v90, 0x10000, v90
    v_add_u32 v91, 0x10000, v91
    v_mfma_f32_16x16x32_bf16 v[136:139], a[128:131], v[48:51], v[136:139]
    v_add_u32 v92, 0x10000, v92
    v_add_u32 v93, 0x10000, v93
    v_mfma_f32_16x16x32_bf16 v[136:139], a[132:135], v[52:55], v[136:139]
    v_add_u32 v94, 0x10000, v94
    v_add_u32 v95, 0x10000, v95
    v_mfma_f32_16x16x32_bf16 v[140:143], a[132:135], v[60:63], v[140:143]
    v_add_u32 v116, 0x10000, v116
    v_add_u32 v127, 0x10000, v127
    v_mfma_f32_16x16x32_bf16 v[140:143], a[128:131], v[56:59], v[140:143]
    s_waitcnt vmcnt(0) lgkmcnt(0)
    s_barrier
    v_mfma_f32_16x16x32_bf16 v[156:159], a[136:139], v[56:59], v[156:159]
    ds_read_b64_tr_b16 a[128:129], v88 offset:0
    v_cmp_eq_u32 vcc, 0, v81
    v_mfma_f32_16x16x32_bf16 v[156:159], a[140:143], v[60:63], v[156:159]
    s_cbranch_vccnz K1_NPOLL
K1_NOK:
    v_mfma_f32_16x16x32_bf16 v[152:155], a[140:143], v[52:55], v[152:155]
    ds_read_b64_tr_b16 a[130:131], v88 offset:1024
    v_readfirstlane_b32 s62, v81
    v_mfma_f32_16x16x32_bf16 v[152:155], a[136:139], v[48:51], v[152:155]
    s_add_u32 m0, s49, 0
    v_lshlrev_b32 v76, 16, v64
    v_mfma_f32_16x16x32_bf16 v[148:151], a[136:139], v[40:43], v[148:151]
    ds_read_b64_tr_b16 a[132:133], v88 offset:8192
    v_and_b32 v77, 0xffff0000, v64
    v_mfma_f32_16x16x32_bf16 v[148:151], a[140:143], v[44:47], v[148:151]
    buffer_load_dwordx4 v100, s[16:19], s44 offen offset:0 lds
    v_mfma_f32_16x16x32_bf16 v[144:147], a[140:143], v[36:39], v[144:147]
    ds_read_b64_tr_b16 a[134:135], v88 offset:9216
    v_add_f32 v72, v76, v77
    v_mfma_f32_16x16x32_bf16 v[144:147], a[136:139], v[32:35], v[144:147]
    v_mul_f32 v73, v76, v76
    v_fmac_f32 v73, v77, v77
    v_mfma_f32_16x16x32_bf16 v[160:163], a[144:147], v[32:35], v[160:163]
    ds_read_b64_tr_b16 a[136:137], v89 offset:0
    v_lshlrev_b32 v78, 16, v65
    v_mfma_f32_16x16x32_bf16 v[160:163], a[148:151], v[36:39], v[160:163]
    buffer_load_dwordx4 v101, s[16:19], s44 offen offset:1024 lds
    v_mfma_f32_16x16x32_bf16 v[164:167], a[148:151], v[44:47], v[164:167]
    ds_read_b64_tr_b16 a[138:139], v89 offset:1024
    v_and_b32 v79, 0xffff0000, v65
    v_mfma_f32_16x16x32_bf16 v[164:167], a[144:147], v[40:43], v[164:167]
    v_add_f32 v72, v72, v78
    v_fmac_f32 v73, v78, v78
    v_mfma_f32_16x16x32_bf16 v[168:171], a[144:147], v[48:51], v[168:171]
    ds_read_b64_tr_b16 a[140:141], v89 offset:8192
    v_add_f32 v72, v72, v79
    v_mfma_f32_16x16x32_bf16 v[168:171], a[148:151], v[52:55], v[168:171]
    buffer_load_dwordx4 v102, s[16:19], s44 offen offset:2048 lds
    v_mfma_f32_16x16x32_bf16 v[172:175], a[148:151], v[60:63], v[172:175]
    ds_read_b64_tr_b16 a[142:143], v89 offset:9216
    v_fmac_f32 v73, v79, v79
    v_mfma_f32_16x16x32_bf16 v[172:175], a[144:147], v[56:59], v[172:175]
    v_lshlrev_b32 v76, 16, v66
    v_and_b32 v77, 0xffff0000, v66
    v_mfma_f32_16x16x32_bf16 v[188:191], a[152:155], v[56:59], v[188:191]
    ds_read_b64_tr_b16 a[144:145], v90 offset:0
    v_add_f32 v72, v72, v76
    v_mfma_f32_16x16x32_bf16 v[188:191], a[156:159], v[60:63], v[188:191]
    buffer_load_dwordx4 v103, s[16:19], s44 offen offset:3072 lds
    v_mfma_f32_16x16x32_bf16 v[184:187], a[156:159], v[52:55], v[184:187]
    ds_read_b64_tr_b16 a[146:147], v90 offset:1024
    s_add_u32 m0, s49, 4096
    v_mfma_f32_16x16x32_bf16 v[184:187], a[152:155], v[48:51], v[184:187]
    v_fmac_f32 v73, v76, v76
    v_add_f32 v72, v72, v77
    v_mfma_f32_16x16x32_bf16 v[180:183], a[152:155], v[40:43], v[180:183]
    ds_read_b64_tr_b16 a[148:149], v90 offset:8192
    v_fmac_f32 v73, v77, v77
    v_mfma_f32_16x16x32_bf16 v[180:183], a[156:159], v[44:47], v[180:183]
    buffer_load_dwordx4 v100, s[16:19], s45 offen offset:0 lds
    v_mfma_f32_16x16x32_bf16 v[176:179], a[156:159], v[36:39], v[176:179]
    ds_read_b64_tr_b16 a[150:151], v90 offset:9216
    v_lshlrev_b32 v78, 16, v67
    v_mfma_f32_16x16x32_bf16 v[176:179], a[152:155], v[32:35], v[176:179]
    v_and_b32 v79, 0xffff0000, v67
    v_add_f32 v72, v72, v78
    v_mfma_f32_16x16x32_bf16 v[192:195], a[160:163], v[32:35], v[192:195]
    ds_read_b64_tr_b16 a[152:153], v91 offset:0
    v_fmac_f32 v73, v78, v78
    v_mfma_f32_16x16x32_bf16 v[192:195], a[164:167], v[36:39], v[192:195]
    buffer_load_dwordx4 v101, s[16:19], s45 offen offset:1024 lds
    v_mfma_f32_16x16x32_bf16 v[196:199], a[164:167], v[44:47], v[196:199]
    ds_read_b64_tr_b16 a[154:155], v91 offset:1024
    v_add_f32 v72, v72, v79
    v_mfma_f32_16x16x32_bf16 v[196:199], a[160:163], v[40:43], v[196:199]
    v_fmac_f32 v73, v79, v79
    v_lshlrev_b32 v76, 16, v68
    v_mfma_f32_16x16x32_bf16 v[200:203], a[160:163], v[48:51], v[200:203]
    ds_read_b64_tr_b16 a[156:157], v91 offset:8192
    v_and_b32 v77, 0xffff0000, v68
    v_mfma_f32_16x16x32_bf16 v[200:203], a[164:167], v[52:55], v[200:203]
    buffer_load_dwordx4 v102, s[16:19], s45 offen offset:2048 lds
    v_mfma_f32_16x16x32_bf16 v[204:207], a[164:167], v[60:63], v[204:207]
    ds_read_b64_tr_b16 a[158:159], v91 offset:9216
    v_add_f32 v74, v76, v77
    v_mfma_f32_16x16x32_bf16 v[204:207], a[160:163], v[56:59], v[204:207]
    v_mul_f32 v75, v76, v76
    v_fmac_f32 v75, v77, v77
    v_mfma_f32_16x16x32_bf16 v[220:223], a[168:171], v[56:59], v[220:223]
    ds_read_b64_tr_b16 a[160:161], v92 offset:0
    v_lshlrev_b32 v78, 16, v69
    v_mfma_f32_16x16x32_bf16 v[220:223], a[172:175], v[60:63], v[220:223]
    buffer_load_dwordx4 v103, s[16:19], s45 offen offset:3072 lds
    v_mfma_f32_16x16x32_bf16 v[216:219], a[172:175], v[52:55], v[216:219]
    ds_read_b64_tr_b16 a[162:163], v92 offset:1024
    s_add_u32 s44, s44, 128
    v_mfma_f32_16x16x32_bf16 v[216:219], a[168:171], v[48:51], v[216:219]
    s_and_b32 s44, s44, 1023
    s_add_u32 s45, s44, 32768
    v_mfma_f32_16x16x32_bf16 v[212:215], a[168:171], v[40:43], v[212:215]
    ds_read_b64_tr_b16 a[164:165], v92 offset:8192
    s_add_u32 m0, s50, 0
    v_mfma_f32_16x16x32_bf16 v[212:215], a[172:175], v[44:47], v[212:215]
    buffer_load_dwordx4 v104, s[20:23], s46 offen offset:0 lds
    v_mfma_f32_16x16x32_bf16 v[208:211], a[172:175], v[36:39], v[208:211]
    ds_read_b64_tr_b16 a[166:167], v92 offset:9216
    v_and_b32 v79, 0xffff0000, v69
    v_mfma_f32_16x16x32_bf16 v[208:211], a[168:171], v[32:35], v[208:211]
    v_add_f32 v74, v74, v78
    v_fmac_f32 v75, v78, v78
    v_mfma_f32_16x16x32_bf16 v[224:227], a[176:179], v[32:35], v[224:227]
    ds_read_b64_tr_b16 a[168:169], v93 offset:0
    v_add_f32 v74, v74, v79
    v_mfma_f32_16x16x32_bf16 v[224:227], a[180:183], v[36:39], v[224:227]
    buffer_load_dwordx4 v105, s[20:23], s46 offen offset:1024 lds
    v_mfma_f32_16x16x32_bf16 v[228:231], a[180:183], v[44:47], v[228:231]
    ds_read_b64_tr_b16 a[170:171], v93 offset:1024
    v_fmac_f32 v75, v79, v79
    v_mfma_f32_16x16x32_bf16 v[228:231], a[176:179], v[40:43], v[228:231]
    v_lshlrev_b32 v76, 16, v70
    v_and_b32 v77, 0xffff0000, v70
    v_mfma_f32_16x16x32_bf16 v[232:235], a[176:179], v[48:51], v[232:235]
    ds_read_b64_tr_b16 a[172:173], v93 offset:8192
    v_add_f32 v74, v74, v76
    v_mfma_f32_16x16x32_bf16 v[232:235], a[180:183], v[52:55], v[232:235]
    buffer_load_dwordx4 v106, s[20:23], s46 offen offset:2048 lds
    v_mfma_f32_16x16x32_bf16 v[236:239], a[180:183], v[60:63], v[236:239]
    ds_read_b64_tr_b16 a[174:175], v93 offset:9216
    v_fmac_f32 v75, v76, v76
    v_mfma_f32_16x16x32_bf16 v[236:239], a[176:179], v[56:59], v[236:239]
    v_add_f32 v74, v74, v77
    v_fmac_f32 v75, v77, v77
    v_mfma_f32_16x16x32_bf16 v[252:255], a[184:187], v[56:59], v[252:255]
    ds_read_b64_tr_b16 a[176:177], v94 offset:0
    v_lshlrev_b32 v78, 16, v71
    v_mfma_f32_16x16x32_bf16 v[252:255], a[188:191], v[60:63], v[252:255]
    buffer_load_dwordx4 v107, s[20:23], s46 offen offset:3072 lds
    v_mfma_f32_16x16x32_bf16 v[248:251], a[188:191], v[52:55], v[248:251]
    ds_read_b64_tr_b16 a[178:179], v94 offset:1024
    s_add_u32 m0, s51, 0
    v_mfma_f32_16x16x32_bf16 v[248:251], a[184:187], v[48:51], v[248:251]
    v_and_b32 v79, 0xffff0000, v71
    v_add_f32 v74, v74, v78
    v_mfma_f32_16x16x32_bf16 v[244:247], a[184:187], v[40:43], v[244:247]
    ds_read_b64_tr_b16 a[180:181], v94 offset:8192
    v_fmac_f32 v75, v78, v78
    v_mfma_f32_16x16x32_bf16 v[244:247], a[188:191], v[44:47], v[244:247]
    buffer_load_dwordx4 v108, s[24:27], s47 offen offset:0 lds
    v_mfma_f32_16x16x32_bf16 v[240:243], a[188:191], v[36:39], v[240:243]
    ds_read_b64_tr_b16 a[182:183], v94 offset:9216
    v_add_f32 v74, v74, v79
    v_mfma_f32_16x16x32_bf16 v[240:243], a[184:187], v[32:35], v[240:243]
    v_fmac_f32 v75, v79, v79
    v_add_f32_dpp v72, v72, v72 row_ror:8 row_mask:0xf bank_mask:0xf
    v_mfma_f32_16x16x32_bf16 a[0:3], a[192:195], v[32:35], a[0:3]
    ds_read_b64_tr_b16 a[184:185], v95 offset:0
    s_waitcnt vmcnt(5)
    v_mfma_f32_16x16x32_bf16 a[0:3], a[196:199], v[36:39], a[0:3]
    buffer_load_dwordx4 v109, s[24:27], s47 offen offset:1024 lds
    v_mfma_f32_16x16x32_bf16 a[24:27], a[196:199], v[44:47], a[24:27]
    ds_read_b64_tr_b16 a[186:187], v95 offset:1024
    ds_read_b128 v[0:3], v112 offset:0
    v_mfma_f32_16x16x32_bf16 a[24:27], a[192:195], v[40:43], a[24:27]
    v_add_f32_dpp v73, v73, v73 row_ror:8 row_mask:0xf bank_mask:0xf
    v_add_f32_dpp v74, v74, v74 row_ror:8 row_mask:0xf bank_mask:0xf
    v_mfma_f32_16x16x32_bf16 a[48:51], a[192:195], v[48:51], a[48:51]
    ds_read_b64_tr_b16 a[188:189], v95 offset:8192
    ds_read_b128 v[4:7], v113 offset:0
    v_mfma_f32_16x16x32_bf16 a[48:51], a[196:199], v[52:55], a[48:51]
    buffer_load_dwordx4 v110, s[24:27], s47 offen offset:2048 lds
    v_mfma_f32_16x16x32_bf16 a[72:75], a[196:199], v[60:63], a[72:75]
    ds_read_b64_tr_b16 a[190:191], v95 offset:9216
    ds_read_b128 v[8:11], v112 offset:2048
    v_mfma_f32_16x16x32_bf16 a[72:75], a[192:195], v[56:59], a[72:75]
    v_add_f32_dpp v75, v75, v75 row_ror:8 row_mask:0xf bank_mask:0xf
    v_add_f32_dpp v72, v72, v72 row_ror:4 row_mask:0xf bank_mask:0xf
    v_mfma_f32_16x16x32_bf16 a[76:79], a[200:203], v[56:59], a[76:79]
    ds_read_b64_tr_b16 a[192:193], v116 offset:0
    ds_read_b128 v[12:15], v113 offset:2048
    v_mfma_f32_16x16x32_bf16 a[76:79], a[204:207], v[60:63], a[76:79]
    buffer_load_dwordx4 v111, s[24:27], s47 offen offset:3072 lds
    v_mfma_f32_16x16x32_bf16 a[52:55], a[204:207], v[52:55], a[52:55]
    ds_read_b64_tr_b16 a[194:195], v116 offset:384
    s_add_u32 s46, s46, 524288
    v_mfma_f32_16x16x32_bf16 a[52:55], a[200:203], v[48:51], a[52:55]
    s_and_b32 s46, s46, 4194303
    s_lshr_b32 s47, s46, 19
    v_mfma_f32_16x16x32_bf16 a[28:31], a[200:203], v[40:43], a[28:31]
    ds_read_b64_tr_b16 a[196:197], v116 offset:4096
    s_mul_i32 s47, s47, 176128
    v_mfma_f32_16x16x32_bf16 a[28:31], a[204:207], v[44:47], a[28:31]
    s_add_u32 m0, s49, 32768
    ds_read_b128 v[16:19], v112 offset:4096
    v_mfma_f32_16x16x32_bf16 a[4:7], a[204:207], v[36:39], a[4:7]
    ds_read_b64_tr_b16 a[198:199], v116 offset:4480
    v_add_f32_dpp v73, v73, v73 row_ror:4 row_mask:0xf bank_mask:0xf
    v_mfma_f32_16x16x32_bf16 a[4:7], a[200:203], v[32:35], a[4:7]
    buffer_load_dwordx4 v100, s[16:19], s44 offen offset:0 lds
    v_mfma_f32_16x16x32_bf16 a[8:11], a[208:211], v[32:35], a[8:11]
    ds_read_b64_tr_b16 a[200:201], v116 offset:32
    ds_read_b128 v[20:23], v113 offset:4096
    v_mfma_f32_16x16x32_bf16 a[8:11], a[212:215], v[36:39], a[8:11]
    v_add_f32_dpp v74, v74, v74 row_ror:4 row_mask:0xf bank_mask:0xf
    v_add_f32_dpp v75, v75, v75 row_ror:4 row_mask:0xf bank_mask:0xf
    v_mfma_f32_16x16x32_bf16 a[32:35], a[212:215], v[44:47], a[32:35]
    ds_read_b64_tr_b16 a[202:203], v116 offset:416
    ds_read_b128 v[24:27], v112 offset:6144
    v_mfma_f32_16x16x32_bf16 a[32:35], a[208:211], v[40:43], a[32:35]
    buffer_load_dwordx4 v101, s[16:19], s44 offen offset:1024 lds
    v_mfma_f32_16x16x32_bf16 a[56:59], a[208:211], v[48:51], a[56:59]
    ds_read_b64_tr_b16 a[204:205], v116 offset:4128
    ds_read_b128 v[28:31], v113 offset:6144
    v_mfma_f32_16x16x32_bf16 a[56:59], a[212:215], v[52:55], a[56:59]
    v_add_f32_dpp v72, v72, v72 row_ror:2 row_mask:0xf bank_mask:0xf
    v_add_f32_dpp v73, v73, v73 row_ror:2 row_mask:0xf bank_mask:0xf
    v_mfma_f32_16x16x32_bf16 a[80:83], a[212:215], v[60:63], a[80:83]
    ds_read_b64_tr_b16 a[206:207], v116 offset:4512
    v_add_f32_dpp v74, v74, v74 row_ror:2 row_mask:0xf bank_mask:0xf
    v_mfma_f32_16x16x32_bf16 a[80:83], a[208:211], v[56:59], a[80:83]
    buffer_load_dwordx4 v102, s[16:19], s44 offen offset:2048 lds
    v_mfma_f32_16x16x32_bf16 a[84:87], a[216:219], v[56:59], a[84:87]
    ds_read_b64_tr_b16 a[208:209], v127 offset:0
    v_add_f32_dpp v75, v75, v75 row_ror:2 row_mask:0xf bank_mask:0xf
    v_mfma_f32_16x16x32_bf16 a[84:87], a[220:223], v[60:63], a[84:87]
    v_add_f32_dpp v72, v72, v72 row_ror:1 row_mask:0xf bank_mask:0xf
    v_add_f32_dpp v73, v73, v73 row_ror:1 row_mask:0xf bank_mask:0xf
    v_mfma_f32_16x16x32_bf16 a[60:63], a[220:223], v[52:55], a[60:63]
    ds_read_b64_tr_b16 a[210:211], v127 offset:384
    v_add_f32_dpp v74, v74, v74 row_ror:1 row_mask:0xf bank_mask:0xf
    v_mfma_f32_16x16x32_bf16 a[60:63], a[216:219], v[48:51], a[60:63]
    buffer_load_dwordx4 v103, s[16:19], s44 offen offset:3072 lds
    v_mfma_f32_16x16x32_bf16 a[36:39], a[216:219], v[40:43], a[36:39]
    ds_read_b64_tr_b16 a[212:213], v127 offset:4096
    s_add_u32 m0, s49, 36864
    v_mfma_f32_16x16x32_bf16 a[36:39], a[220:223], v[44:47], a[36:39]
    v_add_f32_dpp v75, v75, v75 row_ror:1 row_mask:0xf bank_mask:0xf
    v_mov_b32 v76, v72
    v_mfma_f32_16x16x32_bf16 a[12:15], a[220:223], v[36:39], a[12:15]
    ds_read_b64_tr_b16 a[214:215], v127 offset:4480
    v_mov_b32 v77, v73
    v_mfma_f32_16x16x32_bf16 a[12:15], a[216:219], v[32:35], a[12:15]
    buffer_load_dwordx4 v100, s[16:19], s45 offen offset:0 lds
    v_mfma_f32_16x16x32_bf16 a[16:19], a[224:227], v[32:35], a[16:19]
    ds_read_b64_tr_b16 a[216:217], v116 offset:8192
    v_mov_b32 v78, v74
    v_mfma_f32_16x16x32_bf16 a[16:19], a[228:231], v[36:39], a[16:19]
    v_mov_b32 v79, v75
    v_permlane32_swap_b32 v72, v76
    v_mfma_f32_16x16x32_bf16 a[40:43], a[228:231], v[44:47], a[40:43]
    ds_read_b64_tr_b16 a[218:219], v116 offset:8576
    v_permlane32_swap_b32 v73, v77
    v_mfma_f32_16x16x32_bf16 a[40:43], a[224:227], v[40:43], a[40:43]
    buffer_load_dwordx4 v101, s[16:19], s45 offen offset:1024 lds
    v_mfma_f32_16x16x32_bf16 a[64:67], a[224:227], v[48:51], a[64:67]
    ds_read_b64_tr_b16 a[220:221], v116 offset:12288
    v_permlane32_swap_b32 v74, v78
    v_mfma_f32_16x16x32_bf16 a[64:67], a[228:231], v[52:55], a[64:67]
    v_permlane32_swap_b32 v75, v79
    v_add_f32 v72, v72, v76
    v_mfma_f32_16x16x32_bf16 a[88:91], a[228:231], v[60:63], a[88:91]
    ds_read_b64_tr_b16 a[222:223], v116 offset:12672
    v_add_f32 v73, v73, v77
    v_mfma_f32_16x16x32_bf16 a[88:91], a[224:227], v[56:59], a[88:91]
    buffer_load_dwordx4 v102, s[16:19], s45 offen offset:2048 lds
    v_mfma_f32_16x16x32_bf16 a[92:95], a[232:235], v[56:59], a[92:95]
    ds_read_b64_tr_b16 a[224:225], v116 offset:8224
    v_add_f32 v74, v74, v78
    v_mfma_f32_16x16x32_bf16 a[92:95], a[236:239], v[60:63], a[92:95]
    v_add_f32 v75, v75, v79
    v_mov_b32 v76, v72
    v_mfma_f32_16x16x32_bf16 a[68:71], a[236:239], v[52:55], a[68:71]
    ds_read_b64_tr_b16 a[226:227], v116 offset:8608
    v_mov_b32 v77, v73
    v_mfma_f32_16x16x32_bf16 a[68:71], a[232:235], v[48:51], a[68:71]
    buffer_load_dwordx4 v103, s[16:19], s45 offen offset:3072 lds
    v_mfma_f32_16x16x32_bf16 a[44:47], a[232:235], v[40:43], a[44:47]
    ds_read_b64_tr_b16 a[228:229], v116 offset:12320
    s_add_u32 s44, s44, 128
    v_mfma_f32_16x16x32_bf16 a[44:47], a[236:239], v[44:47], a[44:47]
    s_and_b32 s44, s44, 1023
    s_add_u32 s45, s44, 32768
    v_mfma_f32_16x16x32_bf16 a[20:23], a[236:239], v[36:39], a[20:23]
    ds_read_b64_tr_b16 a[230:231], v116 offset:12704
    v_mov_b32 v78, v74
    v_mfma_f32_16x16x32_bf16 a[20:23], a[232:235], v[32:35], a[20:23]
    s_waitcnt lgkmcnt(4)
    v_mov_b32 v79, v75
    v_mfma_f32_16x16x32_bf16 v[128:131], a[128:131], v[0:3], v[128:131]
    ds_read_b64_tr_b16 a[232:233], v127 offset:8192
    ds_read_b64_tr_b16 a[234:235], v127 offset:8576
    v_mfma_f32_16x16x32_bf16 v[128:131], a[132:135], v[4:7], v[128:131]
    ds_read_b64_tr_b16 a[236:237], v127 offset:12288
    ds_read_b64_tr_b16 a[238:239], v127 offset:12672
    v_mfma_f32_16x16x32_bf16 v[132:135], a[132:135], v[12:15], v[132:135]
    v_subrev_u32 v88, 0x10000, v88
    v_subrev_u32 v89, 0x10000, v89
    v_mfma_f32_16x16x32_bf16 v[132:135], a[128:131], v[8:11], v[132:135]
    v_subrev_u32 v90, 0x10000, v90
    v_subrev_u32 v91, 0x10000, v91
    v_mfma_f32_16x16x32_bf16 v[136:139], a[128:131], v[16:19], v[136:139]
    v_subrev_u32 v92, 0x10000, v92
    v_subrev_u32 v93, 0x10000, v93
    v_mfma_f32_16x16x32_bf16 v[136:139], a[132:135], v[20:23], v[136:139]
    v_subrev_u32 v94, 0x10000, v94
    v_subrev_u32 v95, 0x10000, v95
    v_mfma_f32_16x16x32_bf16 v[140:143], a[132:135], v[28:31], v[140:143]
    v_subrev_u32 v116, 0x10000, v116
    v_subrev_u32 v127, 0x10000, v127
    v_mfma_f32_16x16x32_bf16 v[140:143], a[128:131], v[24:27], v[140:143]
    s_waitcnt vmcnt(8) lgkmcnt(0)
    s_barrier
    v_mfma_f32_16x16x32_bf16 v[156:159], a[136:139], v[24:27], v[156:159]
    ds_read_b64_tr_b16 a[128:129], v88 offset:0
    s_add_u32 m0, s50, 32768
    v_mfma_f32_16x16x32_bf16 v[156:159], a[140:143], v[28:31], v[156:159]
    buffer_load_dwordx4 v104, s[20:23], s46 offen offset:0 lds
    v_mfma_f32_16x16x32_bf16 v[152:155], a[140:143], v[20:23], v[152:155]
    ds_read_b64_tr_b16 a[130:131], v88 offset:1024
    v_permlane16_swap_b32 v72, v76
    v_mfma_f32_16x16x32_bf16 v[152:155], a[136:139], v[16:19], v[152:155]
    v_permlane16_swap_b32 v73, v77
    v_permlane16_swap_b32 v74, v78
    v_mfma_f32_16x16x32_bf16 v[148:151], a[136:139], v[8:11], v[148:151]
    ds_read_b64_tr_b16 a[132:133], v88 offset:8192
    v_permlane16_swap_b32 v75, v79
    v_mfma_f32_16x16x32_bf16 v[148:151], a[140:143], v[12:15], v[148:151]
    buffer_load_dwordx4 v105, s[20:23], s46 offen offset:1024 lds
    v_mfma_f32_16x16x32_bf16 v[144:147], a[140:143], v[4:7], v[144:147]
    ds_read_b64_tr_b16 a[134:135], v88 offset:9216
    v_add_f32 v72, v72, v76
    v_mfma_f32_16x16x32_bf16 v[144:147], a[136:139], v[0:3], v[144:147]
    v_add_f32 v73, v73, v77
    v_add_f32 v74, v74, v78
    v_mfma_f32_16x16x32_bf16 v[160:163], a[144:147], v[0:3], v[160:163]
    ds_read_b64_tr_b16 a[136:137], v89 offset:0
    v_add_f32 v75, v75, v79
    v_mfma_f32_16x16x32_bf16 v[160:163], a[148:151], v[4:7], v[160:163]
    buffer_load_dwordx4 v106, s[20:23], s46 offen offset:2048 lds
    v_mfma_f32_16x16x32_bf16 v[164:167], a[148:151], v[12:15], v[164:167]
    ds_read_b64_tr_b16 a[138:139], v89 offset:1024
    v_mul_f32 v72, 0xbb000000, v72
    v_mfma_f32_16x16x32_bf16 v[164:167], a[144:147], v[8:11], v[164:167]
    v_mul_f32 v73, 0x3b000000, v73
    v_fma_f32 v73, -v72, v72, v73
    v_mfma_f32_16x16x32_bf16 v[168:171], a[144:147], v[16:19], v[168:171]
    ds_read_b64_tr_b16 a[140:141], v89 offset:8192
    v_max_f32 v73, 0, v73
    v_mfma_f32_16x16x32_bf16 v[168:171], a[148:151], v[20:23], v[168:171]
    buffer_load_dwordx4 v107, s[20:23], s46 offen offset:3072 lds
    v_mfma_f32_16x16x32_bf16 v[172:175], a[148:151], v[28:31], v[172:175]
    ds_read_b64_tr_b16 a[142:143], v89 offset:9216
    s_add_u32 m0, s51, 32768
    v_mfma_f32_16x16x32_bf16 v[172:175], a[144:147], v[24:27], v[172:175]
    v_add_f32 v73, 0x3727c5ac, v73
    v_mul_f32 v74, 0xbb000000, v74
    v_mfma_f32_16x16x32_bf16 v[188:191], a[152:155], v[24:27], v[188:191]
    ds_read_b64_tr_b16 a[144:145], v90 offset:0
    v_mul_f32 v75, 0x3b000000, v75
    v_mfma_f32_16x16x32_bf16 v[188:191], a[156:159], v[28:31], v[188:191]
    buffer_load_dwordx4 v108, s[24:27], s47 offen offset:0 lds
    v_mfma_f32_16x16x32_bf16 v[184:187], a[156:159], v[20:23], v[184:187]
    ds_read_b64_tr_b16 a[146:147], v90 offset:1024
    v_fma_f32 v75, -v74, v74, v75
    v_mfma_f32_16x16x32_bf16 v[184:187], a[152:155], v[16:19], v[184:187]
    v_max_f32 v75, 0, v75
    v_add_f32 v75, 0x3727c5ac, v75
    v_mfma_f32_16x16x32_bf16 v[180:183], a[152:155], v[8:11], v[180:183]
    ds_read_b64_tr_b16 a[148:149], v90 offset:8192
    v_mfma_f32_16x16x32_bf16 v[180:183], a[156:159], v[12:15], v[180:183]
    buffer_load_dwordx4 v109, s[24:27], s47 offen offset:1024 lds
    v_mfma_f32_16x16x32_bf16 v[176:179], a[156:159], v[4:7], v[176:179]
    ds_read_b64_tr_b16 a[150:151], v90 offset:9216
    s_waitcnt vmcnt(6)
    v_mfma_f32_16x16x32_bf16 v[176:179], a[152:155], v[0:3], v[176:179]
    ds_read_b128 v[32:35], v112 offset:32768
    v_mfma_f32_16x16x32_bf16 v[192:195], a[160:163], v[0:3], v[192:195]
    ds_read_b64_tr_b16 a[152:153], v91 offset:0
    v_mfma_f32_16x16x32_bf16 v[192:195], a[164:167], v[4:7], v[192:195]
    buffer_load_dwordx4 v110, s[24:27], s47 offen offset:2048 lds
    v_mfma_f32_16x16x32_bf16 v[196:199], a[164:167], v[12:15], v[196:199]
    ds_read_b64_tr_b16 a[154:155], v91 offset:1024
    ds_read_b128 v[36:39], v113 offset:32768
    v_mfma_f32_16x16x32_bf16 v[196:199], a[160:163], v[8:11], v[196:199]
    buffer_store_dwordx4 v[72:75], v83, s[88:91], s57 offen sc1
    v_mfma_f32_16x16x32_bf16 v[200:203], a[160:163], v[16:19], v[200:203]
    ds_read_b64_tr_b16 a[156:157], v91 offset:8192
    ds_read_b128 v[40:43], v112 offset:34816
    v_mfma_f32_16x16x32_bf16 v[200:203], a[164:167], v[20:23], v[200:203]
    buffer_load_dwordx4 v111, s[24:27], s47 offen offset:3072 lds
    v_mfma_f32_16x16x32_bf16 v[204:207], a[164:167], v[28:31], v[204:207]
    ds_read_b64_tr_b16 a[158:159], v91 offset:9216
    s_add_u32 s46, s46, 524288
    v_mfma_f32_16x16x32_bf16 v[204:207], a[160:163], v[24:27], v[204:207]
    s_and_b32 s46, s46, 4194303
    s_lshr_b32 s47, s46, 19
    v_mfma_f32_16x16x32_bf16 v[220:223], a[168:171], v[24:27], v[220:223]
    ds_read_b64_tr_b16 a[160:161], v92 offset:0
    s_mul_i32 s47, s47, 176128
    v_mfma_f32_16x16x32_bf16 v[220:223], a[172:175], v[28:31], v[220:223]
    s_add_u32 m0, s49, 0
    ds_read_b128 v[44:47], v113 offset:34816
    v_mfma_f32_16x16x32_bf16 v[216:219], a[172:175], v[20:23], v[216:219]
    ds_read_b64_tr_b16 a[162:163], v92 offset:1024
    s_lshl_b32 s6, s4, 3
    v_mfma_f32_16x16x32_bf16 v[216:219], a[168:171], v[16:19], v[216:219]
    buffer_load_dwordx4 v100, s[16:19], s44 offen offset:0 lds
    v_mfma_f32_16x16x32_bf16 v[212:215], a[168:171], v[8:11], v[212:215]
    ds_read_b64_tr_b16 a[164:165], v92 offset:8192
    ds_read_b128 v[48:51], v112 offset:36864
    v_mfma_f32_16x16x32_bf16 v[212:215], a[172:175], v[12:15], v[212:215]
    s_add_u32 s6, s6, s5
    s_lshl_b32 s6, s6, 2
    v_mfma_f32_16x16x32_bf16 v[208:211], a[172:175], v[4:7], v[208:211]
    ds_read_b64_tr_b16 a[166:167], v92 offset:9216
    ds_read_b128 v[52:55], v113 offset:36864
    v_mfma_f32_16x16x32_bf16 v[208:211], a[168:171], v[0:3], v[208:211]
    buffer_load_dwordx4 v101, s[16:19], s44 offen offset:1024 lds
    v_mfma_f32_16x16x32_bf16 v[224:227], a[176:179], v[0:3], v[224:227]
    ds_read_b64_tr_b16 a[168:169], v93 offset:0
    ds_read_b128 v[56:59], v112 offset:38912
    v_mfma_f32_16x16x32_bf16 v[224:227], a[180:183], v[4:7], v[224:227]
    s_add_u32 s6, s6, s3
    s_lshl_b32 s6, s6, 8
    v_mfma_f32_16x16x32_bf16 v[228:231], a[180:183], v[12:15], v[228:231]
    ds_read_b64_tr_b16 a[170:171], v93 offset:1024
    ds_read_b128 v[60:63], v113 offset:38912
    v_mfma_f32_16x16x32_bf16 v[228:231], a[176:179], v[8:11], v[228:231]
    buffer_load_dwordx4 v102, s[16:19], s44 offen offset:2048 lds
    v_mfma_f32_16x16x32_bf16 v[232:235], a[176:179], v[16:19], v[232:235]
    ds_read_b64_tr_b16 a[172:173], v93 offset:8192
    s_add_u32 s71, s6, 148963328
    v_mfma_f32_16x16x32_bf16 v[232:235], a[180:183], v[20:23], v[232:235]
    v_accvgpr_read_b32 v64, a96
    v_accvgpr_read_b32 v68, a97
    v_mfma_f32_16x16x32_bf16 v[236:239], a[180:183], v[28:31], v[236:239]
    ds_read_b64_tr_b16 a[174:175], v93 offset:9216
    v_accvgpr_read_b32 v65, a100
    v_mfma_f32_16x16x32_bf16 v[236:239], a[176:179], v[24:27], v[236:239]
    buffer_load_dwordx4 v103, s[16:19], s44 offen offset:3072 lds
    v_mfma_f32_16x16x32_bf16 v[252:255], a[184:187], v[24:27], v[252:255]
    ds_read_b64_tr_b16 a[176:177], v94 offset:0
    s_add_u32 m0, s49, 4096
    v_mfma_f32_16x16x32_bf16 v[252:255], a[188:191], v[28:31], v[252:255]
    v_accvgpr_read_b32 v69, a101
    v_accvgpr_read_b32 v66, a104
    v_mfma_f32_16x16x32_bf16 v[248:251], a[188:191], v[20:23], v[248:251]
    ds_read_b64_tr_b16 a[178:179], v94 offset:1024
    v_accvgpr_read_b32 v70, a105
    v_mfma_f32_16x16x32_bf16 v[248:251], a[184:187], v[16:19], v[248:251]
    buffer_load_dwordx4 v100, s[16:19], s45 offen offset:0 lds
    v_mfma_f32_16x16x32_bf16 v[244:247], a[184:187], v[8:11], v[244:247]
    ds_read_b64_tr_b16 a[180:181], v94 offset:8192
    v_accvgpr_read_b32 v67, a108
    v_mfma_f32_16x16x32_bf16 v[244:247], a[188:191], v[12:15], v[244:247]
    v_accvgpr_read_b32 v71, a109
    v_add_f32 v64, v64, v68
    v_mfma_f32_16x16x32_bf16 v[240:243], a[188:191], v[4:7], v[240:243]
    ds_read_b64_tr_b16 a[182:183], v94 offset:9216
    v_add_f32 v65, v65, v69
    v_mfma_f32_16x16x32_bf16 v[240:243], a[184:187], v[0:3], v[240:243]
    buffer_load_dwordx4 v101, s[16:19], s45 offen offset:1024 lds
    v_mfma_f32_16x16x32_bf16 a[0:3], a[192:195], v[0:3], a[0:3]
    ds_read_b64_tr_b16 a[184:185], v95 offset:0
    v_add_f32 v66, v66, v70
    v_mfma_f32_16x16x32_bf16 a[0:3], a[196:199], v[4:7], a[0:3]
    v_add_f32 v67, v67, v71
    v_mfma_f32_16x16x32_bf16 a[24:27], a[196:199], v[12:15], a[24:27]
    ds_read_b64_tr_b16 a[186:187], v95 offset:1024
    v_mfma_f32_16x16x32_bf16 a[24:27], a[192:195], v[8:11], a[24:27]
    buffer_load_dwordx4 v102, s[16:19], s45 offen offset:2048 lds
    v_mfma_f32_16x16x32_bf16 a[48:51], a[192:195], v[16:19], a[48:51]
    ds_read_b64_tr_b16 a[188:189], v95 offset:8192
    v_mfma_f32_16x16x32_bf16 a[48:51], a[196:199], v[20:23], a[48:51]
    buffer_store_dwordx4 v[64:67], v80, s[88:91], s71 offen sc1
    v_mfma_f32_16x16x32_bf16 a[72:75], a[196:199], v[28:31], a[72:75]
    ds_read_b64_tr_b16 a[190:191], v95 offset:9216
    s_nop 0
    v_mfma_f32_16x16x32_bf16 a[72:75], a[192:195], v[24:27], a[72:75]
    buffer_load_dwordx4 v103, s[16:19], s45 offen offset:3072 lds
    v_mfma_f32_16x16x32_bf16 a[76:79], a[200:203], v[24:27], a[76:79]
    ds_read_b64_tr_b16 a[192:193], v116 offset:0
    s_add_u32 s44, s44, 128
    v_mfma_f32_16x16x32_bf16 a[76:79], a[204:207], v[28:31], a[76:79]
    s_and_b32 s44, s44, 1023
    s_add_u32 s45, s44, 32768
    v_mfma_f32_16x16x32_bf16 a[52:55], a[204:207], v[20:23], a[52:55]
    ds_read_b64_tr_b16 a[194:195], v116 offset:384
    s_lshl_b32 s6, s4, 19
    v_mfma_f32_16x16x32_bf16 a[52:55], a[200:203], v[16:19], a[52:55]
    s_add_u32 s8, s66, s6
    s_addc_u32 s9, s67, 0
    v_mfma_f32_16x16x32_bf16 a[28:31], a[200:203], v[8:11], a[28:31]
    ds_read_b64_tr_b16 a[196:197], v116 offset:4096
    v_mfma_f32_16x16x32_bf16 a[28:31], a[204:207], v[12:15], a[28:31]
    s_add_u32 s12, s68, s6
    s_addc_u32 s13, s69, 0
    v_mfma_f32_16x16x32_bf16 a[4:7], a[204:207], v[4:7], a[4:7]
    ds_read_b64_tr_b16 a[198:199], v116 offset:4480
    s_mov_b32 s10, 524288
    v_mfma_f32_16x16x32_bf16 a[4:7], a[200:203], v[0:3], a[4:7]
    s_mov_b32 s11, 0x00020000
    s_mov_b32 s14, 524288
    v_mfma_f32_16x16x32_bf16 a[8:11], a[208:211], v[0:3], a[8:11]
    ds_read_b64_tr_b16 a[200:201], v116 offset:32
    s_mov_b32 s15, 0x00020000
    v_mfma_f32_16x16x32_bf16 a[8:11], a[212:215], v[4:7], a[8:11]
    s_mov_b64 s[98:99], s[8:9]
    s_mov_b64 s[100:101], s[12:13]
    v_mfma_f32_16x16x32_bf16 a[32:35], a[212:215], v[12:15], a[32:35]
    ds_read_b64_tr_b16 a[202:203], v116 offset:416
    v_accvgpr_write_b32 a96, -1
    v_mfma_f32_16x16x32_bf16 a[32:35], a[208:211], v[8:11], a[32:35]
    v_accvgpr_write_b32 a97, -1
    v_accvgpr_write_b32 a98, -1
    v_mfma_f32_16x16x32_bf16 a[56:59], a[208:211], v[16:19], a[56:59]
    ds_read_b64_tr_b16 a[204:205], v116 offset:4128
    v_accvgpr_write_b32 a99, -1
    v_mfma_f32_16x16x32_bf16 a[56:59], a[212:215], v[20:23], a[56:59]
    s_and_b32 s6, s2, 7
    s_lshr_b32 s7, s2, 3
    v_mfma_f32_16x16x32_bf16 a[80:83], a[212:215], v[28:31], a[80:83]
    ds_read_b64_tr_b16 a[206:207], v116 offset:4512
    s_lshr_b32 s79, s6, 2
    v_mfma_f32_16x16x32_bf16 a[80:83], a[208:211], v[24:27], a[80:83]
    s_lshl_b32 s74, s79, 1
    s_add_u32 s74, s74, s6
    v_mfma_f32_16x16x32_bf16 a[84:87], a[216:219], v[24:27], a[84:87]
    ds_read_b64_tr_b16 a[208:209], v127 offset:0
    s_add_u32 s74, s74, 1
    v_mfma_f32_16x16x32_bf16 a[84:87], a[220:223], v[28:31], a[84:87]
    s_and_b32 s74, s74, 3
    s_lshl_b32 s79, s79, 3
    v_mfma_f32_16x16x32_bf16 a[60:63], a[220:223], v[20:23], a[60:63]
    ds_read_b64_tr_b16 a[210:211], v127 offset:384
    s_and_b32 s6, s7, 7
    v_mfma_f32_16x16x32_bf16 a[60:63], a[216:219], v[16:19], a[60:63]
    s_add_u32 s79, s79, s6
    s_lshr_b32 s56, s7, 3
    v_mfma_f32_16x16x32_bf16 a[36:39], a[216:219], v[8:11], a[36:39]
    ds_read_b64_tr_b16 a[212:213], v127 offset:4096
    s_lshl_b32 s7, s7, 2
    v_mfma_f32_16x16x32_bf16 a[36:39], a[220:223], v[12:15], a[36:39]
    s_add_u32 s7, s7, s3
    s_lshl_b32 s68, s74, 7
    v_mfma_f32_16x16x32_bf16 a[12:15], a[220:223], v[4:7], a[12:15]
    ds_read_b64_tr_b16 a[214:215], v127 offset:4480
    s_add_u32 s68, s68, s7
    v_mfma_f32_16x16x32_bf16 a[12:15], a[216:219], v[0:3], a[12:15]
    s_lshl_b32 s68, s68, 13
    s_mul_i32 s69, s74, 352
    v_mfma_f32_16x16x32_bf16 a[16:19], a[224:227], v[0:3], a[16:19]
    ds_read_b64_tr_b16 a[216:217], v116 offset:8192
    s_mul_i32 s7, s7, 3
    v_mfma_f32_16x16x32_bf16 a[16:19], a[228:231], v[4:7], a[16:19]
    s_add_u32 s69, s69, s7
    s_lshl_b32 s69, s69, 10
    v_mfma_f32_16x16x32_bf16 a[40:43], a[228:231], v[12:15], a[40:43]
    ds_read_b64_tr_b16 a[218:219], v116 offset:8576
    s_lshl_b32 s54, s79, 2
    v_mfma_f32_16x16x32_bf16 a[40:43], a[224:227], v[8:11], a[40:43]
    s_add_u32 s54, s54, s56
    s_lshl_b32 s54, s54, 18
    v_mfma_f32_16x16x32_bf16 a[64:67], a[224:227], v[16:19], a[64:67]
    ds_read_b64_tr_b16 a[220:221], v116 offset:12288
    s_lshl_b32 s6, s3, 12
    v_mfma_f32_16x16x32_bf16 a[64:67], a[228:231], v[20:23], a[64:67]
    s_add_u32 s54, s54, s6
    s_add_u32 s70, s54, 150994944
    v_mfma_f32_16x16x32_bf16 a[88:91], a[228:231], v[28:31], a[88:91]
    ds_read_b64_tr_b16 a[222:223], v116 offset:12672
    s_add_u32 s6, s74, 1
    v_mfma_f32_16x16x32_bf16 a[88:91], a[224:227], v[24:27], a[88:91]
    s_and_b32 s6, s6, 3
    s_lshl_b32 s6, s6, 2
    v_mfma_f32_16x16x32_bf16 a[92:95], a[232:235], v[24:27], a[92:95]
    ds_read_b64_tr_b16 a[224:225], v116 offset:8224
    s_add_u32 s6, s6, s74
    v_mfma_f32_16x16x32_bf16 a[92:95], a[236:239], v[28:31], a[92:95]
    s_lshl_b32 s6, s6, 14
    s_add_u32 s40, s6, s70
    v_mfma_f32_16x16x32_bf16 a[68:71], a[236:239], v[20:23], a[68:71]
    ds_read_b64_tr_b16 a[226:227], v116 offset:8608
    s_add_u32 s6, s74, 2
    v_mfma_f32_16x16x32_bf16 a[68:71], a[232:235], v[16:19], a[68:71]
    s_and_b32 s6, s6, 3
    s_lshl_b32 s6, s6, 2
    v_mfma_f32_16x16x32_bf16 a[44:47], a[232:235], v[8:11], a[44:47]
    ds_read_b64_tr_b16 a[228:229], v116 offset:12320
    s_add_u32 s6, s6, s74
    v_mfma_f32_16x16x32_bf16 a[44:47], a[236:239], v[12:15], a[44:47]
    s_lshl_b32 s6, s6, 14
    s_add_u32 s41, s6, s70
    v_mfma_f32_16x16x32_bf16 a[20:23], a[236:239], v[4:7], a[20:23]
    ds_read_b64_tr_b16 a[230:231], v116 offset:12704
    s_add_u32 s6, s74, 3
    v_mfma_f32_16x16x32_bf16 a[20:23], a[232:235], v[0:3], a[20:23]
    s_waitcnt lgkmcnt(4)
    s_and_b32 s6, s6, 3
    v_mfma_f32_16x16x32_bf16 v[128:131], a[128:131], v[32:35], v[128:131]
    ds_read_b64_tr_b16 a[232:233], v127 offset:8192
    ds_read_b64_tr_b16 a[234:235], v127 offset:8576
    v_mfma_f32_16x16x32_bf16 v[128:131], a[132:135], v[36:39], v[128:131]
    ds_read_b64_tr_b16 a[236:237], v127 offset:12288
    ds_read_b64_tr_b16 a[238:239], v127 offset:12672
    v_mfma_f32_16x16x32_bf16 v[132:135], a[132:135], v[44:47], v[132:135]
    s_add_u32 m0, s50, 65536
    s_lshl_b32 s6, s6, 2
    v_mfma_f32_16x16x32_bf16 v[132:135], a[128:131], v[40:43], v[132:135]
    buffer_load_dwordx4 v104, s[20:23], s46 offen offset:0 lds
    v_mfma_f32_16x16x32_bf16 v[136:139], a[128:131], v[48:51], v[136:139]
    s_add_u32 s6, s6, s74
    s_lshl_b32 s6, s6, 14
    v_mfma_f32_16x16x32_bf16 v[136:139], a[132:135], v[52:55], v[136:139]
    s_add_u32 s42, s6, s70
    s_lshr_b32 s7, s3, 1
    v_mfma_f32_16x16x32_bf16 v[140:143], a[132:135], v[60:63], v[140:143]
    s_lshl_b32 s6, s7, 12
    s_sub_u32 s75, 700416, s6
    v_mfma_f32_16x16x32_bf16 v[140:143], a[128:131], v[56:59], v[140:143]
    s_waitcnt vmcnt(2) lgkmcnt(0)
    s_barrier
    v_mfma_f32_16x16x32_bf16 v[156:159], a[136:139], v[56:59], v[156:159]
    ds_read_b64_tr_b16 a[128:129], v88 offset:32768
    s_and_b32 s7, s3, 1
    v_mfma_f32_16x16x32_bf16 v[156:159], a[140:143], v[60:63], v[156:159]
    buffer_load_dwordx4 v105, s[20:23], s46 offen offset:1024 lds
    v_mfma_f32_16x16x32_bf16 v[152:155], a[140:143], v[52:55], v[152:155]
    ds_read_b64_tr_b16 a[130:131], v88 offset:33792
    s_lshl_b32 s54, s79, 1
    v_mfma_f32_16x16x32_bf16 v[152:155], a[136:139], v[48:51], v[152:155]
    s_add_u32 s54, s54, s7
    s_mul_i32 s54, s54, 700416
    v_mfma_f32_16x16x32_bf16 v[148:151], a[136:139], v[40:43], v[148:151]
    ds_read_b64_tr_b16 a[132:133], v88 offset:40960
    s_add_u32 s54, s54, s6
    v_mfma_f32_16x16x32_bf16 v[148:151], a[140:143], v[44:47], v[148:151]
    buffer_load_dwordx4 v106, s[20:23], s46 offen offset:2048 lds
    v_mfma_f32_16x16x32_bf16 v[144:147], a[140:143], v[36:39], v[144:147]
    ds_read_b64_tr_b16 a[134:135], v88 offset:41984
    s_add_u32 s54, s54, 125829120
    v_mfma_f32_16x16x32_bf16 v[144:147], a[136:139], v[32:35], v[144:147]
    s_add_u32 s66, s88, s54
    s_addc_u32 s67, s89, 0
    v_mfma_f32_16x16x32_bf16 v[160:163], a[144:147], v[32:35], v[160:163]
    ds_read_b64_tr_b16 a[136:137], v89 offset:32768
    s_lshl_b32 s54, s56, 1
    v_mfma_f32_16x16x32_bf16 v[160:163], a[148:151], v[36:39], v[160:163]
    buffer_load_dwordx4 v107, s[20:23], s46 offen offset:3072 lds
    v_mfma_f32_16x16x32_bf16 v[164:167], a[148:151], v[44:47], v[164:167]
    ds_read_b64_tr_b16 a[138:139], v89 offset:33792
    s_add_u32 m0, s51, 65536
    v_mfma_f32_16x16x32_bf16 v[164:167], a[144:147], v[40:43], v[164:167]
    s_add_u32 s54, s54, s7
    s_lshl_b32 s54, s54, 7
    v_mfma_f32_16x16x32_bf16 v[168:171], a[144:147], v[48:51], v[168:171]
    ds_read_b64_tr_b16 a[140:141], v89 offset:40960
    s_lshl_b32 s6, s6, 3
    v_mfma_f32_16x16x32_bf16 v[168:171], a[148:151], v[52:55], v[168:171]
    buffer_load_dwordx4 v108, s[24:27], s47 offen offset:0 lds
    v_mfma_f32_16x16x32_bf16 v[172:175], a[148:151], v[60:63], v[172:175]
    ds_read_b64_tr_b16 a[142:143], v89 offset:41984
    s_add_u32 s6, s6, s54
    v_mfma_f32_16x16x32_bf16 v[172:175], a[144:147], v[56:59], v[172:175]
    s_add_u32 s36, s80, s6
    s_addc_u32 s37, s81, 0
    v_mfma_f32_16x16x32_bf16 v[188:191], a[152:155], v[56:59], v[188:191]
    ds_read_b64_tr_b16 a[144:145], v90 offset:32768
    s_sub_u32 s38, 1409024, s6
    v_mfma_f32_16x16x32_bf16 v[188:191], a[156:159], v[60:63], v[188:191]
    buffer_load_dwordx4 v109, s[24:27], s47 offen offset:1024 lds
    v_mfma_f32_16x16x32_bf16 v[184:187], a[156:159], v[52:55], v[184:187]
    ds_read_b64_tr_b16 a[146:147], v90 offset:33792
    s_mov_b32 s39, 0x00020000
    v_mfma_f32_16x16x32_bf16 v[184:187], a[152:155], v[48:51], v[184:187]
    s_lshl_b32 s7, s74, 20
    s_add_u32 s6, s6, s7
    v_mfma_f32_16x16x32_bf16 v[180:183], a[152:155], v[40:43], v[180:183]
    ds_read_b64_tr_b16 a[148:149], v90 offset:40960
    v_mfma_f32_16x16x32_bf16 v[180:183], a[156:159], v[44:47], v[180:183]
    buffer_load_dwordx4 v110, s[24:27], s47 offen offset:2048 lds
    v_mfma_f32_16x16x32_bf16 v[176:179], a[156:159], v[36:39], v[176:179]
    ds_read_b64_tr_b16 a[150:151], v90 offset:41984
    s_waitcnt vmcnt(7)
    v_mfma_f32_16x16x32_bf16 v[176:179], a[152:155], v[32:35], v[176:179]
    ds_read_b128 v[0:3], v112 offset:0
    v_mfma_f32_16x16x32_bf16 v[192:195], a[160:163], v[32:35], v[192:195]
    ds_read_b64_tr_b16 a[152:153], v91 offset:32768
    v_mfma_f32_16x16x32_bf16 v[192:195], a[164:167], v[36:39], v[192:195]
    buffer_load_dwordx4 v111, s[24:27], s47 offen offset:3072 lds
    v_mfma_f32_16x16x32_bf16 v[196:199], a[164:167], v[44:47], v[196:199]
    ds_read_b64_tr_b16 a[154:155], v91 offset:33792
    s_add_u32 s46, s46, 524288
    v_mfma_f32_16x16x32_bf16 v[196:199], a[160:163], v[40:43], v[196:199]
    s_and_b32 s46, s46, 4194303
    s_lshr_b32 s47, s46, 19
    v_mfma_f32_16x16x32_bf16 v[200:203], a[160:163], v[48:51], v[200:203]
    ds_read_b64_tr_b16 a[156:157], v91 offset:40960
    s_mul_i32 s47, s47, 176128
    v_mfma_f32_16x16x32_bf16 v[200:203], a[164:167], v[52:55], v[200:203]
    buffer_store_dword v81, v82, s[88:91], s63 offen sc1
    v_mfma_f32_16x16x32_bf16 v[204:207], a[164:167], v[60:63], v[204:207]
    ds_read_b64_tr_b16 a[158:159], v91 offset:41984
    ds_read_b128 v[4:7], v113 offset:0
    v_mfma_f32_16x16x32_bf16 v[204:207], a[160:163], v[56:59], v[204:207]
    s_add_u32 s32, s72, s6
    s_addc_u32 s33, s73, 0
    v_mfma_f32_16x16x32_bf16 v[220:223], a[168:171], v[56:59], v[220:223]
    ds_read_b64_tr_b16 a[160:161], v92 offset:32768
    s_add_u32 m0, s49, 32768
    v_mfma_f32_16x16x32_bf16 v[220:223], a[172:175], v[60:63], v[220:223]
    buffer_load_dwordx4 v100, s[16:19], s44 offen offset:0 lds
    v_mfma_f32_16x16x32_bf16 v[216:219], a[172:175], v[52:55], v[216:219]
    ds_read_b64_tr_b16 a[162:163], v92 offset:33792
    ds_read_b128 v[8:11], v112 offset:2048
    v_mfma_f32_16x16x32_bf16 v[216:219], a[168:171], v[48:51], v[216:219]
    s_sub_u32 s34, 4194304, s6
    s_mov_b32 s35, 0x00020000
    v_mfma_f32_16x16x32_bf16 v[212:215], a[168:171], v[40:43], v[212:215]
    ds_read_b64_tr_b16 a[164:165], v92 offset:40960
    ds_read_b128 v[12:15], v113 offset:2048
    v_mfma_f32_16x16x32_bf16 v[212:215], a[172:175], v[44:47], v[212:215]
    buffer_load_dwordx4 v101, s[16:19], s44 offen offset:1024 lds
    v_mfma_f32_16x16x32_bf16 v[208:211], a[172:175], v[36:39], v[208:211]
    ds_read_b64_tr_b16 a[166:167], v92 offset:41984
    ds_read_b128 v[16:19], v112 offset:4096
    v_mfma_f32_16x16x32_bf16 v[208:211], a[168:171], v[32:35], v[208:211]
    s_lshl_b32 s7, s79, 1
    s_lshr_b32 s6, s3, 1
    v_mfma_f32_16x16x32_bf16 v[224:227], a[176:179], v[32:35], v[224:227]
    ds_read_b64_tr_b16 a[168:169], v93 offset:32768
    ds_read_b128 v[20:23], v113 offset:4096
    v_mfma_f32_16x16x32_bf16 v[224:227], a[180:183], v[36:39], v[224:227]
    buffer_load_dwordx4 v102, s[16:19], s44 offen offset:2048 lds
    v_mfma_f32_16x16x32_bf16 v[228:231], a[180:183], v[44:47], v[228:231]
    ds_read_b64_tr_b16 a[170:171], v93 offset:33792
    ds_read_b128 v[24:27], v112 offset:6144
    v_mfma_f32_16x16x32_bf16 v[228:231], a[176:179], v[40:43], v[228:231]
    s_add_u32 s7, s7, s6
    s_lshl_b32 s7, s7, 2
    v_mfma_f32_16x16x32_bf16 v[232:235], a[176:179], v[48:51], v[232:235]
    ds_read_b64_tr_b16 a[172:173], v93 offset:40960
    ds_read_b128 v[28:31], v113 offset:6144
    v_mfma_f32_16x16x32_bf16 v[232:235], a[180:183], v[52:55], v[232:235]
    buffer_load_dwordx4 v103, s[16:19], s44 offen offset:3072 lds
    v_mfma_f32_16x16x32_bf16 v[236:239], a[180:183], v[60:63], v[236:239]
    ds_read_b64_tr_b16 a[174:175], v93 offset:41984
    s_add_u32 m0, s49, 36864
    v_mfma_f32_16x16x32_bf16 v[236:239], a[176:179], v[56:59], v[236:239]
    s_add_u32 s7, s7, s74
    s_lshl_b32 s7, s7, 14
    v_mfma_f32_16x16x32_bf16 v[252:255], a[184:187], v[56:59], v[252:255]
    ds_read_b64_tr_b16 a[176:177], v94 offset:32768
    s_add_u32 s76, s7, s54
    v_mfma_f32_16x16x32_bf16 v[252:255], a[188:191], v[60:63], v[252:255]
    buffer_load_dwordx4 v100, s[16:19], s45 offen offset:0 lds
    v_mfma_f32_16x16x32_bf16 v[248:251], a[188:191], v[52:55], v[248:251]
    ds_read_b64_tr_b16 a[178:179], v94 offset:33792
    s_movk_i32 s77, 16384
    v_mfma_f32_16x16x32_bf16 v[248:251], a[184:187], v[48:51], v[248:251]
    s_lshr_b32 s78, s79, 1
    s_lshl_b32 s6, s5, 2
    v_mfma_f32_16x16x32_bf16 v[244:247], a[184:187], v[40:43], v[244:247]
    ds_read_b64_tr_b16 a[180:181], v94 offset:40960
    s_add_u32 s6, s6, s3
    v_mfma_f32_16x16x32_bf16 v[244:247], a[188:191], v[44:47], v[244:247]
    buffer_load_dwordx4 v101, s[16:19], s45 offen offset:1024 lds
    v_mfma_f32_16x16x32_bf16 v[240:243], a[188:191], v[36:39], v[240:243]
    ds_read_b64_tr_b16 a[182:183], v94 offset:41984
    s_lshl_b32 s93, s6, 9
    v_mfma_f32_16x16x32_bf16 v[240:243], a[184:187], v[32:35], v[240:243]
    s_add_u32 s93, s93, 148897792
    s_mul_i32 s7, s6, 700416
    v_mfma_f32_16x16x32_bf16 a[0:3], a[192:195], v[32:35], a[0:3]
    ds_read_b64_tr_b16 a[184:185], v95 offset:32768
    s_add_u32 s7, s7, 125829120
    v_mfma_f32_16x16x32_bf16 a[0:3], a[196:199], v[36:39], a[0:3]
    buffer_load_dwordx4 v102, s[16:19], s45 offen offset:2048 lds
    v_mfma_f32_16x16x32_bf16 a[24:27], a[196:199], v[44:47], a[24:27]
    ds_read_b64_tr_b16 a[186:187], v95 offset:33792
    v_mfma_f32_16x16x32_bf16 a[24:27], a[192:195], v[40:43], a[24:27]
    s_add_u32 s28, s88, s7
    s_addc_u32 s29, s89, 0
    v_mfma_f32_16x16x32_bf16 a[48:51], a[192:195], v[48:51], a[48:51]
    ds_read_b64_tr_b16 a[188:189], v95 offset:40960
    s_mov_b32 s30, 700416
    v_mfma_f32_16x16x32_bf16 a[48:51], a[196:199], v[52:55], a[48:51]
    buffer_load_dwordx4 v103, s[16:19], s45 offen offset:3072 lds
    v_mfma_f32_16x16x32_bf16 a[72:75], a[196:199], v[60:63], a[72:75]
    ds_read_b64_tr_b16 a[190:191], v95 offset:41984
    s_add_u32 s44, s44, 128
    v_mfma_f32_16x16x32_bf16 a[72:75], a[192:195], v[56:59], a[72:75]
    s_and_b32 s44, s44, 1023
    s_add_u32 s45, s44, 32768
    v_mfma_f32_16x16x32_bf16 a[76:79], a[200:203], v[56:59], a[76:79]
    ds_read_b64_tr_b16 a[192:193], v116 offset:32768
    s_mov_b32 s31, 0x00020000
    v_mfma_f32_16x16x32_bf16 a[76:79], a[204:207], v[60:63], a[76:79]
    s_add_u32 s53, s49, 131072
    v_and_b32 v83, 15, v126
    v_mfma_f32_16x16x32_bf16 a[52:55], a[204:207], v[52:55], a[52:55]
    ds_read_b64_tr_b16 a[194:195], v116 offset:33152
    v_lshrrev_b32 v84, 4, v126
    v_mfma_f32_16x16x32_bf16 a[52:55], a[200:203], v[48:51], a[52:55]
    s_lshl_b32 s6, s3, 4
    v_add_u32 v85, s6, v84
    v_mfma_f32_16x16x32_bf16 a[28:31], a[200:203], v[40:43], a[28:31]
    ds_read_b64_tr_b16 a[196:197], v116 offset:36864
    v_lshlrev_b32 v85, 8, v85
    v_mfma_f32_16x16x32_bf16 a[28:31], a[204:207], v[44:47], a[28:31]
    v_xor_b32 v86, v83, v84
    v_xor_b32 v87, 0, v86
    v_mfma_f32_16x16x32_bf16 a[4:7], a[204:207], v[36:39], a[4:7]
    ds_read_b64_tr_b16 a[198:199], v116 offset:37248
    v_lshl_add_u32 v120, v87, 4, v85
    v_mfma_f32_16x16x32_bf16 a[4:7], a[200:203], v[32:35], a[4:7]
    v_xor_b32 v87, 4, v86
    v_lshl_add_u32 v121, v87, 4, v85
    v_mfma_f32_16x16x32_bf16 a[8:11], a[208:211], v[32:35], a[8:11]
    ds_read_b64_tr_b16 a[200:201], v116 offset:32800
    v_xor_b32 v87, 8, v86
    v_mfma_f32_16x16x32_bf16 a[8:11], a[212:215], v[36:39], a[8:11]
    v_lshl_add_u32 v122, v87, 4, v85
    v_xor_b32 v87, 12, v86
    v_mfma_f32_16x16x32_bf16 a[32:35], a[212:215], v[44:47], a[32:35]
    ds_read_b64_tr_b16 a[202:203], v116 offset:33184
    v_lshl_add_u32 v123, v87, 4, v85
    v_mfma_f32_16x16x32_bf16 a[32:35], a[208:211], v[40:43], a[32:35]
    v_lshlrev_b32 v86, 1, v84
    v_xor_b32 v86, v86, v83
    v_mfma_f32_16x16x32_bf16 a[56:59], a[208:211], v[48:51], a[56:59]
    ds_read_b64_tr_b16 a[204:205], v116 offset:36896
    v_xor_b32 v87, 0, v86
    v_mfma_f32_16x16x32_bf16 a[56:59], a[212:215], v[52:55], a[56:59]
    v_lshl_add_u32 v124, v87, 4, v85
    v_xor_b32 v87, 8, v86
    v_mfma_f32_16x16x32_bf16 a[80:83], a[212:215], v[60:63], a[80:83]
    ds_read_b64_tr_b16 a[206:207], v116 offset:37280
    v_lshl_add_u32 v125, v87, 4, v85
    v_mfma_f32_16x16x32_bf16 a[80:83], a[208:211], v[56:59], a[80:83]
    s_mov_b32 s48, 0
    s_mov_b32 s43, 0
    v_mfma_f32_16x16x32_bf16 a[84:87], a[216:219], v[56:59], a[84:87]
    ds_read_b64_tr_b16 a[208:209], v127 offset:32768
    s_movk_i32 s58, 16384
    v_mfma_f32_16x16x32_bf16 a[84:87], a[220:223], v[60:63], a[84:87]
    s_mov_b32 s55, 0xffff0000
    s_mov_b32 s59, 0
    v_mfma_f32_16x16x32_bf16 a[60:63], a[220:223], v[52:55], a[60:63]
    ds_read_b64_tr_b16 a[210:211], v127 offset:33152
    s_mul_i32 s6, s4, 3
    v_mfma_f32_16x16x32_bf16 a[60:63], a[216:219], v[48:51], a[60:63]
    s_and_b32 s7, s4, 1
    s_add_u32 s60, s6, s7
    v_mfma_f32_16x16x32_bf16 a[36:39], a[216:219], v[40:43], a[36:39]
    ds_read_b64_tr_b16 a[212:213], v127 offset:36864
    s_lshr_b32 s60, s60, 1
    v_mfma_f32_16x16x32_bf16 a[36:39], a[220:223], v[44:47], a[36:39]
    s_add_u32 s60, s60, 128
    s_lshl_b32 s60, s60, 12
    v_mfma_f32_16x16x32_bf16 a[12:15], a[220:223], v[36:39], a[12:15]
    ds_read_b64_tr_b16 a[214:215], v127 offset:37248
    s_add_u32 s6, s6, 2
    v_mfma_f32_16x16x32_bf16 a[12:15], a[216:219], v[32:35], a[12:15]
    s_lshl_b32 s7, s7, 1
    s_sub_u32 s6, s6, s7
    v_mfma_f32_16x16x32_bf16 a[16:19], a[224:227], v[32:35], a[16:19]
    ds_read_b64_tr_b16 a[216:217], v116 offset:40960
    s_lshr_b32 s61, s6, 1
    v_mfma_f32_16x16x32_bf16 a[16:19], a[228:231], v[36:39], a[16:19]
    s_add_u32 s61, s61, 128
    s_lshl_b32 s61, s61, 12
    v_mfma_f32_16x16x32_bf16 a[40:43], a[228:231], v[44:47], a[40:43]
    ds_read_b64_tr_b16 a[218:219], v116 offset:41344
    s_and_b32 s6, s6, 1
    v_mfma_f32_16x16x32_bf16 a[40:43], a[224:227], v[40:43], a[40:43]
    s_lshl_b32 s6, s6, 3
    s_add_u32 s61, s61, s6
    v_mfma_f32_16x16x32_bf16 a[64:67], a[224:227], v[48:51], a[64:67]
    ds_read_b64_tr_b16 a[220:221], v116 offset:45056
    v_mfma_f32_16x16x32_bf16 a[64:67], a[228:231], v[52:55], a[64:67]
    v_mfma_f32_16x16x32_bf16 a[88:91], a[228:231], v[60:63], a[88:91]
    ds_read_b64_tr_b16 a[222:223], v116 offset:45440
    v_mfma_f32_16x16x32_bf16 a[88:91], a[224:227], v[56:59], a[88:91]
    v_mfma_f32_16x16x32_bf16 a[92:95], a[232:235], v[56:59], a[92:95]
    ds_read_b64_tr_b16 a[224:225], v116 offset:40992
    v_mfma_f32_16x16x32_bf16 a[92:95], a[236:239], v[60:63], a[92:95]
    v_mfma_f32_16x16x32_bf16 a[68:71], a[236:239], v[52:55], a[68:71]
    ds_read_b64_tr_b16 a[226:227], v116 offset:41376
    v_mfma_f32_16x16x32_bf16 a[68:71], a[232:235], v[48:51], a[68:71]
    v_mfma_f32_16x16x32_bf16 a[44:47], a[232:235], v[40:43], a[44:47]
    ds_read_b64_tr_b16 a[228:229], v116 offset:45088
    v_mfma_f32_16x16x32_bf16 a[44:47], a[236:239], v[44:47], a[44:47]
    v_mfma_f32_16x16x32_bf16 a[20:23], a[236:239], v[36:39], a[20:23]
    ds_read_b64_tr_b16 a[230:231], v116 offset:45472
    v_mfma_f32_16x16x32_bf16 a[20:23], a[232:235], v[32:35], a[20:23]
    s_waitcnt lgkmcnt(4)
    v_mfma_f32_16x16x32_bf16 v[128:131], a[128:131], v[0:3], v[128:131]
    ds_read_b64_tr_b16 a[232:233], v127 offset:40960
    ds_read_b64_tr_b16 a[234:235], v127 offset:41344
    v_mfma_f32_16x16x32_bf16 v[128:131], a[132:135], v[4:7], v[128:131]
    ds_read_b64_tr_b16 a[236:237], v127 offset:45056
    ds_read_b64_tr_b16 a[238:239], v127 offset:45440
    v_mfma_f32_16x16x32_bf16 v[132:135], a[132:135], v[12:15], v[132:135]
    v_add_u32 v88, 0x10000, v88
    v_add_u32 v89, 0x10000, v89
    v_mfma_f32_16x16x32_bf16 v[132:135], a[128:131], v[8:11], v[132:135]
    v_add_u32 v90, 0x10000, v90
    v_add_u32 v91, 0x10000, v91
    v_mfma_f32_16x16x32_bf16 v[136:139], a[128:131], v[16:19], v[136:139]
    v_add_u32 v92, 0x10000, v92
    v_add_u32 v93, 0x10000, v93
    v_mfma_f32_16x16x32_bf16 v[136:139], a[132:135], v[20:23], v[136:139]
    v_add_u32 v94, 0x10000, v94
    v_add_u32 v95, 0x10000, v95
    v_mfma_f32_16x16x32_bf16 v[140:143], a[132:135], v[28:31], v[140:143]
    v_add_u32 v116, 0x10000, v116
    v_add_u32 v127, 0x10000, v127
    v_mfma_f32_16x16x32_bf16 v[140:143], a[128:131], v[24:27], v[140:143]
    s_waitcnt vmcnt(9) lgkmcnt(0)
    s_barrier
    v_mfma_f32_16x16x32_bf16 v[156:159], a[136:139], v[24:27], v[156:159]
    ds_read_b64_tr_b16 a[128:129], v88 offset:0
    s_add_u32 m0, s50, 0
    v_mfma_f32_16x16x32_bf16 v[156:159], a[140:143], v[28:31], v[156:159]
    buffer_load_dwordx4 v104, s[20:23], s46 offen offset:0 lds
    v_mfma_f32_16x16x32_bf16 v[152:155], a[140:143], v[20:23], v[152:155]
    ds_read_b64_tr_b16 a[130:131], v88 offset:1024
    v_mfma_f32_16x16x32_bf16 v[152:155], a[136:139], v[16:19], v[152:155]
    v_mfma_f32_16x16x32_bf16 v[148:151], a[136:139], v[8:11], v[148:151]
    ds_read_b64_tr_b16 a[132:133], v88 offset:8192
    v_mfma_f32_16x16x32_bf16 v[148:151], a[140:143], v[12:15], v[148:151]
    buffer_load_dwordx4 v105, s[20:23], s46 offen offset:1024 lds
    v_mfma_f32_16x16x32_bf16 v[144:147], a[140:143], v[4:7], v[144:147]
    ds_read_b64_tr_b16 a[134:135], v88 offset:9216
    v_mfma_f32_16x16x32_bf16 v[144:147], a[136:139], v[0:3], v[144:147]
    v_mfma_f32_16x16x32_bf16 v[160:163], a[144:147], v[0:3], v[160:163]
    ds_read_b64_tr_b16 a[136:137], v89 offset:0
    v_mfma_f32_16x16x32_bf16 v[160:163], a[148:151], v[4:7], v[160:163]
    buffer_load_dwordx4 v106, s[20:23], s46 offen offset:2048 lds
    v_mfma_f32_16x16x32_bf16 v[164:167], a[148:151], v[12:15], v[164:167]
    ds_read_b64_tr_b16 a[138:139], v89 offset:1024
    v_mfma_f32_16x16x32_bf16 v[164:167], a[144:147], v[8:11], v[164:167]
    v_mfma_f32_16x16x32_bf16 v[168:171], a[144:147], v[16:19], v[168:171]
    ds_read_b64_tr_b16 a[140:141], v89 offset:8192
    v_mfma_f32_16x16x32_bf16 v[168:171], a[148:151], v[20:23], v[168:171]
    buffer_load_dwordx4 v107, s[20:23], s46 offen offset:3072 lds
    v_mfma_f32_16x16x32_bf16 v[172:175], a[148:151], v[28:31], v[172:175]
    ds_read_b64_tr_b16 a[142:143], v89 offset:9216
    s_add_u32 m0, s51, 0
    v_mfma_f32_16x16x32_bf16 v[172:175], a[144:147], v[24:27], v[172:175]
    v_mfma_f32_16x16x32_bf16 v[188:191], a[152:155], v[24:27], v[188:191]
    ds_read_b64_tr_b16 a[144:145], v90 offset:0
    v_mfma_f32_16x16x32_bf16 v[188:191], a[156:159], v[28:31], v[188:191]
    buffer_load_dwordx4 v108, s[24:27], s47 offen offset:0 lds
    v_mfma_f32_16x16x32_bf16 v[184:187], a[156:159], v[20:23], v[184:187]
    ds_read_b64_tr_b16 a[146:147], v90 offset:1024
    v_mfma_f32_16x16x32_bf16 v[184:187], a[152:155], v[16:19], v[184:187]
    v_mfma_f32_16x16x32_bf16 v[180:183], a[152:155], v[8:11], v[180:183]
    ds_read_b64_tr_b16 a[148:149], v90 offset:8192
    v_mfma_f32_16x16x32_bf16 v[180:183], a[156:159], v[12:15], v[180:183]
    buffer_load_dwordx4 v109, s[24:27], s47 offen offset:1024 lds
    v_mfma_f32_16x16x32_bf16 v[176:179], a[156:159], v[4:7], v[176:179]
    ds_read_b64_tr_b16 a[150:151], v90 offset:9216
    s_waitcnt vmcnt(6)
    v_mfma_f32_16x16x32_bf16 v[176:179], a[152:155], v[0:3], v[176:179]
    ds_read_b128 v[32:35], v112 offset:32768
    v_mfma_f32_16x16x32_bf16 v[192:195], a[160:163], v[0:3], v[192:195]
    ds_read_b64_tr_b16 a[152:153], v91 offset:0
    v_mfma_f32_16x16x32_bf16 v[192:195], a[164:167], v[4:7], v[192:195]
    buffer_load_dwordx4 v110, s[24:27], s47 offen offset:2048 lds
    v_mfma_f32_16x16x32_bf16 v[196:199], a[164:167], v[12:15], v[196:199]
    ds_read_b64_tr_b16 a[154:155], v91 offset:1024
    ds_read_b128 v[36:39], v113 offset:32768
    v_mfma_f32_16x16x32_bf16 v[196:199], a[160:163], v[8:11], v[196:199]
    v_mfma_f32_16x16x32_bf16 v[200:203], a[160:163], v[16:19], v[200:203]
    ds_read_b64_tr_b16 a[156:157], v91 offset:8192
    ds_read_b128 v[40:43], v112 offset:34816
    v_mfma_f32_16x16x32_bf16 v[200:203], a[164:167], v[20:23], v[200:203]
    buffer_load_dwordx4 v111, s[24:27], s47 offen offset:3072 lds
    v_mfma_f32_16x16x32_bf16 v[204:207], a[164:167], v[28:31], v[204:207]
    ds_read_b64_tr_b16 a[158:159], v91 offset:9216
    s_add_u32 s46, s46, 524288
    v_mfma_f32_16x16x32_bf16 v[204:207], a[160:163], v[24:27], v[204:207]
    s_and_b32 s46, s46, 4194303
    s_lshr_b32 s47, s46, 19
    v_mfma_f32_16x16x32_bf16 v[220:223], a[168:171], v[24:27], v[220:223]
    ds_read_b64_tr_b16 a[160:161], v92 offset:0
    s_mul_i32 s47, s47, 176128
    v_mfma_f32_16x16x32_bf16 v[220:223], a[172:175], v[28:31], v[220:223]
    s_add_u32 m0, s49, 0
    ds_read_b128 v[44:47], v113 offset:34816
    v_mfma_f32_16x16x32_bf16 v[216:219], a[172:175], v[20:23], v[216:219]
    ds_read_b64_tr_b16 a[162:163], v92 offset:1024
    v_mfma_f32_16x16x32_bf16 v[216:219], a[168:171], v[16:19], v[216:219]
    buffer_load_dwordx4 v100, s[16:19], s44 offen offset:0 lds
    v_mfma_f32_16x16x32_bf16 v[212:215], a[168:171], v[8:11], v[212:215]
    ds_read_b64_tr_b16 a[164:165], v92 offset:8192
    ds_read_b128 v[48:51], v112 offset:36864
    v_mfma_f32_16x16x32_bf16 v[212:215], a[172:175], v[12:15], v[212:215]
    v_mfma_f32_16x16x32_bf16 v[208:211], a[172:175], v[4:7], v[208:211]
    ds_read_b64_tr_b16 a[166:167], v92 offset:9216
    ds_read_b128 v[52:55], v113 offset:36864
    v_mfma_f32_16x16x32_bf16 v[208:211], a[168:171], v[0:3], v[208:211]
    buffer_load_dwordx4 v101, s[16:19], s44 offen offset:1024 lds
    v_mfma_f32_16x16x32_bf16 v[224:227], a[176:179], v[0:3], v[224:227]
    ds_read_b64_tr_b16 a[168:169], v93 offset:0
    ds_read_b128 v[56:59], v112 offset:38912
    v_mfma_f32_16x16x32_bf16 v[224:227], a[180:183], v[4:7], v[224:227]
    v_mfma_f32_16x16x32_bf16 v[228:231], a[180:183], v[12:15], v[228:231]
    ds_read_b64_tr_b16 a[170:171], v93 offset:1024
    ds_read_b128 v[60:63], v113 offset:38912
    v_mfma_f32_16x16x32_bf16 v[228:231], a[176:179], v[8:11], v[228:231]
    buffer_load_dwordx4 v102, s[16:19], s44 offen offset:2048 lds
    v_mfma_f32_16x16x32_bf16 v[232:235], a[176:179], v[16:19], v[232:235]
    ds_read_b64_tr_b16 a[172:173], v93 offset:8192
    v_mfma_f32_16x16x32_bf16 v[232:235], a[180:183], v[20:23], v[232:235]
    v_mfma_f32_16x16x32_bf16 v[236:239], a[180:183], v[28:31], v[236:239]
    ds_read_b64_tr_b16 a[174:175], v93 offset:9216
    v_mfma_f32_16x16x32_bf16 v[236:239], a[176:179], v[24:27], v[236:239]
    buffer_load_dwordx4 v103, s[16:19], s44 offen offset:3072 lds
    v_mfma_f32_16x16x32_bf16 v[252:255], a[184:187], v[24:27], v[252:255]
    ds_read_b64_tr_b16 a[176:177], v94 offset:0
    s_add_u32 m0, s49, 4096
    v_mfma_f32_16x16x32_bf16 v[252:255], a[188:191], v[28:31], v[252:255]
    v_mfma_f32_16x16x32_bf16 v[248:251], a[188:191], v[20:23], v[248:251]
    ds_read_b64_tr_b16 a[178:179], v94 offset:1024
    v_mfma_f32_16x16x32_bf16 v[248:251], a[184:187], v[16:19], v[248:251]
    buffer_load_dwordx4 v100, s[16:19], s45 offen offset:0 lds
    v_mfma_f32_16x16x32_bf16 v[244:247], a[184:187], v[8:11], v[244:247]
    ds_read_b64_tr_b16 a[180:181], v94 offset:8192
    v_mfma_f32_16x16x32_bf16 v[244:247], a[188:191], v[12:15], v[244:247]
    v_mfma_f32_16x16x32_bf16 v[240:243], a[188:191], v[4:7], v[240:243]
    ds_read_b64_tr_b16 a[182:183], v94 offset:9216
    v_mfma_f32_16x16x32_bf16 v[240:243], a[184:187], v[0:3], v[240:243]
    buffer_load_dwordx4 v101, s[16:19], s45 offen offset:1024 lds
    v_mfma_f32_16x16x32_bf16 a[0:3], a[192:195], v[0:3], a[0:3]
    ds_read_b64_tr_b16 a[184:185], v95 offset:0
    v_mfma_f32_16x16x32_bf16 a[0:3], a[196:199], v[4:7], a[0:3]
    v_mfma_f32_16x16x32_bf16 a[24:27], a[196:199], v[12:15], a[24:27]
    ds_read_b64_tr_b16 a[186:187], v95 offset:1024
    v_mfma_f32_16x16x32_bf16 a[24:27], a[192:195], v[8:11], a[24:27]
    buffer_load_dwordx4 v102, s[16:19], s45 offen offset:2048 lds
    v_mfma_f32_16x16x32_bf16 a[48:51], a[192:195], v[16:19], a[48:51]
    ds_read_b64_tr_b16 a[188:189], v95 offset:8192
    v_mfma_f32_16x16x32_bf16 a[48:51], a[196:199], v[20:23], a[48:51]
    v_mfma_f32_16x16x32_bf16 a[72:75], a[196:199], v[28:31], a[72:75]
    ds_read_b64_tr_b16 a[190:191], v95 offset:9216
    v_cmp_gt_u32 vcc, 32, v126
    v_mfma_f32_16x16x32_bf16 a[72:75], a[192:195], v[24:27], a[72:75]
    buffer_load_dwordx4 v103, s[16:19], s45 offen offset:3072 lds
    v_mfma_f32_16x16x32_bf16 a[76:79], a[200:203], v[24:27], a[76:79]
    ds_read_b64_tr_b16 a[192:193], v116 offset:0
    s_add_u32 s44, s44, 128
    v_mfma_f32_16x16x32_bf16 a[76:79], a[204:207], v[28:31], a[76:79]
    s_and_b32 s44, s44, 1023
    s_add_u32 s45, s44, 32768
    v_mfma_f32_16x16x32_bf16 a[52:55], a[204:207], v[20:23], a[52:55]
    ds_read_b64_tr_b16 a[194:195], v116 offset:384
    v_and_b32 v114, 7, v126
    v_mfma_f32_16x16x32_bf16 a[52:55], a[200:203], v[16:19], a[52:55]
    v_mov_b32 v86, s4
    v_and_b32 v87, 7, v126
    v_mfma_f32_16x16x32_bf16 a[28:31], a[200:203], v[8:11], a[28:31]
    ds_read_b64_tr_b16 a[196:197], v116 offset:4096
    v_lshl_add_u32 v114, s3, 3, v114
    v_mfma_f32_16x16x32_bf16 a[28:31], a[204:207], v[12:15], a[28:31]
    v_mov_b32 v78, s5
    v_cndmask_b32 v86, v86, v114, vcc
    v_mfma_f32_16x16x32_bf16 a[4:7], a[204:207], v[4:7], a[4:7]
    ds_read_b64_tr_b16 a[198:199], v116 offset:4480
    v_cndmask_b32 v87, v87, v78, vcc
    v_mfma_f32_16x16x32_bf16 a[4:7], a[200:203], v[0:3], a[4:7]
    v_and_b32 v114, 3, v86
    v_lshl_add_u32 v114, v87, 2, v114
    v_mfma_f32_16x16x32_bf16 a[8:11], a[208:211], v[0:3], a[8:11]
    ds_read_b64_tr_b16 a[200:201], v116 offset:32
    v_lshrrev_b32 v78, 2, v86
    v_mfma_f32_16x16x32_bf16 a[8:11], a[212:215], v[4:7], a[8:11]
    v_lshl_add_u32 v78, v114, 3, v78
    v_lshlrev_b32 v78, 7, v78
    v_mfma_f32_16x16x32_bf16 a[32:35], a[212:215], v[12:15], a[32:35]
    ds_read_b64_tr_b16 a[202:203], v116 offset:416
    v_add_u32 v78, 149946368, v78
    v_mfma_f32_16x16x32_bf16 a[32:35], a[208:211], v[8:11], a[32:35]
    buffer_load_dword v114, v78, s[88:91], 0 offen offset:0 sc1
    v_mfma_f32_16x16x32_bf16 a[56:59], a[208:211], v[16:19], a[56:59]
    ds_read_b64_tr_b16 a[204:205], v116 offset:4128
    v_and_b32 v117, 15, v126
    v_mfma_f32_16x16x32_bf16 a[56:59], a[212:215], v[20:23], a[56:59]
    v_lshrrev_b32 v115, 4, v126
    v_lshlrev_b32 v115, 10, v115
    v_mfma_f32_16x16x32_bf16 a[80:83], a[212:215], v[28:31], a[80:83]
    ds_read_b64_tr_b16 a[206:207], v116 offset:4512
    v_lshl_add_u32 v115, v117, 4, v115
    v_mfma_f32_16x16x32_bf16 a[80:83], a[208:211], v[24:27], a[80:83]
    v_lshlrev_b32 v117, 3, v117
    s_lshl_b32 s6, s4, 13
    v_mfma_f32_16x16x32_bf16 a[84:87], a[216:219], v[24:27], a[84:87]
    ds_read_b64_tr_b16 a[208:209], v127 offset:0
    s_lshl_b32 s7, s3, 8
    v_mfma_f32_16x16x32_bf16 a[84:87], a[220:223], v[28:31], a[84:87]
    s_add_u32 s6, s6, s7
    s_add_u32 s71, s6, 148963328
    v_mfma_f32_16x16x32_bf16 a[60:63], a[220:223], v[20:23], a[60:63]
    ds_read_b64_tr_b16 a[210:211], v127 offset:384
    v_mfma_f32_16x16x32_bf16 a[60:63], a[216:219], v[16:19], a[60:63]
    v_mfma_f32_16x16x32_bf16 a[36:39], a[216:219], v[8:11], a[36:39]
    ds_read_b64_tr_b16 a[212:213], v127 offset:4096
    v_mfma_f32_16x16x32_bf16 a[36:39], a[220:223], v[12:15], a[36:39]
    v_mfma_f32_16x16x32_bf16 a[12:15], a[220:223], v[4:7], a[12:15]
    ds_read_b64_tr_b16 a[214:215], v127 offset:4480
    v_mfma_f32_16x16x32_bf16 a[12:15], a[216:219], v[0:3], a[12:15]
    v_mfma_f32_16x16x32_bf16 a[16:19], a[224:227], v[0:3], a[16:19]
    ds_read_b64_tr_b16 a[216:217], v116 offset:8192
    v_mfma_f32_16x16x32_bf16 a[16:19], a[228:231], v[4:7], a[16:19]
    v_mfma_f32_16x16x32_bf16 a[40:43], a[228:231], v[12:15], a[40:43]
    ds_read_b64_tr_b16 a[218:219], v116 offset:8576
    v_mfma_f32_16x16x32_bf16 a[40:43], a[224:227], v[8:11], a[40:43]
    v_mfma_f32_16x16x32_bf16 a[64:67], a[224:227], v[16:19], a[64:67]
    ds_read_b64_tr_b16 a[220:221], v116 offset:12288
    v_mfma_f32_16x16x32_bf16 a[64:67], a[228:231], v[20:23], a[64:67]
    v_mfma_f32_16x16x32_bf16 a[88:91], a[228:231], v[28:31], a[88:91]
    ds_read_b64_tr_b16 a[222:223], v116 offset:12672
    v_mfma_f32_16x16x32_bf16 a[88:91], a[224:227], v[24:27], a[88:91]
    v_mfma_f32_16x16x32_bf16 a[92:95], a[232:235], v[24:27], a[92:95]
    ds_read_b64_tr_b16 a[224:225], v116 offset:8224
    v_mfma_f32_16x16x32_bf16 a[92:95], a[236:239], v[28:31], a[92:95]
    v_mfma_f32_16x16x32_bf16 a[68:71], a[236:239], v[20:23], a[68:71]
    ds_read_b64_tr_b16 a[226:227], v116 offset:8608
    v_mfma_f32_16x16x32_bf16 a[68:71], a[232:235], v[16:19], a[68:71]
    v_mfma_f32_16x16x32_bf16 a[44:47], a[232:235], v[8:11], a[44:47]
    ds_read_b64_tr_b16 a[228:229], v116 offset:12320
    v_mfma_f32_16x16x32_bf16 a[44:47], a[236:239], v[12:15], a[44:47]
    v_mfma_f32_16x16x32_bf16 a[20:23], a[236:239], v[4:7], a[20:23]
    ds_read_b64_tr_b16 a[230:231], v116 offset:12704
    v_mfma_f32_16x16x32_bf16 a[20:23], a[232:235], v[0:3], a[20:23]
    s_waitcnt lgkmcnt(4)
    v_mfma_f32_16x16x32_bf16 v[128:131], a[128:131], v[32:35], v[128:131]
    ds_read_b64_tr_b16 a[232:233], v127 offset:8192
    ds_read_b64_tr_b16 a[234:235], v127 offset:8576
    v_mfma_f32_16x16x32_bf16 v[128:131], a[132:135], v[36:39], v[128:131]
    ds_read_b64_tr_b16 a[236:237], v127 offset:12288
    ds_read_b64_tr_b16 a[238:239], v127 offset:12672
    v_mfma_f32_16x16x32_bf16 v[132:135], a[132:135], v[44:47], v[132:135]
    v_subrev_u32 v88, 0x10000, v88
    v_subrev_u32 v89, 0x10000, v89
    v_mfma_f32_16x16x32_bf16 v[132:135], a[128:131], v[40:43], v[132:135]
    v_subrev_u32 v90, 0x10000, v90
    v_subrev_u32 v91, 0x10000, v91
    v_mfma_f32_16x16x32_bf16 v[136:139], a[128:131], v[48:51], v[136:139]
    v_subrev_u32 v92, 0x10000, v92
    v_subrev_u32 v93, 0x10000, v93
    v_mfma_f32_16x16x32_bf16 v[136:139], a[132:135], v[52:55], v[136:139]
    v_subrev_u32 v94, 0x10000, v94
    v_subrev_u32 v95, 0x10000, v95
    v_mfma_f32_16x16x32_bf16 v[140:143], a[132:135], v[60:63], v[140:143]
    v_subrev_u32 v116, 0x10000, v116
    v_subrev_u32 v127, 0x10000, v127
    v_mfma_f32_16x16x32_bf16 v[140:143], a[128:131], v[56:59], v[140:143]
    s_waitcnt vmcnt(0) lgkmcnt(0)
    s_barrier
    v_mfma_f32_16x16x32_bf16 v[156:159], a[136:139], v[56:59], v[156:159]
    ds_read_b64_tr_b16 a[128:129], v88 offset:0
    v_cmp_ne_u32 vcc, s62, v114
    v_mfma_f32_16x16x32_bf16 v[156:159], a[140:143], v[60:63], v[156:159]
    s_cbranch_vccnz K1_D0POLL
K1_D0OK:
    v_mfma_f32_16x16x32_bf16 v[152:155], a[140:143], v[52:55], v[152:155]
    s_add_u32 s54, s71, 4096
    ds_read_b64_tr_b16 a[130:131], v88 offset:1024
    v_mfma_f32_16x16x32_bf16 v[152:155], a[136:139], v[48:51], v[152:155]
    s_add_u32 m0, s50, 32768
    v_mfma_f32_16x16x32_bf16 v[148:151], a[136:139], v[40:43], v[148:151]
    ds_read_b64_tr_b16 a[132:133], v88 offset:8192
    v_mfma_f32_16x16x32_bf16 v[148:151], a[140:143], v[44:47], v[148:151]
    buffer_load_dwordx4 v104, s[20:23], s46 offen offset:0 lds
    v_mfma_f32_16x16x32_bf16 v[144:147], a[140:143], v[36:39], v[144:147]
    ds_read_b64_tr_b16 a[134:135], v88 offset:9216
    v_mfma_f32_16x16x32_bf16 v[144:147], a[136:139], v[32:35], v[144:147]
    v_mfma_f32_16x16x32_bf16 v[160:163], a[144:147], v[32:35], v[160:163]
    ds_read_b64_tr_b16 a[136:137], v89 offset:0
    v_mfma_f32_16x16x32_bf16 v[160:163], a[148:151], v[36:39], v[160:163]
    buffer_load_dwordx4 v105, s[20:23], s46 offen offset:1024 lds
    v_mfma_f32_16x16x32_bf16 v[164:167], a[148:151], v[44:47], v[164:167]
    ds_read_b64_tr_b16 a[138:139], v89 offset:1024
    v_mfma_f32_16x16x32_bf16 v[164:167], a[144:147], v[40:43], v[164:167]
    v_mfma_f32_16x16x32_bf16 v[168:171], a[144:147], v[48:51], v[168:171]
    ds_read_b64_tr_b16 a[140:141], v89 offset:8192
    v_mfma_f32_16x16x32_bf16 v[168:171], a[148:151], v[52:55], v[168:171]
    buffer_load_dwordx4 v106, s[20:23], s46 offen offset:2048 lds
    v_mfma_f32_16x16x32_bf16 v[172:175], a[148:151], v[60:63], v[172:175]
    ds_read_b64_tr_b16 a[142:143], v89 offset:9216
    v_mfma_f32_16x16x32_bf16 v[172:175], a[144:147], v[56:59], v[172:175]
    v_mfma_f32_16x16x32_bf16 v[188:191], a[152:155], v[56:59], v[188:191]
    ds_read_b64_tr_b16 a[144:145], v90 offset:0
    v_mfma_f32_16x16x32_bf16 v[188:191], a[156:159], v[60:63], v[188:191]
    buffer_load_dwordx4 v107, s[20:23], s46 offen offset:3072 lds
    v_mfma_f32_16x16x32_bf16 v[184:187], a[156:159], v[52:55], v[184:187]
    ds_read_b64_tr_b16 a[146:147], v90 offset:1024
    s_add_u32 m0, s51, 32768
    v_mfma_f32_16x16x32_bf16 v[184:187], a[152:155], v[48:51], v[184:187]
    v_mfma_f32_16x16x32_bf16 v[180:183], a[152:155], v[40:43], v[180:183]
    ds_read_b64_tr_b16 a[148:149], v90 offset:8192
    v_mfma_f32_16x16x32_bf16 v[180:183], a[156:159], v[44:47], v[180:183]
    buffer_load_dwordx4 v108, s[24:27], s47 offen offset:0 lds
    v_mfma_f32_16x16x32_bf16 v[176:179], a[156:159], v[36:39], v[176:179]
    ds_read_b64_tr_b16 a[150:151], v90 offset:9216
    s_waitcnt vmcnt(6)
    v_mfma_f32_16x16x32_bf16 v[176:179], a[152:155], v[32:35], v[176:179]
    ds_read_b128 v[0:3], v112 offset:0
    v_mfma_f32_16x16x32_bf16 v[192:195], a[160:163], v[32:35], v[192:195]
    ds_read_b64_tr_b16 a[152:153], v91 offset:0
    v_mfma_f32_16x16x32_bf16 v[192:195], a[164:167], v[36:39], v[192:195]
    buffer_load_dwordx4 v109, s[24:27], s47 offen offset:1024 lds
    v_mfma_f32_16x16x32_bf16 v[196:199], a[164:167], v[44:47], v[196:199]
    ds_read_b64_tr_b16 a[154:155], v91 offset:1024
    ds_read_b128 v[4:7], v113 offset:0
    v_mfma_f32_16x16x32_bf16 v[196:199], a[160:163], v[40:43], v[196:199]
    v_mfma_f32_16x16x32_bf16 v[200:203], a[160:163], v[48:51], v[200:203]
    ds_read_b64_tr_b16 a[156:157], v91 offset:8192
    ds_read_b128 v[8:11], v112 offset:2048
    v_mfma_f32_16x16x32_bf16 v[200:203], a[164:167], v[52:55], v[200:203]
    buffer_load_dwordx4 v110, s[24:27], s47 offen offset:2048 lds
    v_mfma_f32_16x16x32_bf16 v[204:207], a[164:167], v[60:63], v[204:207]
    ds_read_b64_tr_b16 a[158:159], v91 offset:9216
    ds_read_b128 v[12:15], v113 offset:2048
    v_mfma_f32_16x16x32_bf16 v[204:207], a[160:163], v[56:59], v[204:207]
    v_mfma_f32_16x16x32_bf16 v[220:223], a[168:171], v[56:59], v[220:223]
    ds_read_b64_tr_b16 a[160:161], v92 offset:0
    ds_read_b128 v[16:19], v112 offset:4096
    v_mfma_f32_16x16x32_bf16 v[220:223], a[172:175], v[60:63], v[220:223]
    buffer_load_dwordx4 v111, s[24:27], s47 offen offset:3072 lds
    v_mfma_f32_16x16x32_bf16 v[216:219], a[172:175], v[52:55], v[216:219]
    ds_read_b64_tr_b16 a[162:163], v92 offset:1024
    s_add_u32 s46, s46, 524288
    v_mfma_f32_16x16x32_bf16 v[216:219], a[168:171], v[48:51], v[216:219]
    s_and_b32 s46, s46, 4194303
    s_lshr_b32 s47, s46, 19
    v_mfma_f32_16x16x32_bf16 v[212:215], a[168:171], v[40:43], v[212:215]
    ds_read_b64_tr_b16 a[164:165], v92 offset:8192
    s_mul_i32 s47, s47, 176128
    v_mfma_f32_16x16x32_bf16 v[212:215], a[172:175], v[44:47], v[212:215]
    buffer_load_dwordx4 v[80:83], v115, s[88:91], s71 offen sc1
    v_mfma_f32_16x16x32_bf16 v[208:211], a[172:175], v[36:39], v[208:211]
    ds_read_b64_tr_b16 a[166:167], v92 offset:9216
    ds_read_b128 v[20:23], v113 offset:4096
    v_mfma_f32_16x16x32_bf16 v[208:211], a[168:171], v[32:35], v[208:211]
    v_mfma_f32_16x16x32_bf16 v[224:227], a[176:179], v[32:35], v[224:227]
    ds_read_b64_tr_b16 a[168:169], v93 offset:0
    ds_read_b128 v[24:27], v112 offset:6144
    v_mfma_f32_16x16x32_bf16 v[224:227], a[180:183], v[36:39], v[224:227]
    buffer_load_dwordx4 v[84:87], v115, s[88:91], s54 offen sc1
    v_mfma_f32_16x16x32_bf16 v[228:231], a[180:183], v[44:47], v[228:231]
    ds_read_b64_tr_b16 a[170:171], v93 offset:1024
    ds_read_b128 v[28:31], v113 offset:6144
    v_mfma_f32_16x16x32_bf16 v[228:231], a[176:179], v[40:43], v[228:231]
    v_mfma_f32_16x16x32_bf16 v[232:235], a[176:179], v[48:51], v[232:235]
    ds_read_b64_tr_b16 a[172:173], v93 offset:8192
    v_mfma_f32_16x16x32_bf16 v[232:235], a[180:183], v[52:55], v[232:235]
    buffer_load_dwordx2 v[64:65], v117, s[88:91], s93 offen offset:0 sc1
    v_mfma_f32_16x16x32_bf16 v[236:239], a[180:183], v[60:63], v[236:239]
    ds_read_b64_tr_b16 a[174:175], v93 offset:9216
    v_mfma_f32_16x16x32_bf16 v[236:239], a[176:179], v[56:59], v[236:239]
    v_mfma_f32_16x16x32_bf16 v[252:255], a[184:187], v[56:59], v[252:255]
    ds_read_b64_tr_b16 a[176:177], v94 offset:0
    v_mfma_f32_16x16x32_bf16 v[252:255], a[188:191], v[60:63], v[252:255]
    buffer_load_dwordx2 v[68:69], v117, s[88:91], s93 offen offset:128 sc1
    v_mfma_f32_16x16x32_bf16 v[248:251], a[188:191], v[52:55], v[248:251]
    ds_read_b64_tr_b16 a[178:179], v94 offset:1024
    v_mfma_f32_16x16x32_bf16 v[248:251], a[184:187], v[48:51], v[248:251]
    v_mfma_f32_16x16x32_bf16 v[244:247], a[184:187], v[40:43], v[244:247]
    ds_read_b64_tr_b16 a[180:181], v94 offset:8192
    v_mfma_f32_16x16x32_bf16 v[244:247], a[188:191], v[44:47], v[244:247]
    buffer_load_dwordx2 v[72:73], v117, s[88:91], s93 offen offset:256 sc1
    v_mfma_f32_16x16x32_bf16 v[240:243], a[188:191], v[36:39], v[240:243]
    ds_read_b64_tr_b16 a[182:183], v94 offset:9216
    v_mfma_f32_16x16x32_bf16 v[240:243], a[184:187], v[32:35], v[240:243]
    v_mfma_f32_16x16x32_bf16 a[0:3], a[192:195], v[32:35], a[0:3]
    ds_read_b64_tr_b16 a[184:185], v95 offset:0
    v_mfma_f32_16x16x32_bf16 a[0:3], a[196:199], v[36:39], a[0:3]
    buffer_load_dwordx2 v[76:77], v117, s[88:91], s93 offen offset:384 sc1
    v_mfma_f32_16x16x32_bf16 a[24:27], a[196:199], v[44:47], a[24:27]
    ds_read_b64_tr_b16 a[186:187], v95 offset:1024
    v_mfma_f32_16x16x32_bf16 a[24:27], a[192:195], v[40:43], a[24:27]
    v_mfma_f32_16x16x32_bf16 a[48:51], a[192:195], v[48:51], a[48:51]
    ds_read_b64_tr_b16 a[188:189], v95 offset:8192
    s_add_u32 m0, s49, 32768
    v_mfma_f32_16x16x32_bf16 a[48:51], a[196:199], v[52:55], a[48:51]
    buffer_load_dwordx4 v100, s[16:19], s44 offen offset:0 lds
    v_mfma_f32_16x16x32_bf16 a[72:75], a[196:199], v[60:63], a[72:75]
    ds_read_b64_tr_b16 a[190:191], v95 offset:9216
    v_mfma_f32_16x16x32_bf16 a[72:75], a[192:195], v[56:59], a[72:75]
    v_mfma_f32_16x16x32_bf16 a[76:79], a[200:203], v[56:59], a[76:79]
    ds_read_b64_tr_b16 a[192:193], v116 offset:0
    v_mfma_f32_16x16x32_bf16 a[76:79], a[204:207], v[60:63], a[76:79]
    buffer_load_dwordx4 v101, s[16:19], s44 offen offset:1024 lds
    v_mfma_f32_16x16x32_bf16 a[52:55], a[204:207], v[52:55], a[52:55]
    ds_read_b64_tr_b16 a[194:195], v116 offset:384
    v_mfma_f32_16x16x32_bf16 a[52:55], a[200:203], v[48:51], a[52:55]
    v_mfma_f32_16x16x32_bf16 a[28:31], a[200:203], v[40:43], a[28:31]
    ds_read_b64_tr_b16 a[196:197], v116 offset:4096
    v_mfma_f32_16x16x32_bf16 a[28:31], a[204:207], v[44:47], a[28:31]
    buffer_load_dwordx4 v102, s[16:19], s44 offen offset:2048 lds
    v_mfma_f32_16x16x32_bf16 a[4:7], a[204:207], v[36:39], a[4:7]
    ds_read_b64_tr_b16 a[198:199], v116 offset:4480
    v_mfma_f32_16x16x32_bf16 a[4:7], a[200:203], v[32:35], a[4:7]
    v_mfma_f32_16x16x32_bf16 a[8:11], a[208:211], v[32:35], a[8:11]
    ds_read_b64_tr_b16 a[200:201], v116 offset:32
    v_mfma_f32_16x16x32_bf16 a[8:11], a[212:215], v[36:39], a[8:11]
    buffer_load_dwordx4 v103, s[16:19], s44 offen offset:3072 lds
    v_mfma_f32_16x16x32_bf16 a[32:35], a[212:215], v[44:47], a[32:35]
    ds_read_b64_tr_b16 a[202:203], v116 offset:416
    s_add_u32 m0, s49, 36864
    v_mfma_f32_16x16x32_bf16 a[32:35], a[208:211], v[40:43], a[32:35]
    v_mfma_f32_16x16x32_bf16 a[56:59], a[208:211], v[48:51], a[56:59]
    ds_read_b64_tr_b16 a[204:205], v116 offset:4128
    v_mfma_f32_16x16x32_bf16 a[56:59], a[212:215], v[52:55], a[56:59]
    buffer_load_dwordx4 v100, s[16:19], s45 offen offset:0 lds
    v_mfma_f32_16x16x32_bf16 a[80:83], a[212:215], v[60:63], a[80:83]
    ds_read_b64_tr_b16 a[206:207], v116 offset:4512
    v_mfma_f32_16x16x32_bf16 a[80:83], a[208:211], v[56:59], a[80:83]
    v_mfma_f32_16x16x32_bf16 a[84:87], a[216:219], v[56:59], a[84:87]
    ds_read_b64_tr_b16 a[208:209], v127 offset:0
    v_mfma_f32_16x16x32_bf16 a[84:87], a[220:223], v[60:63], a[84:87]
    buffer_load_dwordx4 v101, s[16:19], s45 offen offset:1024 lds
    v_mfma_f32_16x16x32_bf16 a[60:63], a[220:223], v[52:55], a[60:63]
    ds_read_b64_tr_b16 a[210:211], v127 offset:384
    v_mfma_f32_16x16x32_bf16 a[60:63], a[216:219], v[48:51], a[60:63]
    v_mfma_f32_16x16x32_bf16 a[36:39], a[216:219], v[40:43], a[36:39]
    ds_read_b64_tr_b16 a[212:213], v127 offset:4096
    v_mfma_f32_16x16x32_bf16 a[36:39], a[220:223], v[44:47], a[36:39]
    buffer_load_dwordx4 v102, s[16:19], s45 offen offset:2048 lds
    v_mfma_f32_16x16x32_bf16 a[12:15], a[220:223], v[36:39], a[12:15]
    ds_read_b64_tr_b16 a[214:215], v127 offset:4480
    v_mfma_f32_16x16x32_bf16 a[12:15], a[216:219], v[32:35], a[12:15]
    v_mfma_f32_16x16x32_bf16 a[16:19], a[224:227], v[32:35], a[16:19]
    ds_read_b64_tr_b16 a[216:217], v116 offset:8192
    v_mfma_f32_16x16x32_bf16 a[16:19], a[228:231], v[36:39], a[16:19]
    buffer_load_dwordx4 v103, s[16:19], s45 offen offset:3072 lds
    v_mfma_f32_16x16x32_bf16 a[40:43], a[228:231], v[44:47], a[40:43]
    ds_read_b64_tr_b16 a[218:219], v116 offset:8576
    s_add_u32 s44, s44, 128
    v_mfma_f32_16x16x32_bf16 a[40:43], a[224:227], v[40:43], a[40:43]
    s_and_b32 s44, s44, 1023
    s_add_u32 s45, s44, 32768
    v_mfma_f32_16x16x32_bf16 a[64:67], a[224:227], v[48:51], a[64:67]
    ds_read_b64_tr_b16 a[220:221], v116 offset:12288
    v_mfma_f32_16x16x32_bf16 a[64:67], a[228:231], v[52:55], a[64:67]
    v_mfma_f32_16x16x32_bf16 a[88:91], a[228:231], v[60:63], a[88:91]
    ds_read_b64_tr_b16 a[222:223], v116 offset:12672
    v_mfma_f32_16x16x32_bf16 a[88:91], a[224:227], v[56:59], a[88:91]
    v_mfma_f32_16x16x32_bf16 a[92:95], a[232:235], v[56:59], a[92:95]
    ds_read_b64_tr_b16 a[224:225], v116 offset:8224
    v_mfma_f32_16x16x32_bf16 a[92:95], a[236:239], v[60:63], a[92:95]
    v_mfma_f32_16x16x32_bf16 a[68:71], a[236:239], v[52:55], a[68:71]
    ds_read_b64_tr_b16 a[226:227], v116 offset:8608
    v_mfma_f32_16x16x32_bf16 a[68:71], a[232:235], v[48:51], a[68:71]
    v_mfma_f32_16x16x32_bf16 a[44:47], a[232:235], v[40:43], a[44:47]
    ds_read_b64_tr_b16 a[228:229], v116 offset:12320
    v_mfma_f32_16x16x32_bf16 a[44:47], a[236:239], v[44:47], a[44:47]
    v_mfma_f32_16x16x32_bf16 a[20:23], a[236:239], v[36:39], a[20:23]
    ds_read_b64_tr_b16 a[230:231], v116 offset:12704
    v_mfma_f32_16x16x32_bf16 a[20:23], a[232:235], v[32:35], a[20:23]
    s_waitcnt lgkmcnt(4)
    v_mfma_f32_16x16x32_bf16 v[128:131], a[128:131], v[0:3], v[128:131]
    ds_read_b64_tr_b16 a[232:233], v127 offset:8192
    ds_read_b64_tr_b16 a[234:235], v127 offset:8576
    v_mfma_f32_16x16x32_bf16 v[128:131], a[132:135], v[4:7], v[128:131]
    ds_read_b64_tr_b16 a[236:237], v127 offset:12288
    ds_read_b64_tr_b16 a[238:239], v127 offset:12672
    v_mfma_f32_16x16x32_bf16 v[132:135], a[132:135], v[12:15], v[132:135]
    v_mfma_f32_16x16x32_bf16 v[132:135], a[128:131], v[8:11], v[132:135]
    v_mfma_f32_16x16x32_bf16 v[136:139], a[128:131], v[16:19], v[136:139]
    v_mfma_f32_16x16x32_bf16 v[136:139], a[132:135], v[20:23], v[136:139]
    v_mfma_f32_16x16x32_bf16 v[140:143], a[132:135], v[28:31], v[140:143]
    v_mfma_f32_16x16x32_bf16 v[140:143], a[128:131], v[24:27], v[140:143]
    s_waitcnt vmcnt(8) lgkmcnt(0)
    s_barrier
    v_mfma_f32_16x16x32_bf16 v[156:159], a[136:139], v[24:27], v[156:159]
    ds_read_b64_tr_b16 a[128:129], v88 offset:32768
    s_add_u32 m0, s52, 0
    v_mfma_f32_16x16x32_bf16 v[156:159], a[140:143], v[28:31], v[156:159]
    buffer_load_dwordx4 v120, s[8:11], s48 offen offset:0 sc1 lds
    v_mfma_f32_16x16x32_bf16 v[152:155], a[140:143], v[20:23], v[152:155]
    ds_read_b64_tr_b16 a[130:131], v88 offset:33792
    v_mfma_f32_16x16x32_bf16 v[152:155], a[136:139], v[16:19], v[152:155]
    v_rsq_f32 v66, v65
    v_mfma_f32_16x16x32_bf16 v[148:151], a[136:139], v[8:11], v[148:151]
    ds_read_b64_tr_b16 a[132:133], v88 offset:40960
    v_mfma_f32_16x16x32_bf16 v[148:151], a[140:143], v[12:15], v[148:151]
    v_rsq_f32 v70, v69
    v_mfma_f32_16x16x32_bf16 v[144:147], a[140:143], v[4:7], v[144:147]
    ds_read_b64_tr_b16 a[134:135], v88 offset:41984
    v_mfma_f32_16x16x32_bf16 v[144:147], a[136:139], v[0:3], v[144:147]
    buffer_load_dwordx4 v121, s[8:11], s48 offen offset:1024 sc1 lds
    v_mfma_f32_16x16x32_bf16 v[160:163], a[144:147], v[0:3], v[160:163]
    ds_read_b64_tr_b16 a[136:137], v89 offset:32768
    v_mfma_f32_16x16x32_bf16 v[160:163], a[148:151], v[4:7], v[160:163]
    v_rsq_f32 v74, v73
    v_mfma_f32_16x16x32_bf16 v[164:167], a[148:151], v[12:15], v[164:167]
    ds_read_b64_tr_b16 a[138:139], v89 offset:33792
    v_mfma_f32_16x16x32_bf16 v[164:167], a[144:147], v[8:11], v[164:167]
    v_rsq_f32 v78, v77
    v_mfma_f32_16x16x32_bf16 v[168:171], a[144:147], v[16:19], v[168:171]
    ds_read_b64_tr_b16 a[140:141], v89 offset:40960
    v_mul_f32 v67, v65, v66
    v_mfma_f32_16x16x32_bf16 v[168:171], a[148:151], v[20:23], v[168:171]
    buffer_load_dwordx4 v122, s[8:11], s48 offen offset:2048 sc1 lds
    v_mfma_f32_16x16x32_bf16 v[172:175], a[148:151], v[28:31], v[172:175]
    ds_read_b64_tr_b16 a[142:143], v89 offset:41984
    v_mul_f32 v65, 0x3e0293ee, v66
    v_mfma_f32_16x16x32_bf16 v[172:175], a[144:147], v[24:27], v[172:175]
    v_mul_f32 v66, 0xbfb8aa3b, v66
    v_mul_f32 v71, v69, v70
    v_mfma_f32_16x16x32_bf16 v[188:191], a[152:155], v[24:27], v[188:191]
    ds_read_b64_tr_b16 a[144:145], v90 offset:32768
    v_mul_f32 v69, 0x3e0293ee, v70
    v_mfma_f32_16x16x32_bf16 v[188:191], a[156:159], v[28:31], v[188:191]
    v_mul_f32 v70, 0xbfb8aa3b, v70
    v_mul_f32 v75, v73, v74
    v_mfma_f32_16x16x32_bf16 v[184:187], a[156:159], v[20:23], v[184:187]
    ds_read_b64_tr_b16 a[146:147], v90 offset:33792
    v_mul_f32 v73, 0x3e0293ee, v74
    v_mfma_f32_16x16x32_bf16 v[184:187], a[152:155], v[16:19], v[184:187]
    buffer_load_dwordx4 v123, s[8:11], s48 offen offset:3072 sc1 lds
    v_mfma_f32_16x16x32_bf16 v[180:183], a[152:155], v[8:11], v[180:183]
    ds_read_b64_tr_b16 a[148:149], v90 offset:40960
    s_add_u32 m0, s52, 65536
    v_mfma_f32_16x16x32_bf16 v[180:183], a[156:159], v[12:15], v[180:183]
    v_mul_f32 v74, 0xbfb8aa3b, v74
    v_mul_f32 v79, v77, v78
    v_mfma_f32_16x16x32_bf16 v[176:179], a[156:159], v[4:7], v[176:179]
    ds_read_b64_tr_b16 a[150:151], v90 offset:41984
    s_waitcnt vmcnt(4)
    v_mfma_f32_16x16x32_bf16 v[176:179], a[152:155], v[0:3], v[176:179]
    ds_read_b128 v[32:35], v112 offset:32768
    v_mul_f32 v77, 0x3e0293ee, v78
    v_mfma_f32_16x16x32_bf16 v[192:195], a[160:163], v[0:3], v[192:195]
    ds_read_b64_tr_b16 a[152:153], v91 offset:32768
    v_mul_f32 v78, 0xbfb8aa3b, v78
    v_mfma_f32_16x16x32_bf16 v[192:195], a[164:167], v[4:7], v[192:195]
    buffer_load_dwordx4 v124, s[12:15], s43 offen offset:0 sc1 lds
    v_mfma_f32_16x16x32_bf16 v[196:199], a[164:167], v[12:15], v[196:199]
    ds_read_b64_tr_b16 a[154:155], v91 offset:33792
    ds_read_b128 v[36:39], v113 offset:32768
    v_mfma_f32_16x16x32_bf16 v[196:199], a[160:163], v[8:11], v[196:199]
    v_add_f32 v80, v80, v84
    v_add_f32 v81, v81, v85
    v_mfma_f32_16x16x32_bf16 v[200:203], a[160:163], v[16:19], v[200:203]
    ds_read_b64_tr_b16 a[156:157], v91 offset:40960
    ds_read_b128 v[40:43], v112 offset:34816
    v_mfma_f32_16x16x32_bf16 v[200:203], a[164:167], v[20:23], v[200:203]
    v_add_f32 v82, v82, v86
    v_add_f32 v83, v83, v87
    v_mfma_f32_16x16x32_bf16 v[204:207], a[164:167], v[28:31], v[204:207]
    ds_read_b64_tr_b16 a[158:159], v91 offset:41984
    ds_read_b128 v[44:47], v113 offset:34816
    v_mfma_f32_16x16x32_bf16 v[204:207], a[160:163], v[24:27], v[204:207]
    buffer_load_dwordx4 v125, s[12:15], s43 offen offset:1024 sc1 lds
    v_mfma_f32_16x16x32_bf16 v[220:223], a[168:171], v[24:27], v[220:223]
    ds_read_b64_tr_b16 a[160:161], v92 offset:32768
    ds_read_b128 v[48:51], v112 offset:36864
    v_mfma_f32_16x16x32_bf16 v[220:223], a[172:175], v[28:31], v[220:223]
    v_mov_b32 v84, v80
    v_mov_b32 v85, v81
    v_mfma_f32_16x16x32_bf16 v[216:219], a[172:175], v[20:23], v[216:219]
    ds_read_b64_tr_b16 a[162:163], v92 offset:33792
    ds_read_b128 v[52:55], v113 offset:36864
    v_mfma_f32_16x16x32_bf16 v[216:219], a[168:171], v[16:19], v[216:219]
    v_mov_b32 v86, v82
    v_mov_b32 v87, v83
    v_mfma_f32_16x16x32_bf16 v[212:215], a[168:171], v[8:11], v[212:215]
    ds_read_b64_tr_b16 a[164:165], v92 offset:40960
    ds_read_b128 v[56:59], v112 offset:38912
    v_mfma_f32_16x16x32_bf16 v[212:215], a[172:175], v[12:15], v[212:215]
    buffer_load_dwordx4 v124, s[12:15], s43 offen offset:2048 sc1 lds
    v_mfma_f32_16x16x32_bf16 v[208:211], a[172:175], v[4:7], v[208:211]
    ds_read_b64_tr_b16 a[166:167], v92 offset:41984
    ds_read_b128 v[60:63], v113 offset:38912
    v_mfma_f32_16x16x32_bf16 v[208:211], a[168:171], v[0:3], v[208:211]
    v_permlane32_swap_b32 v80, v84
    v_permlane32_swap_b32 v81, v85
    v_mfma_f32_16x16x32_bf16 v[224:227], a[176:179], v[0:3], v[224:227]
    ds_read_b64_tr_b16 a[168:169], v93 offset:32768
    v_permlane32_swap_b32 v82, v86
    v_mfma_f32_16x16x32_bf16 v[224:227], a[180:183], v[4:7], v[224:227]
    v_permlane32_swap_b32 v83, v87
    v_add_f32 v80, v80, v84
    v_mfma_f32_16x16x32_bf16 v[228:231], a[180:183], v[12:15], v[228:231]
    ds_read_b64_tr_b16 a[170:171], v93 offset:33792
    v_add_f32 v81, v81, v85
    v_mfma_f32_16x16x32_bf16 v[228:231], a[176:179], v[8:11], v[228:231]
    buffer_load_dwordx4 v125, s[12:15], s43 offen offset:3072 sc1 lds
    v_mfma_f32_16x16x32_bf16 v[232:235], a[176:179], v[16:19], v[232:235]
    ds_read_b64_tr_b16 a[172:173], v93 offset:40960
    s_add_u32 s48, s48, s77
    v_mfma_f32_16x16x32_bf16 v[232:235], a[180:183], v[20:23], v[232:235]
    s_add_u32 s43, s43, s58
    s_add_u32 m0, s52, 16384
    v_mfma_f32_16x16x32_bf16 v[236:239], a[180:183], v[28:31], v[236:239]
    ds_read_b64_tr_b16 a[174:175], v93 offset:41984
    v_add_f32 v82, v82, v86
    v_mfma_f32_16x16x32_bf16 v[236:239], a[176:179], v[24:27], v[236:239]
    v_add_f32 v83, v83, v87
    v_mov_b32 v84, v80
    v_mfma_f32_16x16x32_bf16 v[252:255], a[184:187], v[24:27], v[252:255]
    ds_read_b64_tr_b16 a[176:177], v94 offset:32768
    v_mov_b32 v85, v81
    v_mfma_f32_16x16x32_bf16 v[252:255], a[188:191], v[28:31], v[252:255]
    buffer_load_dwordx4 v120, s[8:11], s48 offen offset:0 sc1 lds
    v_mfma_f32_16x16x32_bf16 v[248:251], a[188:191], v[20:23], v[248:251]
    ds_read_b64_tr_b16 a[178:179], v94 offset:33792
    v_mov_b32 v86, v82
    v_mfma_f32_16x16x32_bf16 v[248:251], a[184:187], v[16:19], v[248:251]
    v_mov_b32 v87, v83
    v_permlane16_swap_b32 v80, v84
    v_mfma_f32_16x16x32_bf16 v[244:247], a[184:187], v[8:11], v[244:247]
    ds_read_b64_tr_b16 a[180:181], v94 offset:40960
    v_permlane16_swap_b32 v81, v85
    v_mfma_f32_16x16x32_bf16 v[244:247], a[188:191], v[12:15], v[244:247]
    v_permlane16_swap_b32 v82, v86
    v_permlane16_swap_b32 v83, v87
    v_mfma_f32_16x16x32_bf16 v[240:243], a[188:191], v[4:7], v[240:243]
    ds_read_b64_tr_b16 a[182:183], v94 offset:41984
    v_add_f32 v80, v80, v84
    v_mfma_f32_16x16x32_bf16 v[240:243], a[184:187], v[0:3], v[240:243]
    buffer_load_dwordx4 v121, s[8:11], s48 offen offset:1024 sc1 lds
    v_mfma_f32_16x16x32_bf16 a[0:3], a[192:195], v[0:3], a[0:3]
    ds_read_b64_tr_b16 a[184:185], v95 offset:32768
    v_add_f32 v81, v81, v85
    v_mfma_f32_16x16x32_bf16 a[0:3], a[196:199], v[4:7], a[0:3]
    v_add_f32 v82, v82, v86
    v_add_f32 v83, v83, v87
    v_mfma_f32_16x16x32_bf16 a[24:27], a[196:199], v[12:15], a[24:27]
    ds_read_b64_tr_b16 a[186:187], v95 offset:33792
    v_lshrrev_b32 v115, 1, v117
    v_mfma_f32_16x16x32_bf16 a[24:27], a[192:195], v[8:11], a[24:27]
    v_add_u32 v115, s53, v115
    v_mfma_f32_16x16x32_bf16 a[48:51], a[192:195], v[16:19], a[48:51]
    ds_read_b64_tr_b16 a[188:189], v95 offset:40960
    v_mfma_f32_16x16x32_bf16 a[48:51], a[196:199], v[20:23], a[48:51]
    buffer_load_dwordx4 v122, s[8:11], s48 offen offset:2048 sc1 lds
    v_mfma_f32_16x16x32_bf16 a[72:75], a[196:199], v[28:31], a[72:75]
    ds_read_b64_tr_b16 a[190:191], v95 offset:41984
    v_mfma_f32_16x16x32_bf16 a[72:75], a[192:195], v[24:27], a[72:75]
    ds_write_b32 v115, v80 offset:0
    v_mfma_f32_16x16x32_bf16 a[76:79], a[200:203], v[24:27], a[76:79]
    ds_read_b64_tr_b16 a[192:193], v116 offset:32768
    v_mfma_f32_16x16x32_bf16 a[76:79], a[204:207], v[28:31], a[76:79]
    ds_write_b32 v115, v81 offset:64
    v_mfma_f32_16x16x32_bf16 a[52:55], a[204:207], v[20:23], a[52:55]
    ds_read_b64_tr_b16 a[194:195], v116 offset:33152
    v_mfma_f32_16x16x32_bf16 a[52:55], a[200:203], v[16:19], a[52:55]
    buffer_load_dwordx4 v123, s[8:11], s48 offen offset:3072 sc1 lds
    v_mfma_f32_16x16x32_bf16 a[28:31], a[200:203], v[8:11], a[28:31]
    ds_read_b64_tr_b16 a[196:197], v116 offset:36864
    s_add_u32 m0, s52, 81920
    v_mfma_f32_16x16x32_bf16 a[28:31], a[204:207], v[12:15], a[28:31]
    ds_write_b32 v115, v82 offset:128
    v_mfma_f32_16x16x32_bf16 a[4:7], a[204:207], v[4:7], a[4:7]
    ds_read_b64_tr_b16 a[198:199], v116 offset:37248
    v_mfma_f32_16x16x32_bf16 a[4:7], a[200:203], v[0:3], a[4:7]
    ds_write_b32 v115, v83 offset:192
    v_mfma_f32_16x16x32_bf16 a[8:11], a[208:211], v[0:3], a[8:11]
    ds_read_b64_tr_b16 a[200:201], v116 offset:32800
    v_and_b32 v80, 15, v126
    v_mfma_f32_16x16x32_bf16 a[8:11], a[212:215], v[4:7], a[8:11]
    buffer_load_dwordx4 v124, s[12:15], s43 offen offset:0 sc1 lds
    v_mfma_f32_16x16x32_bf16 a[32:35], a[212:215], v[12:15], a[32:35]
    ds_read_b64_tr_b16 a[202:203], v116 offset:33184
    v_lshrrev_b32 v81, 4, v126
    v_mfma_f32_16x16x32_bf16 a[32:35], a[208:211], v[8:11], a[32:35]
    v_lshrrev_b32 v82, 2, v80
    v_and_b32 v83, 3, v126
    v_mfma_f32_16x16x32_bf16 a[56:59], a[208:211], v[16:19], a[56:59]
    ds_read_b64_tr_b16 a[204:205], v116 offset:36896
    v_lshlrev_b32 v84, 8, v80
    v_mfma_f32_16x16x32_bf16 a[56:59], a[212:215], v[20:23], a[56:59]
    v_and_b32 v86, 1, v81
    v_lshrrev_b32 v87, 1, v81
    v_mfma_f32_16x16x32_bf16 a[80:83], a[212:215], v[28:31], a[80:83]
    ds_read_b64_tr_b16 a[206:207], v116 offset:37280
    v_lshl_add_u32 v86, v86, 1, v87
    v_mfma_f32_16x16x32_bf16 a[80:83], a[208:211], v[24:27], a[80:83]
    buffer_load_dwordx4 v125, s[12:15], s43 offen offset:1024 sc1 lds
    v_mfma_f32_16x16x32_bf16 a[84:87], a[216:219], v[24:27], a[84:87]
    ds_read_b64_tr_b16 a[208:209], v127 offset:32768
    v_xor_b32 v86, v86, v80
    v_mfma_f32_16x16x32_bf16 a[84:87], a[220:223], v[28:31], a[84:87]
    v_xor_b32 v85, 0, v86
    v_lshl_add_u32 v100, v85, 4, v84
    v_mfma_f32_16x16x32_bf16 a[60:63], a[220:223], v[20:23], a[60:63]
    ds_read_b64_tr_b16 a[210:211], v127 offset:33152
    v_xor_b32 v85, 4, v86
    v_mfma_f32_16x16x32_bf16 a[60:63], a[216:219], v[16:19], a[60:63]
    v_lshl_add_u32 v101, v85, 4, v84
    v_xor_b32 v85, 8, v86
    v_mfma_f32_16x16x32_bf16 a[36:39], a[216:219], v[8:11], a[36:39]
    ds_read_b64_tr_b16 a[212:213], v127 offset:36864
    v_lshl_add_u32 v102, v85, 4, v84
    v_mfma_f32_16x16x32_bf16 a[36:39], a[220:223], v[12:15], a[36:39]
    buffer_load_dwordx4 v124, s[12:15], s43 offen offset:2048 sc1 lds
    v_mfma_f32_16x16x32_bf16 a[12:15], a[220:223], v[4:7], a[12:15]
    ds_read_b64_tr_b16 a[214:215], v127 offset:37248
    v_xor_b32 v85, 12, v86
    v_mfma_f32_16x16x32_bf16 a[12:15], a[216:219], v[0:3], a[12:15]
    v_lshl_add_u32 v103, v85, 4, v84
    v_lshl_add_u32 v84, v81, 2, v82
    v_mfma_f32_16x16x32_bf16 a[16:19], a[224:227], v[0:3], a[16:19]
    ds_read_b64_tr_b16 a[216:217], v116 offset:40960
    v_and_b32 v85, 7, v84
    v_mfma_f32_16x16x32_bf16 a[16:19], a[228:231], v[4:7], a[16:19]
    v_lshlrev_b32 v84, 8, v84
    v_lshl_add_u32 v84, v83, 3, v84
    v_mfma_f32_16x16x32_bf16 a[40:43], a[228:231], v[12:15], a[40:43]
    ds_read_b64_tr_b16 a[218:219], v116 offset:41344
    v_add_u32 v84, 65536, v84
    v_mfma_f32_16x16x32_bf16 a[40:43], a[224:227], v[8:11], a[40:43]
    buffer_load_dwordx4 v125, s[12:15], s43 offen offset:3072 sc1 lds
    v_mfma_f32_16x16x32_bf16 a[64:67], a[224:227], v[16:19], a[64:67]
    ds_read_b64_tr_b16 a[220:221], v116 offset:45056
    s_add_u32 s48, s48, s77
    v_mfma_f32_16x16x32_bf16 a[64:67], a[228:231], v[20:23], a[64:67]
    s_add_u32 s43, s43, s58
    v_xor_b32 v86, 0, v85
    v_mfma_f32_16x16x32_bf16 a[88:91], a[228:231], v[28:31], a[88:91]
    ds_read_b64_tr_b16 a[222:223], v116 offset:45440
    v_lshl_add_u32 v104, v86, 5, v84
    v_mfma_f32_16x16x32_bf16 a[88:91], a[224:227], v[24:27], a[88:91]
    v_xor_b32 v86, 1, v85
    v_lshl_add_u32 v105, v86, 5, v84
    v_mfma_f32_16x16x32_bf16 a[92:95], a[232:235], v[24:27], a[92:95]
    ds_read_b64_tr_b16 a[224:225], v116 offset:40992
    v_xor_b32 v86, 2, v85
    v_mfma_f32_16x16x32_bf16 a[92:95], a[236:239], v[28:31], a[92:95]
    v_lshl_add_u32 v106, v86, 5, v84
    v_xor_b32 v86, 3, v85
    v_mfma_f32_16x16x32_bf16 a[68:71], a[236:239], v[20:23], a[68:71]
    ds_read_b64_tr_b16 a[226:227], v116 offset:41376
    v_lshl_add_u32 v107, v86, 5, v84
    v_mfma_f32_16x16x32_bf16 a[68:71], a[232:235], v[16:19], a[68:71]
    v_xor_b32 v86, 4, v85
    v_lshl_add_u32 v108, v86, 5, v84
    v_mfma_f32_16x16x32_bf16 a[44:47], a[232:235], v[8:11], a[44:47]
    ds_read_b64_tr_b16 a[228:229], v116 offset:45088
    v_xor_b32 v86, 5, v85
    v_mfma_f32_16x16x32_bf16 a[44:47], a[236:239], v[12:15], a[44:47]
    v_lshl_add_u32 v109, v86, 5, v84
    v_xor_b32 v86, 6, v85
    v_mfma_f32_16x16x32_bf16 a[20:23], a[236:239], v[4:7], a[20:23]
    ds_read_b64_tr_b16 a[230:231], v116 offset:45472
    v_lshl_add_u32 v110, v86, 5, v84
    v_mfma_f32_16x16x32_bf16 a[20:23], a[232:235], v[0:3], a[20:23]
    s_waitcnt lgkmcnt(4)
    v_xor_b32 v86, 7, v85
    v_lshl_add_u32 v111, v86, 5, v84
    v_lshrrev_b32 v112, 4, v126
    v_lshlrev_b32 v112, 4, v112
    v_add_u32 v112, 131072, v112
    v_mfma_f32_16x16x32_bf16 v[128:131], a[128:131], v[32:35], v[128:131]
    ds_read_b64_tr_b16 a[232:233], v127 offset:40960
    ds_read_b64_tr_b16 a[234:235], v127 offset:41344
    v_mfma_f32_16x16x32_bf16 v[128:131], a[132:135], v[36:39], v[128:131]
    ds_read_b64_tr_b16 a[236:237], v127 offset:45056
    ds_read_b64_tr_b16 a[238:239], v127 offset:45440
    v_mfma_f32_16x16x32_bf16 v[132:135], a[132:135], v[44:47], v[132:135]
    v_mfma_f32_16x16x32_bf16 v[132:135], a[128:131], v[40:43], v[132:135]
    v_mfma_f32_16x16x32_bf16 v[136:139], a[128:131], v[48:51], v[136:139]
    v_mfma_f32_16x16x32_bf16 v[136:139], a[132:135], v[52:55], v[136:139]
    v_mfma_f32_16x16x32_bf16 v[140:143], a[132:135], v[60:63], v[140:143]
    v_mfma_f32_16x16x32_bf16 v[140:143], a[128:131], v[56:59], v[140:143]
    s_waitcnt lgkmcnt(0)
    s_barrier
    v_mfma_f32_16x16x32_bf16 v[156:159], a[136:139], v[56:59], v[156:159]
    s_add_u32 m0, s52, 32768
    ds_read_b128 v[0:3], v112 offset:0
    v_mfma_f32_16x16x32_bf16 v[156:159], a[140:143], v[60:63], v[156:159]
    buffer_load_dwordx4 v120, s[8:11], s48 offen offset:0 sc1 lds
    v_mfma_f32_16x16x32_bf16 v[152:155], a[140:143], v[52:55], v[152:155]
    ds_read_b128 v[4:7], v112 offset:64
    ds_read_b128 v[8:11], v112 offset:8192
    v_mfma_f32_16x16x32_bf16 v[152:155], a[136:139], v[48:51], v[152:155]
    ds_read_b128 v[12:15], v112 offset:8256
    ds_read_b128 v[16:19], v112 offset:16384
    v_mfma_f32_16x16x32_bf16 v[148:151], a[136:139], v[40:43], v[148:151]
    ds_read_b128 v[20:23], v112 offset:16448
    ds_read_b128 v[24:27], v112 offset:24576
    v_mfma_f32_16x16x32_bf16 v[148:151], a[140:143], v[44:47], v[148:151]
    ds_read_b128 v[28:31], v112 offset:24640
    v_mfma_f32_16x16x32_bf16 v[144:147], a[140:143], v[36:39], v[144:147]
    v_mfma_f32_16x16x32_bf16 v[144:147], a[136:139], v[32:35], v[144:147]
    buffer_load_dwordx4 v121, s[8:11], s48 offen offset:1024 sc1 lds
    v_mfma_f32_16x16x32_bf16 v[160:163], a[144:147], v[32:35], v[160:163]
    v_mfma_f32_16x16x32_bf16 v[160:163], a[148:151], v[36:39], v[160:163]
    v_mfma_f32_16x16x32_bf16 v[164:167], a[148:151], v[44:47], v[164:167]
    v_mfma_f32_16x16x32_bf16 v[164:167], a[144:147], v[40:43], v[164:167]
    s_waitcnt lgkmcnt(0)
    v_mfma_f32_16x16x32_bf16 v[168:171], a[144:147], v[48:51], v[168:171]
    v_fmac_f32 v128, v0, v64
    v_fmac_f32 v129, v1, v64
    v_mfma_f32_16x16x32_bf16 v[168:171], a[148:151], v[52:55], v[168:171]
    buffer_load_dwordx4 v122, s[8:11], s48 offen offset:2048 sc1 lds
    v_mfma_f32_16x16x32_bf16 v[172:175], a[148:151], v[60:63], v[172:175]
    v_fmac_f32 v130, v2, v64
    v_fmac_f32 v131, v3, v64
    v_mfma_f32_16x16x32_bf16 v[172:175], a[144:147], v[56:59], v[172:175]
    v_fmac_f32 v132, v0, v68
    v_fmac_f32 v133, v1, v68
    v_mfma_f32_16x16x32_bf16 v[188:191], a[152:155], v[56:59], v[188:191]
    v_fmac_f32 v134, v2, v68
    v_fmac_f32 v135, v3, v68
    v_mfma_f32_16x16x32_bf16 v[188:191], a[156:159], v[60:63], v[188:191]
    v_fmac_f32 v136, v0, v72
    v_fmac_f32 v137, v1, v72
    v_mfma_f32_16x16x32_bf16 v[184:187], a[156:159], v[52:55], v[184:187]
    v_fmac_f32 v138, v2, v72
    v_fmac_f32 v139, v3, v72
    v_mfma_f32_16x16x32_bf16 v[184:187], a[152:155], v[48:51], v[184:187]
    buffer_load_dwordx4 v123, s[8:11], s48 offen offset:3072 sc1 lds
    v_mfma_f32_16x16x32_bf16 v[180:183], a[152:155], v[40:43], v[180:183]
    s_add_u32 m0, s52, 98304
    v_fmac_f32 v140, v0, v76
    v_mfma_f32_16x16x32_bf16 v[180:183], a[156:159], v[44:47], v[180:183]
    v_fmac_f32 v141, v1, v76
    v_fmac_f32 v142, v2, v76
    v_mfma_f32_16x16x32_bf16 v[176:179], a[156:159], v[36:39], v[176:179]
    v_fmac_f32 v143, v3, v76
    v_fmac_f32 v156, v4, v76
    v_mfma_f32_16x16x32_bf16 v[176:179], a[152:155], v[32:35], v[176:179]
    v_fmac_f32 v157, v5, v76
    v_fmac_f32 v158, v6, v76
    v_mfma_f32_16x16x32_bf16 v[192:195], a[160:163], v[32:35], v[192:195]
    v_fmac_f32 v159, v7, v76
    v_fmac_f32 v152, v4, v72
    v_mfma_f32_16x16x32_bf16 v[192:195], a[164:167], v[36:39], v[192:195]
    buffer_load_dwordx4 v124, s[12:15], s43 offen offset:0 sc1 lds
    v_mfma_f32_16x16x32_bf16 v[196:199], a[164:167], v[44:47], v[196:199]
    v_fmac_f32 v153, v5, v72
    v_fmac_f32 v154, v6, v72
    v_mfma_f32_16x16x32_bf16 v[196:199], a[160:163], v[40:43], v[196:199]
    v_fmac_f32 v155, v7, v72
    v_fmac_f32 v148, v4, v68
    v_mfma_f32_16x16x32_bf16 v[200:203], a[160:163], v[48:51], v[200:203]
    v_fmac_f32 v149, v5, v68
    v_fmac_f32 v150, v6, v68
    v_mfma_f32_16x16x32_bf16 v[200:203], a[164:167], v[52:55], v[200:203]
    v_fmac_f32 v151, v7, v68
    v_fmac_f32 v144, v4, v64
    v_mfma_f32_16x16x32_bf16 v[204:207], a[164:167], v[60:63], v[204:207]
    v_fmac_f32 v145, v5, v64
    v_fmac_f32 v146, v6, v64
    v_mfma_f32_16x16x32_bf16 v[204:207], a[160:163], v[56:59], v[204:207]
    buffer_load_dwordx4 v125, s[12:15], s43 offen offset:1024 sc1 lds
    v_mfma_f32_16x16x32_bf16 v[220:223], a[168:171], v[56:59], v[220:223]
    v_fmac_f32 v147, v7, v64
    v_fmac_f32 v160, v8, v64
    v_mfma_f32_16x16x32_bf16 v[220:223], a[172:175], v[60:63], v[220:223]
    v_fmac_f32 v161, v9, v64
    v_fmac_f32 v162, v10, v64
    v_mfma_f32_16x16x32_bf16 v[216:219], a[172:175], v[52:55], v[216:219]
    v_fmac_f32 v163, v11, v64
    v_fmac_f32 v164, v8, v68
    v_mfma_f32_16x16x32_bf16 v[216:219], a[168:171], v[48:51], v[216:219]
    v_fmac_f32 v165, v9, v68
    v_fmac_f32 v166, v10, v68
    v_mfma_f32_16x16x32_bf16 v[212:215], a[168:171], v[40:43], v[212:215]
    v_fmac_f32 v167, v11, v68
    v_fmac_f32 v168, v8, v72
    v_mfma_f32_16x16x32_bf16 v[212:215], a[172:175], v[44:47], v[212:215]
    buffer_load_dwordx4 v124, s[12:15], s43 offen offset:2048 sc1 lds
    v_mfma_f32_16x16x32_bf16 v[208:211], a[172:175], v[36:39], v[208:211]
    v_fmac_f32 v169, v9, v72
    v_fmac_f32 v170, v10, v72
    v_mfma_f32_16x16x32_bf16 v[208:211], a[168:171], v[32:35], v[208:211]
    v_fmac_f32 v171, v11, v72
    v_fmac_f32 v172, v8, v76
    v_mfma_f32_16x16x32_bf16 v[224:227], a[176:179], v[32:35], v[224:227]
    v_fmac_f32 v173, v9, v76
    v_fmac_f32 v174, v10, v76
    v_mfma_f32_16x16x32_bf16 v[224:227], a[180:183], v[36:39], v[224:227]
    v_fmac_f32 v175, v11, v76
    v_fmac_f32 v188, v12, v76
    v_mfma_f32_16x16x32_bf16 v[228:231], a[180:183], v[44:47], v[228:231]
    v_fmac_f32 v189, v13, v76
    v_fmac_f32 v190, v14, v76
    v_mfma_f32_16x16x32_bf16 v[228:231], a[176:179], v[40:43], v[228:231]
    buffer_load_dwordx4 v125, s[12:15], s43 offen offset:3072 sc1 lds
    v_mfma_f32_16x16x32_bf16 v[232:235], a[176:179], v[48:51], v[232:235]
    s_add_u32 s48, s48, s77
    s_add_u32 s43, s43, s58
    v_mfma_f32_16x16x32_bf16 v[232:235], a[180:183], v[52:55], v[232:235]
    s_add_u32 m0, s52, 49152
    v_fmac_f32 v191, v15, v76
    v_mfma_f32_16x16x32_bf16 v[236:239], a[180:183], v[60:63], v[236:239]
    v_fmac_f32 v184, v12, v72
    v_fmac_f32 v185, v13, v72
    v_mfma_f32_16x16x32_bf16 v[236:239], a[176:179], v[56:59], v[236:239]
    v_fmac_f32 v186, v14, v72
    v_fmac_f32 v187, v15, v72
    v_mfma_f32_16x16x32_bf16 v[252:255], a[184:187], v[56:59], v[252:255]
    v_fmac_f32 v180, v12, v68
    v_fmac_f32 v181, v13, v68
    v_mfma_f32_16x16x32_bf16 v[252:255], a[188:191], v[60:63], v[252:255]
    buffer_load_dwordx4 v120, s[8:11], s48 offen offset:0 sc1 lds
    v_mfma_f32_16x16x32_bf16 v[248:251], a[188:191], v[52:55], v[248:251]
    v_fmac_f32 v182, v14, v68
    v_fmac_f32 v183, v15, v68
    v_mfma_f32_16x16x32_bf16 v[248:251], a[184:187], v[48:51], v[248:251]
    v_fmac_f32 v176, v12, v64
    v_fmac_f32 v177, v13, v64
    v_mfma_f32_16x16x32_bf16 v[244:247], a[184:187], v[40:43], v[244:247]
    v_fmac_f32 v178, v14, v64
    v_fmac_f32 v179, v15, v64
    v_mfma_f32_16x16x32_bf16 v[244:247], a[188:191], v[44:47], v[244:247]
    v_fmac_f32 v192, v16, v64
    v_fmac_f32 v193, v17, v64
    v_mfma_f32_16x16x32_bf16 v[240:243], a[188:191], v[36:39], v[240:243]
    v_fmac_f32 v194, v18, v64
    v_fmac_f32 v195, v19, v64
    v_mfma_f32_16x16x32_bf16 v[240:243], a[184:187], v[32:35], v[240:243]
    buffer_load_dwordx4 v121, s[8:11], s48 offen offset:1024 sc1 lds
    v_mfma_f32_16x16x32_bf16 a[0:3], a[192:195], v[32:35], a[0:3]
    v_fmac_f32 v196, v16, v68
    v_fmac_f32 v197, v17, v68
    v_mfma_f32_16x16x32_bf16 a[0:3], a[196:199], v[36:39], a[0:3]
    v_fmac_f32 v198, v18, v68
    v_fmac_f32 v199, v19, v68
    v_mfma_f32_16x16x32_bf16 a[24:27], a[196:199], v[44:47], a[24:27]
    v_fmac_f32 v200, v16, v72
    v_fmac_f32 v201, v17, v72
    v_mfma_f32_16x16x32_bf16 a[24:27], a[192:195], v[40:43], a[24:27]
    v_fmac_f32 v202, v18, v72
    v_fmac_f32 v203, v19, v72
    v_mfma_f32_16x16x32_bf16 a[48:51], a[192:195], v[48:51], a[48:51]
    v_fmac_f32 v204, v16, v76
    v_fmac_f32 v205, v17, v76
    v_mfma_f32_16x16x32_bf16 a[48:51], a[196:199], v[52:55], a[48:51]
    buffer_load_dwordx4 v122, s[8:11], s48 offen offset:2048 sc1 lds
    v_mfma_f32_16x16x32_bf16 a[72:75], a[196:199], v[60:63], a[72:75]
    v_fmac_f32 v206, v18, v76
    v_fmac_f32 v207, v19, v76
    v_mfma_f32_16x16x32_bf16 a[72:75], a[192:195], v[56:59], a[72:75]
    v_fmac_f32 v220, v20, v76
    v_fmac_f32 v221, v21, v76
    v_mfma_f32_16x16x32_bf16 a[76:79], a[200:203], v[56:59], a[76:79]
    v_fmac_f32 v222, v22, v76
    v_fmac_f32 v223, v23, v76
    v_mfma_f32_16x16x32_bf16 a[76:79], a[204:207], v[60:63], a[76:79]
    v_fmac_f32 v216, v20, v72
    v_fmac_f32 v217, v21, v72
    v_mfma_f32_16x16x32_bf16 a[52:55], a[204:207], v[52:55], a[52:55]
    v_fmac_f32 v218, v22, v72
    v_fmac_f32 v219, v23, v72
    v_mfma_f32_16x16x32_bf16 a[52:55], a[200:203], v[48:51], a[52:55]
    buffer_load_dwordx4 v123, s[8:11], s48 offen offset:3072 sc1 lds
    v_mfma_f32_16x16x32_bf16 a[28:31], a[200:203], v[40:43], a[28:31]
    s_add_u32 m0, s52, 114688
    v_fmac_f32 v212, v20, v68
    v_mfma_f32_16x16x32_bf16 a[28:31], a[204:207], v[44:47], a[28:31]
    v_fmac_f32 v213, v21, v68
    v_fmac_f32 v214, v22, v68
    v_mfma_f32_16x16x32_bf16 a[4:7], a[204:207], v[36:39], a[4:7]
    v_fmac_f32 v215, v23, v68
    v_fmac_f32 v208, v20, v64
    v_mfma_f32_16x16x32_bf16 a[4:7], a[200:203], v[32:35], a[4:7]
    v_fmac_f32 v209, v21, v64
    v_fmac_f32 v210, v22, v64
    v_mfma_f32_16x16x32_bf16 a[8:11], a[208:211], v[32:35], a[8:11]
    v_fmac_f32 v211, v23, v64
    v_fmac_f32 v224, v24, v64
    v_mfma_f32_16x16x32_bf16 a[8:11], a[212:215], v[36:39], a[8:11]
    buffer_load_dwordx4 v124, s[12:15], s43 offen offset:0 sc1 lds
    v_mfma_f32_16x16x32_bf16 a[32:35], a[212:215], v[44:47], a[32:35]
    v_fmac_f32 v225, v25, v64
    v_fmac_f32 v226, v26, v64
    v_mfma_f32_16x16x32_bf16 a[32:35], a[208:211], v[40:43], a[32:35]
    v_fmac_f32 v227, v27, v64
    v_fmac_f32 v228, v24, v68
    v_mfma_f32_16x16x32_bf16 a[56:59], a[208:211], v[48:51], a[56:59]
    v_fmac_f32 v229, v25, v68
    v_fmac_f32 v230, v26, v68
    v_mfma_f32_16x16x32_bf16 a[56:59], a[212:215], v[52:55], a[56:59]
    v_fmac_f32 v231, v27, v68
    v_fmac_f32 v232, v24, v72
    v_mfma_f32_16x16x32_bf16 a[80:83], a[212:215], v[60:63], a[80:83]
    v_fmac_f32 v233, v25, v72
    v_fmac_f32 v234, v26, v72
    v_mfma_f32_16x16x32_bf16 a[80:83], a[208:211], v[56:59], a[80:83]
    buffer_load_dwordx4 v125, s[12:15], s43 offen offset:1024 sc1 lds
    v_mfma_f32_16x16x32_bf16 a[84:87], a[216:219], v[56:59], a[84:87]
    v_fmac_f32 v235, v27, v72
    v_fmac_f32 v236, v24, v76
    v_mfma_f32_16x16x32_bf16 a[84:87], a[220:223], v[60:63], a[84:87]
    v_fmac_f32 v237, v25, v76
    v_fmac_f32 v238, v26, v76
    v_mfma_f32_16x16x32_bf16 a[60:63], a[220:223], v[52:55], a[60:63]
    v_fmac_f32 v239, v27, v76
    v_fmac_f32 v252, v28, v76
    v_mfma_f32_16x16x32_bf16 a[60:63], a[216:219], v[48:51], a[60:63]
    v_fmac_f32 v253, v29, v76
    v_fmac_f32 v254, v30, v76
    v_mfma_f32_16x16x32_bf16 a[36:39], a[216:219], v[40:43], a[36:39]
    v_fmac_f32 v255, v31, v76
    v_fmac_f32 v248, v28, v72
    v_mfma_f32_16x16x32_bf16 a[36:39], a[220:223], v[44:47], a[36:39]
    buffer_load_dwordx4 v124, s[12:15], s43 offen offset:2048 sc1 lds
    v_mfma_f32_16x16x32_bf16 a[12:15], a[220:223], v[36:39], a[12:15]
    v_fmac_f32 v249, v29, v72
    v_fmac_f32 v250, v30, v72
    v_mfma_f32_16x16x32_bf16 a[12:15], a[216:219], v[32:35], a[12:15]
    v_fmac_f32 v251, v31, v72
    v_fmac_f32 v244, v28, v68
    v_mfma_f32_16x16x32_bf16 a[16:19], a[224:227], v[32:35], a[16:19]
    v_fmac_f32 v245, v29, v68
    v_fmac_f32 v246, v30, v68
    v_mfma_f32_16x16x32_bf16 a[16:19], a[228:231], v[36:39], a[16:19]
    v_fmac_f32 v247, v31, v68
    v_fmac_f32 v240, v28, v64
    v_mfma_f32_16x16x32_bf16 a[40:43], a[228:231], v[44:47], a[40:43]
    v_fmac_f32 v241, v29, v64
    v_fmac_f32 v242, v30, v64
    v_mfma_f32_16x16x32_bf16 a[40:43], a[224:227], v[40:43], a[40:43]
    buffer_load_dwordx4 v125, s[12:15], s43 offen offset:3072 sc1 lds
    v_mfma_f32_16x16x32_bf16 a[64:67], a[224:227], v[48:51], a[64:67]
    s_add_u32 s48, s48, s77
    s_add_u32 s43, s43, s58
    v_mfma_f32_16x16x32_bf16 a[64:67], a[228:231], v[52:55], a[64:67]
    v_fmac_f32 v243, v31, v64
    v_mfma_f32_16x16x32_bf16 a[88:91], a[228:231], v[60:63], a[88:91]
    v_mfma_f32_16x16x32_bf16 a[88:91], a[224:227], v[56:59], a[88:91]
    v_mfma_f32_16x16x32_bf16 a[92:95], a[232:235], v[56:59], a[92:95]
    v_mfma_f32_16x16x32_bf16 a[92:95], a[236:239], v[60:63], a[92:95]
    v_mfma_f32_16x16x32_bf16 a[68:71], a[236:239], v[52:55], a[68:71]
    v_mfma_f32_16x16x32_bf16 a[68:71], a[232:235], v[48:51], a[68:71]
    v_mfma_f32_16x16x32_bf16 a[44:47], a[232:235], v[40:43], a[44:47]
    v_mfma_f32_16x16x32_bf16 a[44:47], a[236:239], v[44:47], a[44:47]
    v_mfma_f32_16x16x32_bf16 a[20:23], a[236:239], v[36:39], a[20:23]
    v_mfma_f32_16x16x32_bf16 a[20:23], a[232:235], v[32:35], a[20:23]
    v_pk_mul_f32 v[192:193], v[192:193], v[64:65] op_sel:[0,1] op_sel_hi:[1,1]
    v_pk_mul_f32 v[194:195], v[194:195], v[64:65] op_sel:[0,1] op_sel_hi:[1,1]
    v_cvt_pk_bf16_f32 v8, v192, v193
    v_cvt_pk_bf16_f32 v9, v194, v195
    v_pk_mul_f32 v[208:209], v[208:209], v[64:65] op_sel:[0,1] op_sel_hi:[1,1]
    v_pk_mul_f32 v[210:211], v[210:211], v[64:65] op_sel:[0,1] op_sel_hi:[1,1]
    v_cvt_pk_bf16_f32 v10, v208, v209
    v_cvt_pk_bf16_f32 v11, v210, v211
    v_pk_mul_f32 v[196:197], v[196:197], v[68:69] op_sel:[0,1] op_sel_hi:[1,1]
    v_pk_mul_f32 v[198:199], v[198:199], v[68:69] op_sel:[0,1] op_sel_hi:[1,1]
    v_cvt_pk_bf16_f32 v24, v196, v197
    v_cvt_pk_bf16_f32 v25, v198, v199
    v_pk_mul_f32 v[212:213], v[212:213], v[68:69] op_sel:[0,1] op_sel_hi:[1,1]
    v_pk_mul_f32 v[214:215], v[214:215], v[68:69] op_sel:[0,1] op_sel_hi:[1,1]
    v_cvt_pk_bf16_f32 v26, v212, v213
    v_cvt_pk_bf16_f32 v27, v214, v215
    v_pk_mul_f32 v[200:201], v[200:201], v[72:73] op_sel:[0,1] op_sel_hi:[1,1]
    v_pk_mul_f32 v[202:203], v[202:203], v[72:73] op_sel:[0,1] op_sel_hi:[1,1]
    v_cvt_pk_bf16_f32 v40, v200, v201
    v_cvt_pk_bf16_f32 v41, v202, v203
    v_pk_mul_f32 v[216:217], v[216:217], v[72:73] op_sel:[0,1] op_sel_hi:[1,1]
    v_pk_mul_f32 v[218:219], v[218:219], v[72:73] op_sel:[0,1] op_sel_hi:[1,1]
    v_cvt_pk_bf16_f32 v42, v216, v217
    v_cvt_pk_bf16_f32 v43, v218, v219
    v_pk_mul_f32 v[204:205], v[204:205], v[76:77] op_sel:[0,1] op_sel_hi:[1,1]
    v_pk_mul_f32 v[206:207], v[206:207], v[76:77] op_sel:[0,1] op_sel_hi:[1,1]
    v_cvt_pk_bf16_f32 v56, v204, v205
    v_cvt_pk_bf16_f32 v57, v206, v207
    v_pk_mul_f32 v[220:221], v[220:221], v[76:77] op_sel:[0,1] op_sel_hi:[1,1]
    v_pk_mul_f32 v[222:223], v[222:223], v[76:77] op_sel:[0,1] op_sel_hi:[1,1]
    v_cvt_pk_bf16_f32 v58, v220, v221
    v_cvt_pk_bf16_f32 v59, v222, v223
    s_nop 1
    v_permlane16_swap_b32 v8, v10
    v_permlane16_swap_b32 v9, v11
    v_permlane16_swap_b32 v24, v26
    v_permlane16_swap_b32 v25, v27
    v_permlane16_swap_b32 v40, v42
    v_permlane16_swap_b32 v41, v43
    v_permlane16_swap_b32 v56, v58
    v_permlane16_swap_b32 v57, v59
    v_pk_mul_f32 v[224:225], v[224:225], v[64:65] op_sel:[0,1] op_sel_hi:[1,1]
    v_pk_mul_f32 v[226:227], v[226:227], v[64:65] op_sel:[0,1] op_sel_hi:[1,1]
    v_cvt_pk_bf16_f32 v12, v224, v225
    v_cvt_pk_bf16_f32 v13, v226, v227
    v_pk_mul_f32 v[240:241], v[240:241], v[64:65] op_sel:[0,1] op_sel_hi:[1,1]
    v_pk_mul_f32 v[242:243], v[242:243], v[64:65] op_sel:[0,1] op_sel_hi:[1,1]
    v_cvt_pk_bf16_f32 v14, v240, v241
    v_cvt_pk_bf16_f32 v15, v242, v243
    v_pk_mul_f32 v[228:229], v[228:229], v[68:69] op_sel:[0,1] op_sel_hi:[1,1]
    v_pk_mul_f32 v[230:231], v[230:231], v[68:69] op_sel:[0,1] op_sel_hi:[1,1]
    v_cvt_pk_bf16_f32 v28, v228, v229
    v_cvt_pk_bf16_f32 v29, v230, v231
    v_pk_mul_f32 v[244:245], v[244:245], v[68:69] op_sel:[0,1] op_sel_hi:[1,1]
    v_pk_mul_f32 v[246:247], v[246:247], v[68:69] op_sel:[0,1] op_sel_hi:[1,1]
    v_cvt_pk_bf16_f32 v30, v244, v245
    v_cvt_pk_bf16_f32 v31, v246, v247
    v_pk_mul_f32 v[232:233], v[232:233], v[72:73] op_sel:[0,1] op_sel_hi:[1,1]
    v_pk_mul_f32 v[234:235], v[234:235], v[72:73] op_sel:[0,1] op_sel_hi:[1,1]
    v_cvt_pk_bf16_f32 v44, v232, v233
    v_cvt_pk_bf16_f32 v45, v234, v235
    v_pk_mul_f32 v[248:249], v[248:249], v[72:73] op_sel:[0,1] op_sel_hi:[1,1]
    v_pk_mul_f32 v[250:251], v[250:251], v[72:73] op_sel:[0,1] op_sel_hi:[1,1]
    v_cvt_pk_bf16_f32 v46, v248, v249
    v_cvt_pk_bf16_f32 v47, v250, v251
    v_pk_mul_f32 v[236:237], v[236:237], v[76:77] op_sel:[0,1] op_sel_hi:[1,1]
    v_pk_mul_f32 v[238:239], v[238:239], v[76:77] op_sel:[0,1] op_sel_hi:[1,1]
    v_cvt_pk_bf16_f32 v60, v236, v237
    v_cvt_pk_bf16_f32 v61, v238, v239
    v_pk_mul_f32 v[252:253], v[252:253], v[76:77] op_sel:[0,1] op_sel_hi:[1,1]
    v_pk_mul_f32 v[254:255], v[254:255], v[76:77] op_sel:[0,1] op_sel_hi:[1,1]
    v_cvt_pk_bf16_f32 v62, v252, v253
    v_cvt_pk_bf16_f32 v63, v254, v255
    ds_read_b128 v[208:211], v112 offset:128
    ds_read_b128 v[212:215], v112 offset:8320
    ds_read_b128 v[216:219], v112 offset:16512
    ds_read_b128 v[220:223], v112 offset:192
    ds_read_b128 v[224:227], v112 offset:8384
    ds_read_b128 v[228:231], v112 offset:16576
    v_permlane16_swap_b32 v12, v14
    v_permlane16_swap_b32 v13, v15
    v_permlane16_swap_b32 v28, v30
    v_permlane16_swap_b32 v29, v31
    v_permlane16_swap_b32 v44, v46
    v_permlane16_swap_b32 v45, v47
    v_permlane16_swap_b32 v60, v62
    v_permlane16_swap_b32 v61, v63
    v_pk_mul_f32 v[128:129], v[128:129], v[64:65] op_sel:[0,1] op_sel_hi:[1,1]
    v_pk_mul_f32 v[130:131], v[130:131], v[64:65] op_sel:[0,1] op_sel_hi:[1,1]
    v_cvt_pk_bf16_f32 v0, v128, v129
    v_cvt_pk_bf16_f32 v1, v130, v131
    v_pk_mul_f32 v[144:145], v[144:145], v[64:65] op_sel:[0,1] op_sel_hi:[1,1]
    v_pk_mul_f32 v[146:147], v[146:147], v[64:65] op_sel:[0,1] op_sel_hi:[1,1]
    v_cvt_pk_bf16_f32 v2, v144, v145
    v_cvt_pk_bf16_f32 v3, v146, v147
    v_pk_mul_f32 v[132:133], v[132:133], v[68:69] op_sel:[0,1] op_sel_hi:[1,1]
    v_pk_mul_f32 v[134:135], v[134:135], v[68:69] op_sel:[0,1] op_sel_hi:[1,1]
    v_cvt_pk_bf16_f32 v16, v132, v133
    v_cvt_pk_bf16_f32 v17, v134, v135
    v_pk_mul_f32 v[148:149], v[148:149], v[68:69] op_sel:[0,1] op_sel_hi:[1,1]
    v_pk_mul_f32 v[150:151], v[150:151], v[68:69] op_sel:[0,1] op_sel_hi:[1,1]
    v_cvt_pk_bf16_f32 v18, v148, v149
    v_cvt_pk_bf16_f32 v19, v150, v151
    v_pk_mul_f32 v[136:137], v[136:137], v[72:73] op_sel:[0,1] op_sel_hi:[1,1]
    v_pk_mul_f32 v[138:139], v[138:139], v[72:73] op_sel:[0,1] op_sel_hi:[1,1]
    v_cvt_pk_bf16_f32 v32, v136, v137
    v_cvt_pk_bf16_f32 v33, v138, v139
    v_pk_mul_f32 v[152:153], v[152:153], v[72:73] op_sel:[0,1] op_sel_hi:[1,1]
    v_pk_mul_f32 v[154:155], v[154:155], v[72:73] op_sel:[0,1] op_sel_hi:[1,1]
    v_cvt_pk_bf16_f32 v34, v152, v153
    v_cvt_pk_bf16_f32 v35, v154, v155
    v_pk_mul_f32 v[140:141], v[140:141], v[76:77] op_sel:[0,1] op_sel_hi:[1,1]
    v_pk_mul_f32 v[142:143], v[142:143], v[76:77] op_sel:[0,1] op_sel_hi:[1,1]
    v_cvt_pk_bf16_f32 v48, v140, v141
    v_cvt_pk_bf16_f32 v49, v142, v143
    v_pk_mul_f32 v[156:157], v[156:157], v[76:77] op_sel:[0,1] op_sel_hi:[1,1]
    v_pk_mul_f32 v[158:159], v[158:159], v[76:77] op_sel:[0,1] op_sel_hi:[1,1]
    v_cvt_pk_bf16_f32 v50, v156, v157
    v_cvt_pk_bf16_f32 v51, v158, v159
    s_waitcnt vmcnt(24) lgkmcnt(0)
    s_barrier
    ds_read_b128 v[128:131], v100 offset:0
    ds_read_b128 v[132:135], v101 offset:0
    ds_read_b128 v[136:139], v102 offset:0
    ds_read_b128 v[140:143], v103 offset:0
    ds_read_b128 v[144:147], v103 offset:4096
    ds_read_b128 v[148:151], v102 offset:4096
    ds_read_b128 v[152:155], v101 offset:4096
    ds_read_b128 v[156:159], v100 offset:4096
    ds_read_b64_tr_b16 a[128:129], v104 offset:0
    ds_read_b64_tr_b16 a[130:131], v104 offset:4096
    ds_read_b64_tr_b16 a[132:133], v104 offset:8192
    ds_read_b64_tr_b16 a[134:135], v104 offset:12288
    ds_read_b64_tr_b16 a[136:137], v105 offset:0
    ds_read_b64_tr_b16 a[138:139], v105 offset:4096
    ds_read_b64_tr_b16 a[140:141], v105 offset:8192
    ds_read_b64_tr_b16 a[142:143], v105 offset:12288
    ds_read_b64_tr_b16 a[144:145], v106 offset:0
    ds_read_b64_tr_b16 a[146:147], v106 offset:4096
    ds_read_b64_tr_b16 a[148:149], v106 offset:8192
    ds_read_b64_tr_b16 a[150:151], v106 offset:12288
    ds_read_b64_tr_b16 a[152:153], v107 offset:0
    ds_read_b64_tr_b16 a[154:155], v107 offset:4096
    ds_read_b64_tr_b16 a[156:157], v107 offset:8192
    ds_read_b64_tr_b16 a[158:159], v107 offset:12288
    v_permlane16_swap_b32 v0, v2
    v_permlane16_swap_b32 v1, v3
    v_permlane16_swap_b32 v16, v18
    v_permlane16_swap_b32 v17, v19
    v_permlane16_swap_b32 v32, v34
    v_permlane16_swap_b32 v33, v35
    v_permlane16_swap_b32 v48, v50
    v_permlane16_swap_b32 v49, v51
    v_pk_mul_f32 v[160:161], v[160:161], v[64:65] op_sel:[0,1] op_sel_hi:[1,1]
    v_pk_mul_f32 v[162:163], v[162:163], v[64:65] op_sel:[0,1] op_sel_hi:[1,1]
    v_cvt_pk_bf16_f32 v4, v160, v161
    v_cvt_pk_bf16_f32 v5, v162, v163
    v_pk_mul_f32 v[176:177], v[176:177], v[64:65] op_sel:[0,1] op_sel_hi:[1,1]
    v_pk_mul_f32 v[178:179], v[178:179], v[64:65] op_sel:[0,1] op_sel_hi:[1,1]
    v_cvt_pk_bf16_f32 v6, v176, v177
    v_cvt_pk_bf16_f32 v7, v178, v179
    v_pk_mul_f32 v[164:165], v[164:165], v[68:69] op_sel:[0,1] op_sel_hi:[1,1]
    v_pk_mul_f32 v[166:167], v[166:167], v[68:69] op_sel:[0,1] op_sel_hi:[1,1]
    v_cvt_pk_bf16_f32 v20, v164, v165
    v_cvt_pk_bf16_f32 v21, v166, v167
    v_pk_mul_f32 v[180:181], v[180:181], v[68:69] op_sel:[0,1] op_sel_hi:[1,1]
    v_pk_mul_f32 v[182:183], v[182:183], v[68:69] op_sel:[0,1] op_sel_hi:[1,1]
    v_cvt_pk_bf16_f32 v22, v180, v181
    v_cvt_pk_bf16_f32 v23, v182, v183
    v_pk_mul_f32 v[168:169], v[168:169], v[72:73] op_sel:[0,1] op_sel_hi:[1,1]
    v_pk_mul_f32 v[170:171], v[170:171], v[72:73] op_sel:[0,1] op_sel_hi:[1,1]
    v_cvt_pk_bf16_f32 v36, v168, v169
    v_cvt_pk_bf16_f32 v37, v170, v171
    v_pk_mul_f32 v[184:185], v[184:185], v[72:73] op_sel:[0,1] op_sel_hi:[1,1]
    v_pk_mul_f32 v[186:187], v[186:187], v[72:73] op_sel:[0,1] op_sel_hi:[1,1]
    v_cvt_pk_bf16_f32 v38, v184, v185
    v_cvt_pk_bf16_f32 v39, v186, v187
    v_pk_mul_f32 v[172:173], v[172:173], v[76:77] op_sel:[0,1] op_sel_hi:[1,1]
    v_pk_mul_f32 v[174:175], v[174:175], v[76:77] op_sel:[0,1] op_sel_hi:[1,1]
    v_cvt_pk_bf16_f32 v52, v172, v173
    v_cvt_pk_bf16_f32 v53, v174, v175
    v_pk_mul_f32 v[188:189], v[188:189], v[76:77] op_sel:[0,1] op_sel_hi:[1,1]
    v_pk_mul_f32 v[190:191], v[190:191], v[76:77] op_sel:[0,1] op_sel_hi:[1,1]
    v_cvt_pk_bf16_f32 v54, v188, v189
    v_cvt_pk_bf16_f32 v55, v190, v191
    ds_read_b128 v[160:163], v100 offset:8192
    ds_read_b128 v[164:167], v101 offset:8192
    ds_read_b128 v[168:171], v102 offset:8192
    ds_read_b128 v[172:175], v103 offset:8192
    ds_read_b128 v[176:179], v103 offset:12288
    ds_read_b128 v[180:183], v102 offset:12288
    ds_read_b128 v[184:187], v101 offset:12288
    ds_read_b128 v[188:191], v100 offset:12288
    ds_read_b64_tr_b16 a[160:161], v108 offset:0
    ds_read_b64_tr_b16 a[162:163], v108 offset:4096
    ds_read_b64_tr_b16 a[164:165], v108 offset:8192
    ds_read_b64_tr_b16 a[166:167], v108 offset:12288
    ds_read_b64_tr_b16 a[168:169], v109 offset:0
    ds_read_b64_tr_b16 a[170:171], v109 offset:4096
    ds_read_b64_tr_b16 a[172:173], v109 offset:8192
    ds_read_b64_tr_b16 a[174:175], v109 offset:12288
    ds_read_b64_tr_b16 a[176:177], v110 offset:0
    ds_read_b64_tr_b16 a[178:179], v110 offset:4096
    ds_read_b64_tr_b16 a[180:181], v110 offset:8192
    ds_read_b64_tr_b16 a[182:183], v110 offset:12288
    ds_read_b64_tr_b16 a[184:185], v111 offset:0
    ds_read_b64_tr_b16 a[186:187], v111 offset:4096
    ds_read_b64_tr_b16 a[188:189], v111 offset:8192
    ds_read_b64_tr_b16 a[190:191], v111 offset:12288
    v_permlane16_swap_b32 v4, v6
    v_permlane16_swap_b32 v5, v7
    v_permlane16_swap_b32 v20, v22
    v_permlane16_swap_b32 v21, v23
    v_permlane16_swap_b32 v36, v38
    v_permlane16_swap_b32 v37, v39
    v_permlane16_swap_b32 v52, v54
    v_permlane16_swap_b32 v53, v55
    v_mov_b32 v240, 0
    v_mov_b32 v241, 0
    v_mov_b32 v242, 0
    v_mov_b32 v243, 0
    v_mov_b32 v244, 0
    v_mov_b32 v245, 0
    v_mov_b32 v246, 0
    v_mov_b32 v247, 0
    v_mov_b32 v248, 0
    v_mov_b32 v249, 0
    v_mov_b32 v250, 0
    v_mov_b32 v251, 0
    v_mov_b32 v252, 0
    v_mov_b32 v253, 0
    v_mov_b32 v254, 0
    v_mov_b32 v255, 0
    s_waitcnt lgkmcnt(15)
    v_mfma_f32_16x16x32_bf16 v[192:195], v[128:131], v[0:3], 0
    v_accvgpr_read_b32 v80, a8
    v_accvgpr_read_b32 v81, a9
    v_accvgpr_read_b32 v82, a10
    v_accvgpr_read_b32 v83, a11
    v_mfma_f32_16x16x32_bf16 v[192:195], v[132:135], v[4:7], v[192:195]
    v_accvgpr_read_b32 v84, a20
    v_accvgpr_read_b32 v85, a21
    v_accvgpr_read_b32 v86, a22
    v_accvgpr_read_b32 v87, a23
    v_pk_fma_f32 v[80:81], v[216:217], v[64:65], v[80:81] op_sel_hi:[1,0,1]
    v_pk_fma_f32 v[82:83], v[218:219], v[64:65], v[82:83] op_sel_hi:[1,0,1]
    v_pk_mul_f32 v[80:81], v[80:81], v[66:67] op_sel_hi:[1,0]
    v_pk_mul_f32 v[82:83], v[82:83], v[66:67] op_sel_hi:[1,0]
    v_mfma_f32_16x16x32_bf16 v[192:195], v[136:139], v[8:11], v[192:195]
    v_exp_f32 v80, v80
    v_exp_f32 v81, v81
    v_exp_f32 v82, v82
    v_exp_f32 v83, v83
    v_pk_fma_f32 v[80:81], v[80:81], v[66:67], v[66:67] op_sel:[0,1,1] op_sel_hi:[1,1,1]
    v_pk_fma_f32 v[82:83], v[82:83], v[66:67], v[66:67] op_sel:[0,1,1] op_sel_hi:[1,1,1]
    v_mfma_f32_16x16x32_bf16 v[192:195], v[140:143], v[12:15], v[192:195]
    v_rcp_f32 v80, v80
    v_rcp_f32 v81, v81
    v_rcp_f32 v82, v82
    v_rcp_f32 v83, v83
    v_pk_fma_f32 v[84:85], v[228:229], v[64:65], v[84:85] op_sel_hi:[1,0,1]
    v_pk_fma_f32 v[86:87], v[230:231], v[64:65], v[86:87] op_sel_hi:[1,0,1]
    v_pk_mul_f32 v[84:85], v[84:85], v[80:81]
    v_pk_mul_f32 v[86:87], v[86:87], v[82:83]
    v_cvt_pk_bf16_f32 v236, v84, v85
    v_cvt_pk_bf16_f32 v237, v86, v87
    buffer_store_dwordx2 v[236:237], v118, s[28:31], s61 offen offset:0 sc1
    v_mfma_f32_16x16x32_bf16 v[196:199], v[128:131], v[16:19], 0
    v_accvgpr_read_b32 v88, a0
    v_accvgpr_read_b32 v89, a1
    v_accvgpr_read_b32 v90, a2
    v_accvgpr_read_b32 v91, a3
    v_mfma_f32_16x16x32_bf16 v[196:199], v[132:135], v[20:23], v[196:199]
    v_accvgpr_read_b32 v92, a12
    v_accvgpr_read_b32 v93, a13
    v_accvgpr_read_b32 v94, a14
    v_accvgpr_read_b32 v95, a15
    v_pk_fma_f32 v[88:89], v[208:209], v[64:65], v[88:89] op_sel_hi:[1,0,1]
    v_pk_fma_f32 v[90:91], v[210:211], v[64:65], v[90:91] op_sel_hi:[1,0,1]
    v_pk_mul_f32 v[88:89], v[88:89], v[66:67] op_sel_hi:[1,0]
    v_pk_mul_f32 v[90:91], v[90:91], v[66:67] op_sel_hi:[1,0]
    v_mfma_f32_16x16x32_bf16 v[196:199], v[136:139], v[24:27], v[196:199]
    v_exp_f32 v88, v88
    v_exp_f32 v89, v89
    v_exp_f32 v90, v90
    v_exp_f32 v91, v91
    v_pk_fma_f32 v[88:89], v[88:89], v[66:67], v[66:67] op_sel:[0,1,1] op_sel_hi:[1,1,1]
    v_pk_fma_f32 v[90:91], v[90:91], v[66:67], v[66:67] op_sel:[0,1,1] op_sel_hi:[1,1,1]
    v_mfma_f32_16x16x32_bf16 v[196:199], v[140:143], v[28:31], v[196:199]
    v_rcp_f32 v88, v88
    v_rcp_f32 v89, v89
    v_rcp_f32 v90, v90
    v_rcp_f32 v91, v91
    v_pk_fma_f32 v[92:93], v[220:221], v[64:65], v[92:93] op_sel_hi:[1,0,1]
    v_pk_fma_f32 v[94:95], v[222:223], v[64:65], v[94:95] op_sel_hi:[1,0,1]
    v_pk_mul_f32 v[92:93], v[92:93], v[88:89]
    v_pk_mul_f32 v[94:95], v[94:95], v[90:91]
    v_cvt_pk_bf16_f32 v232, v92, v93
    v_cvt_pk_bf16_f32 v233, v94, v95
    v_mfma_f32_16x16x32_bf16 v[200:203], v[128:131], v[32:35], 0
    v_accvgpr_read_b32 v80, a4
    v_accvgpr_read_b32 v81, a5
    v_accvgpr_read_b32 v82, a6
    v_accvgpr_read_b32 v83, a7
    v_mfma_f32_16x16x32_bf16 v[200:203], v[132:135], v[36:39], v[200:203]
    v_accvgpr_read_b32 v84, a16
    v_accvgpr_read_b32 v85, a17
    v_accvgpr_read_b32 v86, a18
    v_accvgpr_read_b32 v87, a19
    v_pk_fma_f32 v[80:81], v[212:213], v[64:65], v[80:81] op_sel_hi:[1,0,1]
    v_pk_fma_f32 v[82:83], v[214:215], v[64:65], v[82:83] op_sel_hi:[1,0,1]
    v_pk_mul_f32 v[80:81], v[80:81], v[66:67] op_sel_hi:[1,0]
    v_pk_mul_f32 v[82:83], v[82:83], v[66:67] op_sel_hi:[1,0]
    v_mfma_f32_16x16x32_bf16 v[200:203], v[136:139], v[40:43], v[200:203]
    v_exp_f32 v80, v80
    v_exp_f32 v81, v81
    v_exp_f32 v82, v82
    v_exp_f32 v83, v83
    v_pk_fma_f32 v[80:81], v[80:81], v[66:67], v[66:67] op_sel:[0,1,1] op_sel_hi:[1,1,1]
    v_pk_fma_f32 v[82:83], v[82:83], v[66:67], v[66:67] op_sel:[0,1,1] op_sel_hi:[1,1,1]
    v_mfma_f32_16x16x32_bf16 v[200:203], v[140:143], v[44:47], v[200:203]
    v_rcp_f32 v80, v80
    v_rcp_f32 v81, v81
    v_rcp_f32 v82, v82
    v_rcp_f32 v83, v83
    v_pk_fma_f32 v[84:85], v[224:225], v[64:65], v[84:85] op_sel_hi:[1,0,1]
    v_pk_fma_f32 v[86:87], v[226:227], v[64:65], v[86:87] op_sel_hi:[1,0,1]
    v_pk_mul_f32 v[84:85], v[84:85], v[80:81]
    v_pk_mul_f32 v[86:87], v[86:87], v[82:83]
    v_cvt_pk_bf16_f32 v234, v84, v85
    v_cvt_pk_bf16_f32 v235, v86, v87
    buffer_store_dwordx4 v[232:235], v118, s[28:31], s60 offen offset:0 sc1
    v_mfma_f32_16x16x32_bf16 v[204:207], v[128:131], v[48:51], 0
    v_accvgpr_read_b32 v88, a32
    v_accvgpr_read_b32 v89, a33
    v_accvgpr_read_b32 v90, a34
    v_accvgpr_read_b32 v91, a35
    v_mfma_f32_16x16x32_bf16 v[204:207], v[132:135], v[52:55], v[204:207]
    v_accvgpr_read_b32 v92, a44
    v_accvgpr_read_b32 v93, a45
    v_accvgpr_read_b32 v94, a46
    v_accvgpr_read_b32 v95, a47
    v_pk_fma_f32 v[88:89], v[216:217], v[68:69], v[88:89] op_sel_hi:[1,0,1]
    v_pk_fma_f32 v[90:91], v[218:219], v[68:69], v[90:91] op_sel_hi:[1,0,1]
    v_pk_mul_f32 v[88:89], v[88:89], v[70:71] op_sel_hi:[1,0]
    v_pk_mul_f32 v[90:91], v[90:91], v[70:71] op_sel_hi:[1,0]
    v_mfma_f32_16x16x32_bf16 v[204:207], v[136:139], v[56:59], v[204:207]
    v_exp_f32 v88, v88
    v_exp_f32 v89, v89
    v_exp_f32 v90, v90
    v_exp_f32 v91, v91
    v_pk_fma_f32 v[88:89], v[88:89], v[70:71], v[70:71] op_sel:[0,1,1] op_sel_hi:[1,1,1]
    v_pk_fma_f32 v[90:91], v[90:91], v[70:71], v[70:71] op_sel:[0,1,1] op_sel_hi:[1,1,1]
    v_mfma_f32_16x16x32_bf16 v[204:207], v[140:143], v[60:63], v[204:207]
    v_rcp_f32 v88, v88
    v_rcp_f32 v89, v89
    v_rcp_f32 v90, v90
    v_rcp_f32 v91, v91
    v_pk_fma_f32 v[92:93], v[228:229], v[68:69], v[92:93] op_sel_hi:[1,0,1]
    v_pk_fma_f32 v[94:95], v[230:231], v[68:69], v[94:95] op_sel_hi:[1,0,1]
    v_pk_mul_f32 v[92:93], v[92:93], v[88:89]
    v_pk_mul_f32 v[94:95], v[94:95], v[90:91]
    v_cvt_pk_bf16_f32 v236, v92, v93
    v_cvt_pk_bf16_f32 v237, v94, v95
    buffer_store_dwordx2 v[236:237], v118, s[28:31], s61 offen offset:1024 sc1
    v_mfma_f32_32x32x16_bf16 a[112:127], v[240:243], v[240:243], 0
    v_accvgpr_read_b32 v80, a24
    v_accvgpr_read_b32 v81, a25
    v_accvgpr_read_b32 v82, a26
    v_accvgpr_read_b32 v83, a27
    v_accvgpr_read_b32 v84, a36
    v_accvgpr_read_b32 v85, a37
    v_accvgpr_read_b32 v86, a38
    v_accvgpr_read_b32 v87, a39
    v_pk_fma_f32 v[80:81], v[208:209], v[68:69], v[80:81] op_sel_hi:[1,0,1]
    v_pk_fma_f32 v[82:83], v[210:211], v[68:69], v[82:83] op_sel_hi:[1,0,1]
    v_pk_mul_f32 v[80:81], v[80:81], v[70:71] op_sel_hi:[1,0]
    v_pk_mul_f32 v[82:83], v[82:83], v[70:71] op_sel_hi:[1,0]
    v_mfma_f32_32x32x16_bf16 a[96:111], v[240:243], v[240:243], 0
    v_exp_f32 v80, v80
    v_exp_f32 v81, v81
    v_exp_f32 v82, v82
    v_exp_f32 v83, v83
    v_pk_fma_f32 v[80:81], v[80:81], v[70:71], v[70:71] op_sel:[0,1,1] op_sel_hi:[1,1,1]
    v_pk_fma_f32 v[82:83], v[82:83], v[70:71], v[70:71] op_sel:[0,1,1] op_sel_hi:[1,1,1]
    v_rcp_f32 v80, v80
    v_rcp_f32 v81, v81
    v_rcp_f32 v82, v82
    v_rcp_f32 v83, v83
    v_pk_fma_f32 v[84:85], v[220:221], v[68:69], v[84:85] op_sel_hi:[1,0,1]
    v_pk_fma_f32 v[86:87], v[222:223], v[68:69], v[86:87] op_sel_hi:[1,0,1]
    v_pk_mul_f32 v[84:85], v[84:85], v[80:81]
    v_pk_mul_f32 v[86:87], v[86:87], v[82:83]
    v_cvt_pk_bf16_f32 v232, v84, v85
    v_cvt_pk_bf16_f32 v233, v86, v87
    v_mfma_f32_32x32x16_bf16 a[0:15], v[240:243], v[240:243], 0
    v_accvgpr_read_b32 v88, a28
    v_accvgpr_read_b32 v89, a29
    v_accvgpr_read_b32 v90, a30
    v_accvgpr_read_b32 v91, a31
    v_accvgpr_read_b32 v92, a40
    v_accvgpr_read_b32 v93, a41
    v_accvgpr_read_b32 v94, a42
    v_accvgpr_read_b32 v95, a43
    v_pk_fma_f32 v[88:89], v[212:213], v[68:69], v[88:89] op_sel_hi:[1,0,1]
    v_pk_fma_f32 v[90:91], v[214:215], v[68:69], v[90:91] op_sel_hi:[1,0,1]
    v_pk_mul_f32 v[88:89], v[88:89], v[70:71] op_sel_hi:[1,0]
    v_pk_mul_f32 v[90:91], v[90:91], v[70:71] op_sel_hi:[1,0]
    v_exp_f32 v88, v88
    v_exp_f32 v89, v89
    v_exp_f32 v90, v90
    v_exp_f32 v91, v91
    v_pk_fma_f32 v[88:89], v[88:89], v[70:71], v[70:71] op_sel:[0,1,1] op_sel_hi:[1,1,1]
    v_pk_fma_f32 v[90:91], v[90:91], v[70:71], v[70:71] op_sel:[0,1,1] op_sel_hi:[1,1,1]
    v_rcp_f32 v88, v88
    v_rcp_f32 v89, v89
    v_rcp_f32 v90, v90
    v_rcp_f32 v91, v91
    v_pk_fma_f32 v[92:93], v[224:225], v[68:69], v[92:93] op_sel_hi:[1,0,1]
    v_pk_fma_f32 v[94:95], v[226:227], v[68:69], v[94:95] op_sel_hi:[1,0,1]
    v_pk_mul_f32 v[92:93], v[92:93], v[88:89]
    v_pk_mul_f32 v[94:95], v[94:95], v[90:91]
    v_cvt_pk_bf16_f32 v234, v92, v93
    v_cvt_pk_bf16_f32 v235, v94, v95
    buffer_store_dwordx4 v[232:235], v118, s[28:31], s60 offen offset:1024 sc1
    v_mfma_f32_32x32x16_bf16 a[16:31], v[240:243], v[240:243], 0
    v_accvgpr_read_b32 v80, a56
    v_accvgpr_read_b32 v81, a57
    v_accvgpr_read_b32 v82, a58
    v_accvgpr_read_b32 v83, a59
    v_accvgpr_read_b32 v84, a68
    v_accvgpr_read_b32 v85, a69
    v_accvgpr_read_b32 v86, a70
    v_accvgpr_read_b32 v87, a71
    v_pk_fma_f32 v[80:81], v[216:217], v[72:73], v[80:81] op_sel_hi:[1,0,1]
    v_pk_fma_f32 v[82:83], v[218:219], v[72:73], v[82:83] op_sel_hi:[1,0,1]
    v_pk_mul_f32 v[80:81], v[80:81], v[74:75] op_sel_hi:[1,0]
    v_pk_mul_f32 v[82:83], v[82:83], v[74:75] op_sel_hi:[1,0]
    v_mfma_f32_32x32x16_bf16 a[32:47], v[240:243], v[240:243], 0
    v_exp_f32 v80, v80
    v_exp_f32 v81, v81
    v_exp_f32 v82, v82
    v_exp_f32 v83, v83
    v_pk_fma_f32 v[80:81], v[80:81], v[74:75], v[74:75] op_sel:[0,1,1] op_sel_hi:[1,1,1]
    v_pk_fma_f32 v[82:83], v[82:83], v[74:75], v[74:75] op_sel:[0,1,1] op_sel_hi:[1,1,1]
    v_rcp_f32 v80, v80
    v_rcp_f32 v81, v81
    v_rcp_f32 v82, v82
    v_rcp_f32 v83, v83
    v_pk_fma_f32 v[84:85], v[228:229], v[72:73], v[84:85] op_sel_hi:[1,0,1]
    v_pk_fma_f32 v[86:87], v[230:231], v[72:73], v[86:87] op_sel_hi:[1,0,1]
    v_pk_mul_f32 v[84:85], v[84:85], v[80:81]
    v_pk_mul_f32 v[86:87], v[86:87], v[82:83]
    v_cvt_pk_bf16_f32 v236, v84, v85
    v_cvt_pk_bf16_f32 v237, v86, v87
    buffer_store_dwordx2 v[236:237], v118, s[28:31], s61 offen offset:2048 sc1
    v_accvgpr_read_b32 v88, a48
    v_accvgpr_read_b32 v89, a49
    v_accvgpr_read_b32 v90, a50
    v_accvgpr_read_b32 v91, a51
    v_accvgpr_read_b32 v92, a60
    v_accvgpr_read_b32 v93, a61
    v_accvgpr_read_b32 v94, a62
    v_accvgpr_read_b32 v95, a63
    v_pk_fma_f32 v[88:89], v[208:209], v[72:73], v[88:89] op_sel_hi:[1,0,1]
    v_pk_fma_f32 v[90:91], v[210:211], v[72:73], v[90:91] op_sel_hi:[1,0,1]
    v_pk_mul_f32 v[88:89], v[88:89], v[74:75] op_sel_hi:[1,0]
    v_pk_mul_f32 v[90:91], v[90:91], v[74:75] op_sel_hi:[1,0]
    v_exp_f32 v88, v88
    v_exp_f32 v89, v89
    v_exp_f32 v90, v90
    v_exp_f32 v91, v91
    v_pk_fma_f32 v[88:89], v[88:89], v[74:75], v[74:75] op_sel:[0,1,1] op_sel_hi:[1,1,1]
    v_pk_fma_f32 v[90:91], v[90:91], v[74:75], v[74:75] op_sel:[0,1,1] op_sel_hi:[1,1,1]
    v_rcp_f32 v88, v88
    v_rcp_f32 v89, v89
    v_rcp_f32 v90, v90
    v_rcp_f32 v91, v91
    v_pk_fma_f32 v[92:93], v[220:221], v[72:73], v[92:93] op_sel_hi:[1,0,1]
    v_pk_fma_f32 v[94:95], v[222:223], v[72:73], v[94:95] op_sel_hi:[1,0,1]
    v_pk_mul_f32 v[92:93], v[92:93], v[88:89]
    v_pk_mul_f32 v[94:95], v[94:95], v[90:91]
    v_cvt_pk_bf16_f32 v232, v92, v93
    v_cvt_pk_bf16_f32 v233, v94, v95
    v_accvgpr_read_b32 v80, a52
    v_accvgpr_read_b32 v81, a53
    v_accvgpr_read_b32 v82, a54
    v_accvgpr_read_b32 v83, a55
    v_accvgpr_read_b32 v84, a64
    v_accvgpr_read_b32 v85, a65
    v_accvgpr_read_b32 v86, a66
    v_accvgpr_read_b32 v87, a67
    v_pk_fma_f32 v[80:81], v[212:213], v[72:73], v[80:81] op_sel_hi:[1,0,1]
    v_pk_fma_f32 v[82:83], v[214:215], v[72:73], v[82:83] op_sel_hi:[1,0,1]
    v_pk_mul_f32 v[80:81], v[80:81], v[74:75] op_sel_hi:[1,0]
    v_pk_mul_f32 v[82:83], v[82:83], v[74:75] op_sel_hi:[1,0]
    v_exp_f32 v80, v80
    v_exp_f32 v81, v81
    v_exp_f32 v82, v82
    v_exp_f32 v83, v83
    v_pk_fma_f32 v[80:81], v[80:81], v[74:75], v[74:75] op_sel:[0,1,1] op_sel_hi:[1,1,1]
    v_pk_fma_f32 v[82:83], v[82:83], v[74:75], v[74:75] op_sel:[0,1,1] op_sel_hi:[1,1,1]
    v_rcp_f32 v80, v80
    v_rcp_f32 v81, v81
    v_rcp_f32 v82, v82
    v_rcp_f32 v83, v83
    v_pk_fma_f32 v[84:85], v[224:225], v[72:73], v[84:85] op_sel_hi:[1,0,1]
    v_pk_fma_f32 v[86:87], v[226:227], v[72:73], v[86:87] op_sel_hi:[1,0,1]
    v_pk_mul_f32 v[84:85], v[84:85], v[80:81]
    v_pk_mul_f32 v[86:87], v[86:87], v[82:83]
    v_cvt_pk_bf16_f32 v234, v84, v85
    v_cvt_pk_bf16_f32 v235, v86, v87
    buffer_store_dwordx4 v[232:235], v118, s[28:31], s60 offen offset:2048 sc1
    v_mfma_f32_32x32x16_bf16 a[48:63], v[240:243], v[240:243], 0
    v_accvgpr_read_b32 v88, a80
    v_accvgpr_read_b32 v89, a81
    v_accvgpr_read_b32 v90, a82
    v_accvgpr_read_b32 v91, a83
    v_accvgpr_read_b32 v92, a92
    v_accvgpr_read_b32 v93, a93
    v_accvgpr_read_b32 v94, a94
    v_accvgpr_read_b32 v95, a95
    v_pk_fma_f32 v[88:89], v[216:217], v[76:77], v[88:89] op_sel_hi:[1,0,1]
    v_pk_fma_f32 v[90:91], v[218:219], v[76:77], v[90:91] op_sel_hi:[1,0,1]
    v_pk_mul_f32 v[88:89], v[88:89], v[78:79] op_sel_hi:[1,0]
    v_pk_mul_f32 v[90:91], v[90:91], v[78:79] op_sel_hi:[1,0]
    v_exp_f32 v88, v88
    v_exp_f32 v89, v89
    v_exp_f32 v90, v90
    v_exp_f32 v91, v91
    v_pk_fma_f32 v[88:89], v[88:89], v[78:79], v[78:79] op_sel:[0,1,1] op_sel_hi:[1,1,1]
    v_pk_fma_f32 v[90:91], v[90:91], v[78:79], v[78:79] op_sel:[0,1,1] op_sel_hi:[1,1,1]
    v_rcp_f32 v88, v88
    v_rcp_f32 v89, v89
    v_rcp_f32 v90, v90
    v_rcp_f32 v91, v91
    v_pk_fma_f32 v[92:93], v[228:229], v[76:77], v[92:93] op_sel_hi:[1,0,1]
    v_pk_fma_f32 v[94:95], v[230:231], v[76:77], v[94:95] op_sel_hi:[1,0,1]
    v_pk_mul_f32 v[92:93], v[92:93], v[88:89]
    v_pk_mul_f32 v[94:95], v[94:95], v[90:91]
    v_cvt_pk_bf16_f32 v236, v92, v93
    v_cvt_pk_bf16_f32 v237, v94, v95
    buffer_store_dwordx2 v[236:237], v118, s[28:31], s61 offen offset:3072 sc1
    v_accvgpr_read_b32 v80, a72
    v_accvgpr_read_b32 v81, a73
    v_accvgpr_read_b32 v82, a74
    v_accvgpr_read_b32 v83, a75
    v_accvgpr_read_b32 v84, a84
    v_accvgpr_read_b32 v85, a85
    v_accvgpr_read_b32 v86, a86
    v_accvgpr_read_b32 v87, a87
    v_pk_fma_f32 v[80:81], v[208:209], v[76:77], v[80:81] op_sel_hi:[1,0,1]
    v_pk_fma_f32 v[82:83], v[210:211], v[76:77], v[82:83] op_sel_hi:[1,0,1]
    v_pk_mul_f32 v[80:81], v[80:81], v[78:79] op_sel_hi:[1,0]
    v_pk_mul_f32 v[82:83], v[82:83], v[78:79] op_sel_hi:[1,0]
    v_exp_f32 v80, v80
    v_exp_f32 v81, v81
    v_exp_f32 v82, v82
    v_exp_f32 v83, v83
    v_pk_fma_f32 v[80:81], v[80:81], v[78:79], v[78:79] op_sel:[0,1,1] op_sel_hi:[1,1,1]
    v_pk_fma_f32 v[82:83], v[82:83], v[78:79], v[78:79] op_sel:[0,1,1] op_sel_hi:[1,1,1]
    v_rcp_f32 v80, v80
    v_rcp_f32 v81, v81
    v_rcp_f32 v82, v82
    v_rcp_f32 v83, v83
    v_pk_fma_f32 v[84:85], v[220:221], v[76:77], v[84:85] op_sel_hi:[1,0,1]
    v_pk_fma_f32 v[86:87], v[222:223], v[76:77], v[86:87] op_sel_hi:[1,0,1]
    v_pk_mul_f32 v[84:85], v[84:85], v[80:81]
    v_pk_mul_f32 v[86:87], v[86:87], v[82:83]
    v_cvt_pk_bf16_f32 v232, v84, v85
    v_cvt_pk_bf16_f32 v233, v86, v87
    v_accvgpr_read_b32 v88, a76
    v_accvgpr_read_b32 v89, a77
    v_accvgpr_read_b32 v90, a78
    v_accvgpr_read_b32 v91, a79
    v_accvgpr_read_b32 v92, a88
    v_accvgpr_read_b32 v93, a89
    v_accvgpr_read_b32 v94, a90
    v_accvgpr_read_b32 v95, a91
    v_pk_fma_f32 v[88:89], v[212:213], v[76:77], v[88:89] op_sel_hi:[1,0,1]
    v_pk_fma_f32 v[90:91], v[214:215], v[76:77], v[90:91] op_sel_hi:[1,0,1]
    v_pk_mul_f32 v[88:89], v[88:89], v[78:79] op_sel_hi:[1,0]
    v_pk_mul_f32 v[90:91], v[90:91], v[78:79] op_sel_hi:[1,0]
    v_exp_f32 v88, v88
    v_exp_f32 v89, v89
    v_exp_f32 v90, v90
    v_exp_f32 v91, v91
    v_pk_fma_f32 v[88:89], v[88:89], v[78:79], v[78:79] op_sel:[0,1,1] op_sel_hi:[1,1,1]
    v_pk_fma_f32 v[90:91], v[90:91], v[78:79], v[78:79] op_sel:[0,1,1] op_sel_hi:[1,1,1]
    v_rcp_f32 v88, v88
    v_rcp_f32 v89, v89
    v_rcp_f32 v90, v90
    v_rcp_f32 v91, v91
    v_pk_fma_f32 v[92:93], v[224:225], v[76:77], v[92:93] op_sel_hi:[1,0,1]
    v_pk_fma_f32 v[94:95], v[226:227], v[76:77], v[94:95] op_sel_hi:[1,0,1]
    v_pk_mul_f32 v[92:93], v[92:93], v[88:89]
    v_pk_mul_f32 v[94:95], v[94:95], v[90:91]
    v_cvt_pk_bf16_f32 v234, v92, v93
    v_cvt_pk_bf16_f32 v235, v94, v95
    buffer_store_dwordx4 v[232:235], v118, s[28:31], s60 offen offset:3072 sc1
    v_mfma_f32_32x32x16_bf16 a[64:79], v[240:243], v[240:243], 0
    v_mfma_f32_32x32x16_bf16 a[80:95], v[240:243], v[240:243], 0
    v_max3_f32 v192, v192, v193, v194
    v_max_f32 v192, v192, v195
    v_max3_f32 v196, v196, v197, v198
    v_max_f32 v196, v196, v199
    v_max3_f32 v200, v200, v201, v202
    v_max_f32 v200, v200, v203
    v_max3_f32 v204, v204, v205, v206
    v_max_f32 v204, v204, v207
    v_mov_b32 v193, v192
    v_mov_b32 v197, v196
    v_mov_b32 v201, v200
    v_mov_b32 v205, v204
    v_permlane32_swap_b32 v192, v193
    v_permlane32_swap_b32 v196, v197
    v_permlane32_swap_b32 v200, v201
    v_permlane32_swap_b32 v204, v205
    v_max_f32 v192, v192, v193
    v_max_f32 v196, v196, v197
    v_max_f32 v200, v200, v201
    v_max_f32 v204, v204, v205
    v_mov_b32 v193, v192
    v_mov_b32 v197, v196
    v_mov_b32 v201, v200
    v_mov_b32 v205, v204
    v_permlane16_swap_b32 v192, v193
    v_permlane16_swap_b32 v196, v197
    v_permlane16_swap_b32 v200, v201
    v_permlane16_swap_b32 v204, v205
    v_max_f32 v192, v192, v193
    v_max_f32 v196, v196, v197
    v_max_f32 v200, v200, v201
    v_max_f32 v204, v204, v205
    v_sub_f32 v224, 0, v192
    v_sub_f32 v225, 0, v192
    v_sub_f32 v226, 0, v192
    v_sub_f32 v227, 0, v192
    v_sub_f32 v228, 0, v196
    v_sub_f32 v229, 0, v196
    v_sub_f32 v230, 0, v196
    v_sub_f32 v231, 0, v196
    v_sub_f32 v232, 0, v200
    v_sub_f32 v233, 0, v200
    v_sub_f32 v234, 0, v200
    v_sub_f32 v235, 0, v200
    v_sub_f32 v236, 0, v204
    v_sub_f32 v237, 0, v204
    v_sub_f32 v238, 0, v204
    v_sub_f32 v239, 0, v204
K1_HAVEMAX:
    s_waitcnt lgkmcnt(0)
    v_mfma_f32_16x16x32_bf16 v[192:195], v[128:131], v[0:3], v[224:227]
    s_mov_b32 s54, 0
    v_mfma_f32_16x16x32_bf16 v[192:195], v[132:135], v[4:7], v[192:195]
    s_cmp_lg_u32 s59, 0
    s_cselect_b32 s56, 7, 1
    v_mfma_f32_16x16x32_bf16 v[192:195], v[136:139], v[8:11], v[192:195]
    s_mov_b32 s16, s72
    s_mov_b32 s17, s73
    v_mfma_f32_16x16x32_bf16 v[192:195], v[140:143], v[12:15], v[192:195]
    s_mov_b32 s18, 4194304
    s_mov_b32 s19, 0x00020000
    v_mfma_f32_16x16x32_bf16 v[196:199], v[144:147], v[12:15], v[224:227]
    s_mov_b32 s20, s80
    s_mov_b32 s21, s81
    v_mfma_f32_16x16x32_bf16 v[196:199], v[148:151], v[8:11], v[196:199]
    s_mov_b32 s22, 1409024
    s_mov_b32 s23, 0x00020000
    v_mfma_f32_16x16x32_bf16 v[196:199], v[152:155], v[4:7], v[196:199]
    v_lshlrev_b32 v90, 7, v126
    v_min_u32 v91, 256, v90
    v_mfma_f32_16x16x32_bf16 v[196:199], v[156:159], v[0:3], v[196:199]
    v_min_u32 v90, 384, v90
    v_mov_b32 v80, -1
    v_mfma_f32_16x16x32_bf16 v[200:203], v[160:163], v[0:3], v[224:227]
    v_exp_f32 v192, v192
    v_mfma_f32_16x16x32_bf16 v[200:203], v[164:167], v[4:7], v[200:203]
    v_exp_f32 v193, v193
    v_mfma_f32_16x16x32_bf16 v[200:203], v[168:171], v[8:11], v[200:203]
    v_exp_f32 v194, v194
    v_mfma_f32_16x16x32_bf16 v[200:203], v[172:175], v[12:15], v[200:203]
    v_exp_f32 v195, v195
    v_mfma_f32_16x16x32_bf16 v[204:207], v[176:179], v[12:15], v[224:227]
    v_exp_f32 v196, v196
    v_mfma_f32_16x16x32_bf16 v[204:207], v[180:183], v[8:11], v[204:207]
    v_exp_f32 v197, v197
    v_mfma_f32_16x16x32_bf16 v[204:207], v[184:187], v[4:7], v[204:207]
    v_exp_f32 v198, v198
    v_mfma_f32_16x16x32_bf16 v[204:207], v[188:191], v[0:3], v[204:207]
    v_exp_f32 v199, v199
    v_cvt_pk_bf16_f32 v208, v192, v193
    v_cvt_pk_bf16_f32 v209, v194, v195
    v_cvt_pk_bf16_f32 v210, v196, v197
    v_cvt_pk_bf16_f32 v211, v198, v199
    v_exp_f32 v200, v200
    v_exp_f32 v201, v201
    v_exp_f32 v202, v202
    v_exp_f32 v203, v203
    v_exp_f32 v204, v204
    v_cvt_pk_bf16_f32 v212, v200, v201
    v_cvt_pk_bf16_f32 v213, v202, v203
    v_mov_b32 v81, -1
    v_mov_b32 v82, -1
    v_mov_b32 v83, -1
    s_lshl_b32 s6, s74, 14
    s_add_u32 s6, s6, s70
    v_add_u32 v84, s6, v118
    s_add_u32 s46, s74, 1
    s_and_b32 s46, s46, 3
    s_lshl_b32 s46, s46, 16
    s_movk_i32 s47, 2048
    v_mfma_f32_16x16x32_bf16 v[192:195], v[128:131], v[16:19], v[228:231]
.p2align 6
K1_LOOP:
    v_mfma_f32_16x16x32_bf16 v[192:195], v[132:135], v[20:23], v[192:195]
    v_exp_f32 v205, v205
    v_mfma_f32_16x16x32_bf16 v[192:195], v[136:139], v[24:27], v[192:195]
    v_cvt_pk_bf16_f32 v214, v204, v205
    v_mfma_f32_16x16x32_bf16 v[192:195], v[140:143], v[28:31], v[192:195]
    v_exp_f32 v206, v206
    v_mfma_f32_16x16x32_bf16 v[196:199], v[144:147], v[28:31], v[228:231]
    s_waitcnt vmcnt(18) lgkmcnt(0)
    s_add_u32 m0, s52, 0
    v_mfma_f32_16x16x32_bf16 v[196:199], v[148:151], v[24:27], v[196:199]
    v_exp_f32 v207, v207
    v_mfma_f32_16x16x32_bf16 v[196:199], v[152:155], v[20:23], v[196:199]
    v_cvt_pk_bf16_f32 v215, v206, v207
    v_mfma_f32_16x16x32_bf16 v[196:199], v[156:159], v[16:19], v[196:199]
    s_barrier
    v_mfma_f32_16x16x32_bf16 v[200:203], v[160:163], v[16:19], v[228:231]
    v_exp_f32 v192, v192
    v_mfma_f32_16x16x32_bf16 v[200:203], v[164:167], v[20:23], v[200:203]
    buffer_load_dwordx4 v120, s[8:11], s48 offen offset:0 sc1 lds
    v_mfma_f32_16x16x32_bf16 v[200:203], v[168:171], v[24:27], v[200:203]
    v_exp_f32 v193, v193
    v_mfma_f32_16x16x32_bf16 v[200:203], v[172:175], v[28:31], v[200:203]
    ds_read_b64_tr_b16 a[192:193], v104 offset:16384
    v_cvt_pk_bf16_f32 v216, v192, v193
    v_mfma_f32_16x16x32_bf16 v[204:207], v[176:179], v[28:31], v[228:231]
    v_exp_f32 v194, v194
    v_mfma_f32_16x16x32_bf16 v[204:207], v[180:183], v[24:27], v[204:207]
    ds_read_b64_tr_b16 a[194:195], v104 offset:20480
    ds_read_b64_tr_b16 a[196:197], v104 offset:24576
    v_mfma_f32_16x16x32_bf16 v[204:207], v[184:187], v[20:23], v[204:207]
    v_exp_f32 v195, v195
    v_mfma_f32_16x16x32_bf16 v[204:207], v[188:191], v[16:19], v[204:207]
    ds_read_b64_tr_b16 a[198:199], v104 offset:28672
    v_cvt_pk_bf16_f32 v217, v194, v195
    v_mfma_f32_16x16x32_bf16 a[0:3], a[128:131], v[208:211], a[0:3]
    v_exp_f32 v196, v196
    v_mfma_f32_16x16x32_bf16 a[0:3], a[132:135], v[212:215], a[0:3]
    buffer_load_dwordx4 v121, s[8:11], s48 offen offset:1024 sc1 lds
    v_mfma_f32_16x16x32_bf16 a[16:19], a[136:139], v[208:211], a[16:19]
    v_exp_f32 v197, v197
    v_mfma_f32_16x16x32_bf16 a[16:19], a[140:143], v[212:215], a[16:19]
    ds_read_b64_tr_b16 a[200:201], v105 offset:16384
    v_cvt_pk_bf16_f32 v218, v196, v197
    v_mfma_f32_16x16x32_bf16 a[32:35], a[144:147], v[208:211], a[32:35]
    v_exp_f32 v198, v198
    v_mfma_f32_16x16x32_bf16 a[32:35], a[148:151], v[212:215], a[32:35]
    buffer_load_dwordx4 v122, s[8:11], s48 offen offset:2048 sc1 lds
    v_mfma_f32_16x16x32_bf16 a[48:51], a[152:155], v[208:211], a[48:51]
    v_exp_f32 v199, v199
    v_mfma_f32_16x16x32_bf16 a[48:51], a[156:159], v[212:215], a[48:51]
    ds_read_b64_tr_b16 a[202:203], v105 offset:20480
    v_cvt_pk_bf16_f32 v219, v198, v199
    v_mfma_f32_16x16x32_bf16 a[64:67], a[160:163], v[208:211], a[64:67]
    v_exp_f32 v200, v200
    v_mfma_f32_16x16x32_bf16 a[64:67], a[164:167], v[212:215], a[64:67]
    ds_read_b64_tr_b16 a[204:205], v105 offset:24576
    ds_read_b64_tr_b16 a[206:207], v105 offset:28672
    v_mfma_f32_16x16x32_bf16 a[80:83], a[168:171], v[208:211], a[80:83]
    v_exp_f32 v201, v201
    v_mfma_f32_16x16x32_bf16 a[80:83], a[172:175], v[212:215], a[80:83]
    ds_read_b64_tr_b16 a[208:209], v106 offset:16384
    v_cvt_pk_bf16_f32 v220, v200, v201
    v_mfma_f32_16x16x32_bf16 a[96:99], a[176:179], v[208:211], a[96:99]
    v_exp_f32 v202, v202
    v_mfma_f32_16x16x32_bf16 a[96:99], a[180:183], v[212:215], a[96:99]
    buffer_load_dwordx4 v123, s[8:11], s48 offen offset:3072 sc1 lds
    v_mfma_f32_16x16x32_bf16 a[112:115], a[184:187], v[208:211], a[112:115]
    v_exp_f32 v203, v203
    v_mfma_f32_16x16x32_bf16 a[112:115], a[188:191], v[212:215], a[112:115]
    ds_read_b64_tr_b16 a[210:211], v106 offset:20480
    v_cvt_pk_bf16_f32 v221, v202, v203
    v_smfmac_f32_16x16x64_bf16 v[240:243], v[96:99], v[208:215], v119
    v_exp_f32 v204, v204
    v_mfma_f32_16x16x32_bf16 v[192:195], v[128:131], v[32:35], v[232:235]
    s_add_u32 m0, s52, 65536
    ds_read_b64_tr_b16 a[212:213], v106 offset:24576
    v_mfma_f32_16x16x32_bf16 v[192:195], v[132:135], v[36:39], v[192:195]
    v_exp_f32 v205, v205
    v_mfma_f32_16x16x32_bf16 v[192:195], v[136:139], v[40:43], v[192:195]
    ds_read_b64_tr_b16 a[214:215], v106 offset:28672
    v_cvt_pk_bf16_f32 v222, v204, v205
    v_mfma_f32_16x16x32_bf16 v[192:195], v[140:143], v[44:47], v[192:195]
    v_exp_f32 v206, v206
    v_mfma_f32_16x16x32_bf16 v[196:199], v[144:147], v[44:47], v[232:235]
    buffer_load_dwordx4 v124, s[12:15], s43 offen offset:0 sc1 lds
    v_mfma_f32_16x16x32_bf16 v[196:199], v[148:151], v[40:43], v[196:199]
    v_exp_f32 v207, v207
    v_mfma_f32_16x16x32_bf16 v[196:199], v[152:155], v[36:39], v[196:199]
    ds_read_b64_tr_b16 a[216:217], v107 offset:16384
    v_cvt_pk_bf16_f32 v223, v206, v207
    v_mfma_f32_16x16x32_bf16 v[196:199], v[156:159], v[32:35], v[196:199]
    ds_read_b64_tr_b16 a[218:219], v107 offset:20480
    v_mfma_f32_16x16x32_bf16 v[200:203], v[160:163], v[32:35], v[232:235]
    v_exp_f32 v192, v192
    v_mfma_f32_16x16x32_bf16 v[200:203], v[164:167], v[36:39], v[200:203]
    ds_read_b64_tr_b16 a[220:221], v107 offset:24576
    v_mfma_f32_16x16x32_bf16 v[200:203], v[168:171], v[40:43], v[200:203]
    v_exp_f32 v193, v193
    v_mfma_f32_16x16x32_bf16 v[200:203], v[172:175], v[44:47], v[200:203]
    ds_read_b64_tr_b16 a[222:223], v107 offset:28672
    v_cvt_pk_bf16_f32 v208, v192, v193
    v_mfma_f32_16x16x32_bf16 v[204:207], v[176:179], v[44:47], v[232:235]
    v_exp_f32 v194, v194
    v_mfma_f32_16x16x32_bf16 v[204:207], v[180:183], v[40:43], v[204:207]
    buffer_load_dwordx4 v125, s[12:15], s43 offen offset:1024 sc1 lds
    v_mfma_f32_16x16x32_bf16 v[204:207], v[184:187], v[36:39], v[204:207]
    v_exp_f32 v195, v195
    v_mfma_f32_16x16x32_bf16 v[204:207], v[188:191], v[32:35], v[204:207]
    ds_read_b64_tr_b16 a[224:225], v108 offset:16384
    v_cvt_pk_bf16_f32 v209, v194, v195
    v_mfma_f32_16x16x32_bf16 a[4:7], a[128:131], v[216:219], a[4:7]
    v_exp_f32 v196, v196
    v_mfma_f32_16x16x32_bf16 a[4:7], a[132:135], v[220:223], a[4:7]
    ds_read_b64_tr_b16 a[226:227], v108 offset:20480
    v_mfma_f32_16x16x32_bf16 a[20:23], a[136:139], v[216:219], a[20:23]
    v_exp_f32 v197, v197
    v_mfma_f32_16x16x32_bf16 a[20:23], a[140:143], v[220:223], a[20:23]
    ds_read_b64_tr_b16 a[228:229], v108 offset:24576
    v_cvt_pk_bf16_f32 v210, v196, v197
    v_mfma_f32_16x16x32_bf16 a[36:39], a[144:147], v[216:219], a[36:39]
    v_exp_f32 v198, v198
    v_mfma_f32_16x16x32_bf16 a[36:39], a[148:151], v[220:223], a[36:39]
    buffer_load_dwordx4 v124, s[12:15], s43 offen offset:2048 sc1 lds
    v_mfma_f32_16x16x32_bf16 a[52:55], a[152:155], v[216:219], a[52:55]
    v_exp_f32 v199, v199
    v_mfma_f32_16x16x32_bf16 a[52:55], a[156:159], v[220:223], a[52:55]
    ds_read_b64_tr_b16 a[230:231], v108 offset:28672
    v_cvt_pk_bf16_f32 v211, v198, v199
    v_mfma_f32_16x16x32_bf16 a[68:71], a[160:163], v[216:219], a[68:71]
    v_exp_f32 v200, v200
    v_mfma_f32_16x16x32_bf16 a[68:71], a[164:167], v[220:223], a[68:71]
    ds_read_b64_tr_b16 a[232:233], v109 offset:16384
    v_mfma_f32_16x16x32_bf16 a[84:87], a[168:171], v[216:219], a[84:87]
    v_exp_f32 v201, v201
    v_mfma_f32_16x16x32_bf16 a[84:87], a[172:175], v[220:223], a[84:87]
    ds_read_b64_tr_b16 a[234:235], v109 offset:20480
    v_cvt_pk_bf16_f32 v212, v200, v201
    v_mfma_f32_16x16x32_bf16 a[100:103], a[176:179], v[216:219], a[100:103]
    v_exp_f32 v202, v202
    v_mfma_f32_16x16x32_bf16 a[100:103], a[180:183], v[220:223], a[100:103]
    buffer_load_dwordx4 v125, s[12:15], s43 offen offset:3072 sc1 lds
    v_mfma_f32_16x16x32_bf16 a[116:119], a[184:187], v[216:219], a[116:119]
    v_exp_f32 v203, v203
    v_mfma_f32_16x16x32_bf16 a[116:119], a[188:191], v[220:223], a[116:119]
    ds_read_b64_tr_b16 a[236:237], v109 offset:24576
    v_cvt_pk_bf16_f32 v213, v202, v203
    v_smfmac_f32_16x16x64_bf16 v[244:247], v[96:99], v[216:223], v119
    v_exp_f32 v204, v204
    v_mfma_f32_16x16x32_bf16 v[192:195], v[128:131], v[48:51], v[236:239]
    s_add_u32 s48, s48, s77
    s_add_u32 s43, s43, s58
    v_mfma_f32_16x16x32_bf16 v[192:195], v[132:135], v[52:55], v[192:195]
    v_exp_f32 v205, v205
    v_mfma_f32_16x16x32_bf16 v[192:195], v[136:139], v[56:59], v[192:195]
    ds_read_b128 v[128:131], v100 offset:16384
    v_cvt_pk_bf16_f32 v214, v204, v205
    v_mfma_f32_16x16x32_bf16 v[192:195], v[140:143], v[60:63], v[192:195]
    v_exp_f32 v206, v206
    v_mfma_f32_16x16x32_bf16 v[196:199], v[144:147], v[60:63], v[236:239]
    ds_read_b128 v[132:135], v101 offset:16384
    ds_read_b128 v[136:139], v102 offset:16384
    v_mfma_f32_16x16x32_bf16 v[196:199], v[148:151], v[56:59], v[196:199]
    v_exp_f32 v207, v207
    v_mfma_f32_16x16x32_bf16 v[196:199], v[152:155], v[52:55], v[196:199]
    ds_read_b128 v[140:143], v103 offset:16384
    v_cvt_pk_bf16_f32 v215, v206, v207
    v_mfma_f32_16x16x32_bf16 v[196:199], v[156:159], v[48:51], v[196:199]
    ds_read_b128 v[144:147], v103 offset:20480
    v_mfma_f32_16x16x32_bf16 v[200:203], v[160:163], v[48:51], v[236:239]
    v_exp_f32 v192, v192
    v_mfma_f32_16x16x32_bf16 v[200:203], v[164:167], v[52:55], v[200:203]
    ds_read_b128 v[148:151], v102 offset:20480
    v_mfma_f32_16x16x32_bf16 v[200:203], v[168:171], v[56:59], v[200:203]
    v_exp_f32 v193, v193
    v_mfma_f32_16x16x32_bf16 v[200:203], v[172:175], v[60:63], v[200:203]
    ds_read_b128 v[152:155], v101 offset:20480
    v_cvt_pk_bf16_f32 v216, v192, v193
    v_mfma_f32_16x16x32_bf16 v[204:207], v[176:179], v[60:63], v[236:239]
    v_exp_f32 v194, v194
    v_mfma_f32_16x16x32_bf16 v[204:207], v[180:183], v[56:59], v[204:207]
    ds_read_b128 v[156:159], v100 offset:20480
    v_mfma_f32_16x16x32_bf16 v[204:207], v[184:187], v[52:55], v[204:207]
    v_exp_f32 v195, v195
    v_mfma_f32_16x16x32_bf16 v[204:207], v[188:191], v[48:51], v[204:207]
    ds_read_b128 v[160:163], v100 offset:24576
    v_cvt_pk_bf16_f32 v217, v194, v195
    v_mfma_f32_16x16x32_bf16 a[8:11], a[128:131], v[208:211], a[8:11]
    v_exp_f32 v196, v196
    v_mfma_f32_16x16x32_bf16 a[8:11], a[132:135], v[212:215], a[8:11]
    ds_read_b128 v[164:167], v101 offset:24576
    v_mfma_f32_16x16x32_bf16 a[24:27], a[136:139], v[208:211], a[24:27]
    v_exp_f32 v197, v197
    v_mfma_f32_16x16x32_bf16 a[24:27], a[140:143], v[212:215], a[24:27]
    ds_read_b128 v[168:171], v102 offset:24576
    v_cvt_pk_bf16_f32 v218, v196, v197
    v_mfma_f32_16x16x32_bf16 a[40:43], a[144:147], v[208:211], a[40:43]
    v_exp_f32 v198, v198
    v_mfma_f32_16x16x32_bf16 a[40:43], a[148:151], v[212:215], a[40:43]
    ds_read_b128 v[172:175], v103 offset:24576
    v_mfma_f32_16x16x32_bf16 a[56:59], a[152:155], v[208:211], a[56:59]
    v_exp_f32 v199, v199
    v_mfma_f32_16x16x32_bf16 a[56:59], a[156:159], v[212:215], a[56:59]
    ds_read_b128 v[176:179], v103 offset:28672
    v_cvt_pk_bf16_f32 v219, v198, v199
    v_mfma_f32_16x16x32_bf16 a[72:75], a[160:163], v[208:211], a[72:75]
    v_exp_f32 v200, v200
    v_mfma_f32_16x16x32_bf16 a[72:75], a[164:167], v[212:215], a[72:75]
    ds_read_b128 v[180:183], v102 offset:28672
    v_mfma_f32_16x16x32_bf16 a[88:91], a[168:171], v[208:211], a[88:91]
    v_exp_f32 v201, v201
    v_mfma_f32_16x16x32_bf16 a[88:91], a[172:175], v[212:215], a[88:91]
    ds_read_b128 v[184:187], v101 offset:28672
    v_cvt_pk_bf16_f32 v220, v200, v201
    v_mfma_f32_16x16x32_bf16 a[104:107], a[176:179], v[208:211], a[104:107]
    v_exp_f32 v202, v202
    v_mfma_f32_16x16x32_bf16 a[104:107], a[180:183], v[212:215], a[104:107]
    ds_read_b128 v[188:191], v100 offset:28672
    v_mfma_f32_16x16x32_bf16 a[120:123], a[184:187], v[208:211], a[120:123]
    v_exp_f32 v203, v203
    v_mfma_f32_16x16x32_bf16 a[120:123], a[188:191], v[212:215], a[120:123]
    s_waitcnt lgkmcnt(3)
    v_cvt_pk_bf16_f32 v221, v202, v203
    v_smfmac_f32_16x16x64_bf16 v[248:251], v[96:99], v[208:215], v119
    v_exp_f32 v204, v204
    v_mfma_f32_16x16x32_bf16 v[192:195], v[128:131], v[0:3], v[224:227]
    ds_read_b64_tr_b16 a[238:239], v109 offset:28672
    v_mfma_f32_16x16x32_bf16 v[192:195], v[132:135], v[4:7], v[192:195]
    v_exp_f32 v205, v205
    v_mfma_f32_16x16x32_bf16 v[192:195], v[136:139], v[8:11], v[192:195]
    ds_read_b64_tr_b16 a[240:241], v110 offset:16384
    v_cvt_pk_bf16_f32 v222, v204, v205
    v_mfma_f32_16x16x32_bf16 v[192:195], v[140:143], v[12:15], v[192:195]
    v_exp_f32 v206, v206
    v_mfma_f32_16x16x32_bf16 v[196:199], v[144:147], v[12:15], v[224:227]
    ds_read_b64_tr_b16 a[242:243], v110 offset:20480
    v_mfma_f32_16x16x32_bf16 v[196:199], v[148:151], v[8:11], v[196:199]
    v_exp_f32 v207, v207
    v_mfma_f32_16x16x32_bf16 v[196:199], v[152:155], v[4:7], v[196:199]
    ds_read_b64_tr_b16 a[244:245], v110 offset:24576
    v_cvt_pk_bf16_f32 v223, v206, v207
    v_mfma_f32_16x16x32_bf16 v[196:199], v[156:159], v[0:3], v[196:199]
    s_waitcnt lgkmcnt(4)
    v_mfma_f32_16x16x32_bf16 v[200:203], v[160:163], v[0:3], v[224:227]
    v_exp_f32 v192, v192
    v_mfma_f32_16x16x32_bf16 v[200:203], v[164:167], v[4:7], v[200:203]
    ds_read_b64_tr_b16 a[246:247], v110 offset:28672
    v_mfma_f32_16x16x32_bf16 v[200:203], v[168:171], v[8:11], v[200:203]
    v_exp_f32 v193, v193
    v_mfma_f32_16x16x32_bf16 v[200:203], v[172:175], v[12:15], v[200:203]
    ds_read_b64_tr_b16 a[248:249], v111 offset:16384
    v_cvt_pk_bf16_f32 v208, v192, v193
    v_mfma_f32_16x16x32_bf16 v[204:207], v[176:179], v[12:15], v[224:227]
    v_exp_f32 v194, v194
    v_mfma_f32_16x16x32_bf16 v[204:207], v[180:183], v[8:11], v[204:207]
    ds_read_b64_tr_b16 a[250:251], v111 offset:20480
    v_mfma_f32_16x16x32_bf16 v[204:207], v[184:187], v[4:7], v[204:207]
    v_exp_f32 v195, v195
    v_mfma_f32_16x16x32_bf16 v[204:207], v[188:191], v[0:3], v[204:207]
    ds_read_b64_tr_b16 a[252:253], v111 offset:24576
    v_cvt_pk_bf16_f32 v209, v194, v195
    v_mfma_f32_16x16x32_bf16 a[12:15], a[128:131], v[216:219], a[12:15]
    v_exp_f32 v196, v196
    v_mfma_f32_16x16x32_bf16 a[12:15], a[132:135], v[220:223], a[12:15]
    ds_read_b64_tr_b16 a[254:255], v111 offset:28672
    v_mfma_f32_16x16x32_bf16 a[28:31], a[136:139], v[216:219], a[28:31]
    v_exp_f32 v197, v197
    v_mfma_f32_16x16x32_bf16 a[28:31], a[140:143], v[220:223], a[28:31]
    v_cvt_pk_bf16_f32 v210, v196, v197
    v_mfma_f32_16x16x32_bf16 a[44:47], a[144:147], v[216:219], a[44:47]
    v_exp_f32 v198, v198
    v_mfma_f32_16x16x32_bf16 a[44:47], a[148:151], v[220:223], a[44:47]
    buffer_load_dword v72, v91, s[16:19], s68 offen
    v_mfma_f32_16x16x32_bf16 a[60:63], a[152:155], v[216:219], a[60:63]
    v_exp_f32 v199, v199
    v_mfma_f32_16x16x32_bf16 a[60:63], a[156:159], v[220:223], a[60:63]
    s_add_u32 s68, s68, 384
    v_cvt_pk_bf16_f32 v211, v198, v199
    v_mfma_f32_16x16x32_bf16 a[76:79], a[160:163], v[216:219], a[76:79]
    v_exp_f32 v200, v200
    v_mfma_f32_16x16x32_bf16 a[76:79], a[164:167], v[220:223], a[76:79]
    buffer_store_dwordx4 v[80:83], v84, s[88:91], s46 offen offset:0 sc1
    v_mfma_f32_16x16x32_bf16 a[92:95], a[168:171], v[216:219], a[92:95]
    v_exp_f32 v201, v201
    v_mfma_f32_16x16x32_bf16 a[92:95], a[172:175], v[220:223], a[92:95]
    v_cvt_pk_bf16_f32 v212, v200, v201
    v_mfma_f32_16x16x32_bf16 a[108:111], a[176:179], v[216:219], a[108:111]
    v_exp_f32 v202, v202
    v_mfma_f32_16x16x32_bf16 a[108:111], a[180:183], v[220:223], a[108:111]
    v_mfma_f32_16x16x32_bf16 a[124:127], a[184:187], v[216:219], a[124:127]
    v_exp_f32 v203, v203
    v_mfma_f32_16x16x32_bf16 a[124:127], a[188:191], v[220:223], a[124:127]
    v_cvt_pk_bf16_f32 v213, v202, v203
    v_smfmac_f32_16x16x64_bf16 v[252:255], v[96:99], v[216:223], v119
    v_exp_f32 v204, v204
    v_mfma_f32_16x16x32_bf16 v[192:195], v[128:131], v[16:19], v[228:231]
    v_mfma_f32_16x16x32_bf16 v[192:195], v[132:135], v[20:23], v[192:195]
    v_exp_f32 v205, v205
    v_mfma_f32_16x16x32_bf16 v[192:195], v[136:139], v[24:27], v[192:195]
    v_cvt_pk_bf16_f32 v214, v204, v205
    v_mfma_f32_16x16x32_bf16 v[192:195], v[140:143], v[28:31], v[192:195]
    v_exp_f32 v206, v206
    v_mfma_f32_16x16x32_bf16 v[196:199], v[144:147], v[28:31], v[228:231]
    s_waitcnt vmcnt(18) lgkmcnt(0)
    s_add_u32 m0, s52, 16384
    v_mfma_f32_16x16x32_bf16 v[196:199], v[148:151], v[24:27], v[196:199]
    v_exp_f32 v207, v207
    v_mfma_f32_16x16x32_bf16 v[196:199], v[152:155], v[20:23], v[196:199]
    v_cvt_pk_bf16_f32 v215, v206, v207
    v_mfma_f32_16x16x32_bf16 v[196:199], v[156:159], v[16:19], v[196:199]
    s_barrier
    v_mfma_f32_16x16x32_bf16 v[200:203], v[160:163], v[16:19], v[228:231]
    v_exp_f32 v192, v192
    v_mfma_f32_16x16x32_bf16 v[200:203], v[164:167], v[20:23], v[200:203]
    buffer_load_dwordx4 v120, s[8:11], s48 offen offset:0 sc1 lds
    v_mfma_f32_16x16x32_bf16 v[200:203], v[168:171], v[24:27], v[200:203]
    v_exp_f32 v193, v193
    v_mfma_f32_16x16x32_bf16 v[200:203], v[172:175], v[28:31], v[200:203]
    ds_read_b64_tr_b16 a[128:129], v104 offset:32768
    v_cvt_pk_bf16_f32 v216, v192, v193
    v_mfma_f32_16x16x32_bf16 v[204:207], v[176:179], v[28:31], v[228:231]
    v_exp_f32 v194, v194
    v_mfma_f32_16x16x32_bf16 v[204:207], v[180:183], v[24:27], v[204:207]
    ds_read_b64_tr_b16 a[130:131], v104 offset:36864
    ds_read_b64_tr_b16 a[132:133], v104 offset:40960
    v_mfma_f32_16x16x32_bf16 v[204:207], v[184:187], v[20:23], v[204:207]
    v_exp_f32 v195, v195
    v_mfma_f32_16x16x32_bf16 v[204:207], v[188:191], v[16:19], v[204:207]
    ds_read_b64_tr_b16 a[134:135], v104 offset:45056
    v_cvt_pk_bf16_f32 v217, v194, v195
    v_mfma_f32_16x16x32_bf16 a[0:3], a[192:195], v[208:211], a[0:3]
    v_exp_f32 v196, v196
    v_mfma_f32_16x16x32_bf16 a[0:3], a[196:199], v[212:215], a[0:3]
    buffer_load_dwordx4 v121, s[8:11], s48 offen offset:1024 sc1 lds
    v_mfma_f32_16x16x32_bf16 a[16:19], a[200:203], v[208:211], a[16:19]
    v_exp_f32 v197, v197
    v_mfma_f32_16x16x32_bf16 a[16:19], a[204:207], v[212:215], a[16:19]
    ds_read_b64_tr_b16 a[136:137], v105 offset:32768
    v_cvt_pk_bf16_f32 v218, v196, v197
    v_mfma_f32_16x16x32_bf16 a[32:35], a[208:211], v[208:211], a[32:35]
    v_exp_f32 v198, v198
    v_mfma_f32_16x16x32_bf16 a[32:35], a[212:215], v[212:215], a[32:35]
    buffer_load_dwordx4 v122, s[8:11], s48 offen offset:2048 sc1 lds
    v_mfma_f32_16x16x32_bf16 a[48:51], a[216:219], v[208:211], a[48:51]
    v_exp_f32 v199, v199
    v_mfma_f32_16x16x32_bf16 a[48:51], a[220:223], v[212:215], a[48:51]
    ds_read_b64_tr_b16 a[138:139], v105 offset:36864
    v_cvt_pk_bf16_f32 v219, v198, v199
    v_mfma_f32_16x16x32_bf16 a[64:67], a[224:227], v[208:211], a[64:67]
    v_exp_f32 v200, v200
    v_mfma_f32_16x16x32_bf16 a[64:67], a[228:231], v[212:215], a[64:67]
    ds_read_b64_tr_b16 a[140:141], v105 offset:40960
    ds_read_b64_tr_b16 a[142:143], v105 offset:45056
    v_mfma_f32_16x16x32_bf16 a[80:83], a[232:235], v[208:211], a[80:83]
    v_exp_f32 v201, v201
    v_mfma_f32_16x16x32_bf16 a[80:83], a[236:239], v[212:215], a[80:83]
    ds_read_b64_tr_b16 a[144:145], v106 offset:32768
    v_cvt_pk_bf16_f32 v220, v200, v201
    v_mfma_f32_16x16x32_bf16 a[96:99], a[240:243], v[208:211], a[96:99]
    v_exp_f32 v202, v202
    v_mfma_f32_16x16x32_bf16 a[96:99], a[244:247], v[212:215], a[96:99]
    buffer_load_dwordx4 v123, s[8:11], s48 offen offset:3072 sc1 lds
    v_mfma_f32_16x16x32_bf16 a[112:115], a[248:251], v[208:211], a[112:115]
    v_exp_f32 v203, v203
    v_mfma_f32_16x16x32_bf16 a[112:115], a[252:255], v[212:215], a[112:115]
    ds_read_b64_tr_b16 a[146:147], v106 offset:36864
    v_cvt_pk_bf16_f32 v221, v202, v203
    v_smfmac_f32_16x16x64_bf16 v[240:243], v[96:99], v[208:215], v119
    v_exp_f32 v204, v204
    v_mfma_f32_16x16x32_bf16 v[192:195], v[128:131], v[32:35], v[232:235]
    s_add_u32 m0, s52, 81920
    ds_read_b64_tr_b16 a[148:149], v106 offset:40960
    v_mfma_f32_16x16x32_bf16 v[192:195], v[132:135], v[36:39], v[192:195]
    v_exp_f32 v205, v205
    v_mfma_f32_16x16x32_bf16 v[192:195], v[136:139], v[40:43], v[192:195]
    ds_read_b64_tr_b16 a[150:151], v106 offset:45056
    v_cvt_pk_bf16_f32 v222, v204, v205
    v_mfma_f32_16x16x32_bf16 v[192:195], v[140:143], v[44:47], v[192:195]
    v_exp_f32 v206, v206
    v_mfma_f32_16x16x32_bf16 v[196:199], v[144:147], v[44:47], v[232:235]
    buffer_load_dwordx4 v124, s[12:15], s43 offen offset:0 sc1 lds
    v_mfma_f32_16x16x32_bf16 v[196:199], v[148:151], v[40:43], v[196:199]
    v_exp_f32 v207, v207
    v_mfma_f32_16x16x32_bf16 v[196:199], v[152:155], v[36:39], v[196:199]
    ds_read_b64_tr_b16 a[152:153], v107 offset:32768
    v_cvt_pk_bf16_f32 v223, v206, v207
    v_mfma_f32_16x16x32_bf16 v[196:199], v[156:159], v[32:35], v[196:199]
    ds_read_b64_tr_b16 a[154:155], v107 offset:36864
    v_mfma_f32_16x16x32_bf16 v[200:203], v[160:163], v[32:35], v[232:235]
    v_exp_f32 v192, v192
    v_mfma_f32_16x16x32_bf16 v[200:203], v[164:167], v[36:39], v[200:203]
    ds_read_b64_tr_b16 a[156:157], v107 offset:40960
    v_mfma_f32_16x16x32_bf16 v[200:203], v[168:171], v[40:43], v[200:203]
    v_exp_f32 v193, v193
    v_mfma_f32_16x16x32_bf16 v[200:203], v[172:175], v[44:47], v[200:203]
    ds_read_b64_tr_b16 a[158:159], v107 offset:45056
    v_cvt_pk_bf16_f32 v208, v192, v193
    v_mfma_f32_16x16x32_bf16 v[204:207], v[176:179], v[44:47], v[232:235]
    v_exp_f32 v194, v194
    v_mfma_f32_16x16x32_bf16 v[204:207], v[180:183], v[40:43], v[204:207]
    buffer_load_dwordx4 v125, s[12:15], s43 offen offset:1024 sc1 lds
    v_mfma_f32_16x16x32_bf16 v[204:207], v[184:187], v[36:39], v[204:207]
    v_exp_f32 v195, v195
    v_mfma_f32_16x16x32_bf16 v[204:207], v[188:191], v[32:35], v[204:207]
    ds_read_b64_tr_b16 a[160:161], v108 offset:32768
    v_cvt_pk_bf16_f32 v209, v194, v195
    v_mfma_f32_16x16x32_bf16 a[4:7], a[192:195], v[216:219], a[4:7]
    v_exp_f32 v196, v196
    v_mfma_f32_16x16x32_bf16 a[4:7], a[196:199], v[220:223], a[4:7]
    ds_read_b64_tr_b16 a[162:163], v108 offset:36864
    v_mfma_f32_16x16x32_bf16 a[20:23], a[200:203], v[216:219], a[20:23]
    v_exp_f32 v197, v197
    v_mfma_f32_16x16x32_bf16 a[20:23], a[204:207], v[220:223], a[20:23]
    ds_read_b64_tr_b16 a[164:165], v108 offset:40960
    v_cvt_pk_bf16_f32 v210, v196, v197
    v_mfma_f32_16x16x32_bf16 a[36:39], a[208:211], v[216:219], a[36:39]
    v_exp_f32 v198, v198
    v_mfma_f32_16x16x32_bf16 a[36:39], a[212:215], v[220:223], a[36:39]
    buffer_load_dwordx4 v124, s[12:15], s43 offen offset:2048 sc1 lds
    v_mfma_f32_16x16x32_bf16 a[52:55], a[216:219], v[216:219], a[52:55]
    v_exp_f32 v199, v199
    v_mfma_f32_16x16x32_bf16 a[52:55], a[220:223], v[220:223], a[52:55]
    ds_read_b64_tr_b16 a[166:167], v108 offset:45056
    v_cvt_pk_bf16_f32 v211, v198, v199
    v_mfma_f32_16x16x32_bf16 a[68:71], a[224:227], v[216:219], a[68:71]
    v_exp_f32 v200, v200
    v_mfma_f32_16x16x32_bf16 a[68:71], a[228:231], v[220:223], a[68:71]
    ds_read_b64_tr_b16 a[168:169], v109 offset:32768
    v_mfma_f32_16x16x32_bf16 a[84:87], a[232:235], v[216:219], a[84:87]
    v_exp_f32 v201, v201
    v_mfma_f32_16x16x32_bf16 a[84:87], a[236:239], v[220:223], a[84:87]
    ds_read_b64_tr_b16 a[170:171], v109 offset:36864
    v_cvt_pk_bf16_f32 v212, v200, v201
    v_mfma_f32_16x16x32_bf16 a[100:103], a[240:243], v[216:219], a[100:103]
    v_exp_f32 v202, v202
    v_mfma_f32_16x16x32_bf16 a[100:103], a[244:247], v[220:223], a[100:103]
    buffer_load_dwordx4 v125, s[12:15], s43 offen offset:3072 sc1 lds
    v_mfma_f32_16x16x32_bf16 a[116:119], a[248:251], v[216:219], a[116:119]
    v_exp_f32 v203, v203
    v_mfma_f32_16x16x32_bf16 a[116:119], a[252:255], v[220:223], a[116:119]
    ds_read_b64_tr_b16 a[172:173], v109 offset:40960
    v_cvt_pk_bf16_f32 v213, v202, v203
    v_smfmac_f32_16x16x64_bf16 v[244:247], v[96:99], v[216:223], v119
    v_exp_f32 v204, v204
    v_mfma_f32_16x16x32_bf16 v[192:195], v[128:131], v[48:51], v[236:239]
    s_add_u32 s48, s48, s77
    s_add_u32 s43, s43, s58
    v_mfma_f32_16x16x32_bf16 v[192:195], v[132:135], v[52:55], v[192:195]
    v_exp_f32 v205, v205
    v_mfma_f32_16x16x32_bf16 v[192:195], v[136:139], v[56:59], v[192:195]
    ds_read_b128 v[128:131], v100 offset:32768
    v_cvt_pk_bf16_f32 v214, v204, v205
    v_mfma_f32_16x16x32_bf16 v[192:195], v[140:143], v[60:63], v[192:195]
    v_exp_f32 v206, v206
    v_mfma_f32_16x16x32_bf16 v[196:199], v[144:147], v[60:63], v[236:239]
    ds_read_b128 v[132:135], v101 offset:32768
    ds_read_b128 v[136:139], v102 offset:32768
    v_mfma_f32_16x16x32_bf16 v[196:199], v[148:151], v[56:59], v[196:199]
    v_exp_f32 v207, v207
    v_mfma_f32_16x16x32_bf16 v[196:199], v[152:155], v[52:55], v[196:199]
    ds_read_b128 v[140:143], v103 offset:32768
    v_cvt_pk_bf16_f32 v215, v206, v207
    v_mfma_f32_16x16x32_bf16 v[196:199], v[156:159], v[48:51], v[196:199]
    ds_read_b128 v[144:147], v103 offset:36864
    v_mfma_f32_16x16x32_bf16 v[200:203], v[160:163], v[48:51], v[236:239]
    v_exp_f32 v192, v192
    v_mfma_f32_16x16x32_bf16 v[200:203], v[164:167], v[52:55], v[200:203]
    ds_read_b128 v[148:151], v102 offset:36864
    v_mfma_f32_16x16x32_bf16 v[200:203], v[168:171], v[56:59], v[200:203]
    v_exp_f32 v193, v193
    v_mfma_f32_16x16x32_bf16 v[200:203], v[172:175], v[60:63], v[200:203]
    ds_read_b128 v[152:155], v101 offset:36864
    v_cvt_pk_bf16_f32 v216, v192, v193
    v_mfma_f32_16x16x32_bf16 v[204:207], v[176:179], v[60:63], v[236:239]
    v_exp_f32 v194, v194
    v_mfma_f32_16x16x32_bf16 v[204:207], v[180:183], v[56:59], v[204:207]
    ds_read_b128 v[156:159], v100 offset:36864
    v_mfma_f32_16x16x32_bf16 v[204:207], v[184:187], v[52:55], v[204:207]
    v_exp_f32 v195, v195
    v_mfma_f32_16x16x32_bf16 v[204:207], v[188:191], v[48:51], v[204:207]
    ds_read_b128 v[160:163], v100 offset:40960
    v_cvt_pk_bf16_f32 v217, v194, v195
    v_mfma_f32_16x16x32_bf16 a[8:11], a[192:195], v[208:211], a[8:11]
    v_exp_f32 v196, v196
    v_mfma_f32_16x16x32_bf16 a[8:11], a[196:199], v[212:215], a[8:11]
    ds_read_b128 v[164:167], v101 offset:40960
    v_mfma_f32_16x16x32_bf16 a[24:27], a[200:203], v[208:211], a[24:27]
    v_exp_f32 v197, v197
    v_mfma_f32_16x16x32_bf16 a[24:27], a[204:207], v[212:215], a[24:27]
    ds_read_b128 v[168:171], v102 offset:40960
    v_cvt_pk_bf16_f32 v218, v196, v197
    v_mfma_f32_16x16x32_bf16 a[40:43], a[208:211], v[208:211], a[40:43]
    v_exp_f32 v198, v198
    v_mfma_f32_16x16x32_bf16 a[40:43], a[212:215], v[212:215], a[40:43]
    ds_read_b128 v[172:175], v103 offset:40960
    v_mfma_f32_16x16x32_bf16 a[56:59], a[216:219], v[208:211], a[56:59]
    v_exp_f32 v199, v199
    v_mfma_f32_16x16x32_bf16 a[56:59], a[220:223], v[212:215], a[56:59]
    ds_read_b128 v[176:179], v103 offset:45056
    v_cvt_pk_bf16_f32 v219, v198, v199
    v_mfma_f32_16x16x32_bf16 a[72:75], a[224:227], v[208:211], a[72:75]
    v_exp_f32 v200, v200
    v_mfma_f32_16x16x32_bf16 a[72:75], a[228:231], v[212:215], a[72:75]
    ds_read_b128 v[180:183], v102 offset:45056
    v_mfma_f32_16x16x32_bf16 a[88:91], a[232:235], v[208:211], a[88:91]
    v_exp_f32 v201, v201
    v_mfma_f32_16x16x32_bf16 a[88:91], a[236:239], v[212:215], a[88:91]
    ds_read_b128 v[184:187], v101 offset:45056
    v_cvt_pk_bf16_f32 v220, v200, v201
    v_mfma_f32_16x16x32_bf16 a[104:107], a[240:243], v[208:211], a[104:107]
    v_exp_f32 v202, v202
    v_mfma_f32_16x16x32_bf16 a[104:107], a[244:247], v[212:215], a[104:107]
    ds_read_b128 v[188:191], v100 offset:45056
    v_mfma_f32_16x16x32_bf16 a[120:123], a[248:251], v[208:211], a[120:123]
    v_exp_f32 v203, v203
    v_mfma_f32_16x16x32_bf16 a[120:123], a[252:255], v[212:215], a[120:123]
    s_waitcnt lgkmcnt(3)
    v_cvt_pk_bf16_f32 v221, v202, v203
    v_smfmac_f32_16x16x64_bf16 v[248:251], v[96:99], v[208:215], v119
    v_exp_f32 v204, v204
    v_mfma_f32_16x16x32_bf16 v[192:195], v[128:131], v[0:3], v[224:227]
    ds_read_b64_tr_b16 a[174:175], v109 offset:45056
    v_mfma_f32_16x16x32_bf16 v[192:195], v[132:135], v[4:7], v[192:195]
    v_exp_f32 v205, v205
    v_mfma_f32_16x16x32_bf16 v[192:195], v[136:139], v[8:11], v[192:195]
    ds_read_b64_tr_b16 a[176:177], v110 offset:32768
    v_cvt_pk_bf16_f32 v222, v204, v205
    v_mfma_f32_16x16x32_bf16 v[192:195], v[140:143], v[12:15], v[192:195]
    v_exp_f32 v206, v206
    v_mfma_f32_16x16x32_bf16 v[196:199], v[144:147], v[12:15], v[224:227]
    ds_read_b64_tr_b16 a[178:179], v110 offset:36864
    v_mfma_f32_16x16x32_bf16 v[196:199], v[148:151], v[8:11], v[196:199]
    v_exp_f32 v207, v207
    v_mfma_f32_16x16x32_bf16 v[196:199], v[152:155], v[4:7], v[196:199]
    ds_read_b64_tr_b16 a[180:181], v110 offset:40960
    v_cvt_pk_bf16_f32 v223, v206, v207
    v_mfma_f32_16x16x32_bf16 v[196:199], v[156:159], v[0:3], v[196:199]
    s_waitcnt lgkmcnt(4)
    v_mfma_f32_16x16x32_bf16 v[200:203], v[160:163], v[0:3], v[224:227]
    v_exp_f32 v192, v192
    v_mfma_f32_16x16x32_bf16 v[200:203], v[164:167], v[4:7], v[200:203]
    ds_read_b64_tr_b16 a[182:183], v110 offset:45056
    v_mfma_f32_16x16x32_bf16 v[200:203], v[168:171], v[8:11], v[200:203]
    v_exp_f32 v193, v193
    v_mfma_f32_16x16x32_bf16 v[200:203], v[172:175], v[12:15], v[200:203]
    ds_read_b64_tr_b16 a[184:185], v111 offset:32768
    v_cvt_pk_bf16_f32 v208, v192, v193
    v_mfma_f32_16x16x32_bf16 v[204:207], v[176:179], v[12:15], v[224:227]
    v_exp_f32 v194, v194
    v_mfma_f32_16x16x32_bf16 v[204:207], v[180:183], v[8:11], v[204:207]
    ds_read_b64_tr_b16 a[186:187], v111 offset:36864
    v_mfma_f32_16x16x32_bf16 v[204:207], v[184:187], v[4:7], v[204:207]
    v_exp_f32 v195, v195
    v_mfma_f32_16x16x32_bf16 v[204:207], v[188:191], v[0:3], v[204:207]
    ds_read_b64_tr_b16 a[188:189], v111 offset:40960
    v_cvt_pk_bf16_f32 v209, v194, v195
    v_mfma_f32_16x16x32_bf16 a[12:15], a[192:195], v[216:219], a[12:15]
    v_exp_f32 v196, v196
    v_mfma_f32_16x16x32_bf16 a[12:15], a[196:199], v[220:223], a[12:15]
    ds_read_b64_tr_b16 a[190:191], v111 offset:45056
    v_mfma_f32_16x16x32_bf16 a[28:31], a[200:203], v[216:219], a[28:31]
    v_exp_f32 v197, v197
    v_mfma_f32_16x16x32_bf16 a[28:31], a[204:207], v[220:223], a[28:31]
    v_cvt_pk_bf16_f32 v210, v196, v197
    v_mfma_f32_16x16x32_bf16 a[44:47], a[208:211], v[216:219], a[44:47]
    v_exp_f32 v198, v198
    v_mfma_f32_16x16x32_bf16 a[44:47], a[212:215], v[220:223], a[44:47]
    buffer_load_dword v73, v91, s[16:19], s68 offen
    v_mfma_f32_16x16x32_bf16 a[60:63], a[216:219], v[216:219], a[60:63]
    v_exp_f32 v199, v199
    v_mfma_f32_16x16x32_bf16 a[60:63], a[220:223], v[220:223], a[60:63]
    s_add_u32 s68, s68, 384
    v_cvt_pk_bf16_f32 v211, v198, v199
    v_mfma_f32_16x16x32_bf16 a[76:79], a[224:227], v[216:219], a[76:79]
    v_exp_f32 v200, v200
    v_mfma_f32_16x16x32_bf16 a[76:79], a[228:231], v[220:223], a[76:79]
    v_mfma_f32_16x16x32_bf16 a[92:95], a[232:235], v[216:219], a[92:95]
    v_exp_f32 v201, v201
    v_mfma_f32_16x16x32_bf16 a[92:95], a[236:239], v[220:223], a[92:95]
    v_cvt_pk_bf16_f32 v212, v200, v201
    v_mfma_f32_16x16x32_bf16 a[108:111], a[240:243], v[216:219], a[108:111]
    v_exp_f32 v202, v202
    v_mfma_f32_16x16x32_bf16 a[108:111], a[244:247], v[220:223], a[108:111]
    v_mfma_f32_16x16x32_bf16 a[124:127], a[248:251], v[216:219], a[124:127]
    v_exp_f32 v203, v203
    v_mfma_f32_16x16x32_bf16 a[124:127], a[252:255], v[220:223], a[124:127]
    v_cvt_pk_bf16_f32 v213, v202, v203
    v_smfmac_f32_16x16x64_bf16 v[252:255], v[96:99], v[216:223], v119
    v_exp_f32 v204, v204
    v_mfma_f32_16x16x32_bf16 v[192:195], v[128:131], v[16:19], v[228:231]
    v_mfma_f32_16x16x32_bf16 v[192:195], v[132:135], v[20:23], v[192:195]
    v_exp_f32 v205, v205
    v_mfma_f32_16x16x32_bf16 v[192:195], v[136:139], v[24:27], v[192:195]
    v_cvt_pk_bf16_f32 v214, v204, v205
    v_mfma_f32_16x16x32_bf16 v[192:195], v[140:143], v[28:31], v[192:195]
    v_exp_f32 v206, v206
    v_mfma_f32_16x16x32_bf16 v[196:199], v[144:147], v[28:31], v[228:231]
    s_waitcnt vmcnt(18) lgkmcnt(0)
    s_add_u32 m0, s52, 32768
    v_mfma_f32_16x16x32_bf16 v[196:199], v[148:151], v[24:27], v[196:199]
    v_exp_f32 v207, v207
    v_mfma_f32_16x16x32_bf16 v[196:199], v[152:155], v[20:23], v[196:199]
    v_cvt_pk_bf16_f32 v215, v206, v207
    v_mfma_f32_16x16x32_bf16 v[196:199], v[156:159], v[16:19], v[196:199]
    s_barrier
    v_mfma_f32_16x16x32_bf16 v[200:203], v[160:163], v[16:19], v[228:231]
    v_exp_f32 v192, v192
    v_mfma_f32_16x16x32_bf16 v[200:203], v[164:167], v[20:23], v[200:203]
    buffer_load_dwordx4 v120, s[8:11], s48 offen offset:0 sc1 lds
    v_mfma_f32_16x16x32_bf16 v[200:203], v[168:171], v[24:27], v[200:203]
    v_exp_f32 v193, v193
    v_mfma_f32_16x16x32_bf16 v[200:203], v[172:175], v[28:31], v[200:203]
    ds_read_b64_tr_b16 a[192:193], v104 offset:49152
    v_cvt_pk_bf16_f32 v216, v192, v193
    v_mfma_f32_16x16x32_bf16 v[204:207], v[176:179], v[28:31], v[228:231]
    v_exp_f32 v194, v194
    v_mfma_f32_16x16x32_bf16 v[204:207], v[180:183], v[24:27], v[204:207]
    ds_read_b64_tr_b16 a[194:195], v104 offset:53248
    ds_read_b64_tr_b16 a[196:197], v104 offset:57344
    v_mfma_f32_16x16x32_bf16 v[204:207], v[184:187], v[20:23], v[204:207]
    v_exp_f32 v195, v195
    v_mfma_f32_16x16x32_bf16 v[204:207], v[188:191], v[16:19], v[204:207]
    ds_read_b64_tr_b16 a[198:199], v104 offset:61440
    v_cvt_pk_bf16_f32 v217, v194, v195
    v_mfma_f32_16x16x32_bf16 a[0:3], a[128:131], v[208:211], a[0:3]
    v_exp_f32 v196, v196
    v_mfma_f32_16x16x32_bf16 a[0:3], a[132:135], v[212:215], a[0:3]
    buffer_load_dwordx4 v121, s[8:11], s48 offen offset:1024 sc1 lds
    v_mfma_f32_16x16x32_bf16 a[16:19], a[136:139], v[208:211], a[16:19]
    v_exp_f32 v197, v197
    v_mfma_f32_16x16x32_bf16 a[16:19], a[140:143], v[212:215], a[16:19]
    ds_read_b64_tr_b16 a[200:201], v105 offset:49152
    v_cvt_pk_bf16_f32 v218, v196, v197
    v_mfma_f32_16x16x32_bf16 a[32:35], a[144:147], v[208:211], a[32:35]
    v_exp_f32 v198, v198
    v_mfma_f32_16x16x32_bf16 a[32:35], a[148:151], v[212:215], a[32:35]
    buffer_load_dwordx4 v122, s[8:11], s48 offen offset:2048 sc1 lds
    v_mfma_f32_16x16x32_bf16 a[48:51], a[152:155], v[208:211], a[48:51]
    v_exp_f32 v199, v199
    v_mfma_f32_16x16x32_bf16 a[48:51], a[156:159], v[212:215], a[48:51]
    ds_read_b64_tr_b16 a[202:203], v105 offset:53248
    v_cvt_pk_bf16_f32 v219, v198, v199
    v_mfma_f32_16x16x32_bf16 a[64:67], a[160:163], v[208:211], a[64:67]
    v_exp_f32 v200, v200
    v_mfma_f32_16x16x32_bf16 a[64:67], a[164:167], v[212:215], a[64:67]
    ds_read_b64_tr_b16 a[204:205], v105 offset:57344
    ds_read_b64_tr_b16 a[206:207], v105 offset:61440
    v_mfma_f32_16x16x32_bf16 a[80:83], a[168:171], v[208:211], a[80:83]
    v_exp_f32 v201, v201
    v_mfma_f32_16x16x32_bf16 a[80:83], a[172:175], v[212:215], a[80:83]
    ds_read_b64_tr_b16 a[208:209], v106 offset:49152
    v_cvt_pk_bf16_f32 v220, v200, v201
    v_mfma_f32_16x16x32_bf16 a[96:99], a[176:179], v[208:211], a[96:99]
    v_exp_f32 v202, v202
    v_mfma_f32_16x16x32_bf16 a[96:99], a[180:183], v[212:215], a[96:99]
    buffer_load_dwordx4 v123, s[8:11], s48 offen offset:3072 sc1 lds
    v_mfma_f32_16x16x32_bf16 a[112:115], a[184:187], v[208:211], a[112:115]
    v_exp_f32 v203, v203
    v_mfma_f32_16x16x32_bf16 a[112:115], a[188:191], v[212:215], a[112:115]
    ds_read_b64_tr_b16 a[210:211], v106 offset:53248
    v_cvt_pk_bf16_f32 v221, v202, v203
    v_smfmac_f32_16x16x64_bf16 v[240:243], v[96:99], v[208:215], v119
    v_exp_f32 v204, v204
    v_mfma_f32_16x16x32_bf16 v[192:195], v[128:131], v[32:35], v[232:235]
    s_add_u32 m0, s52, 98304
    ds_read_b64_tr_b16 a[212:213], v106 offset:57344
    v_mfma_f32_16x16x32_bf16 v[192:195], v[132:135], v[36:39], v[192:195]
    v_exp_f32 v205, v205
    v_mfma_f32_16x16x32_bf16 v[192:195], v[136:139], v[40:43], v[192:195]
    ds_read_b64_tr_b16 a[214:215], v106 offset:61440
    v_cvt_pk_bf16_f32 v222, v204, v205
    v_mfma_f32_16x16x32_bf16 v[192:195], v[140:143], v[44:47], v[192:195]
    v_exp_f32 v206, v206
    v_mfma_f32_16x16x32_bf16 v[196:199], v[144:147], v[44:47], v[232:235]
    buffer_load_dwordx4 v124, s[12:15], s43 offen offset:0 sc1 lds
    v_mfma_f32_16x16x32_bf16 v[196:199], v[148:151], v[40:43], v[196:199]
    v_exp_f32 v207, v207
    v_mfma_f32_16x16x32_bf16 v[196:199], v[152:155], v[36:39], v[196:199]
    ds_read_b64_tr_b16 a[216:217], v107 offset:49152
    v_cvt_pk_bf16_f32 v223, v206, v207
    v_mfma_f32_16x16x32_bf16 v[196:199], v[156:159], v[32:35], v[196:199]
    ds_read_b64_tr_b16 a[218:219], v107 offset:53248
    v_mfma_f32_16x16x32_bf16 v[200:203], v[160:163], v[32:35], v[232:235]
    v_exp_f32 v192, v192
    v_mfma_f32_16x16x32_bf16 v[200:203], v[164:167], v[36:39], v[200:203]
    ds_read_b64_tr_b16 a[220:221], v107 offset:57344
    v_mfma_f32_16x16x32_bf16 v[200:203], v[168:171], v[40:43], v[200:203]
    v_exp_f32 v193, v193
    v_mfma_f32_16x16x32_bf16 v[200:203], v[172:175], v[44:47], v[200:203]
    ds_read_b64_tr_b16 a[222:223], v107 offset:61440
    v_cvt_pk_bf16_f32 v208, v192, v193
    v_mfma_f32_16x16x32_bf16 v[204:207], v[176:179], v[44:47], v[232:235]
    v_exp_f32 v194, v194
    v_mfma_f32_16x16x32_bf16 v[204:207], v[180:183], v[40:43], v[204:207]
    buffer_load_dwordx4 v125, s[12:15], s43 offen offset:1024 sc1 lds
    v_mfma_f32_16x16x32_bf16 v[204:207], v[184:187], v[36:39], v[204:207]
    v_exp_f32 v195, v195
    v_mfma_f32_16x16x32_bf16 v[204:207], v[188:191], v[32:35], v[204:207]
    ds_read_b64_tr_b16 a[224:225], v108 offset:49152
    v_cvt_pk_bf16_f32 v209, v194, v195
    v_mfma_f32_16x16x32_bf16 a[4:7], a[128:131], v[216:219], a[4:7]
    v_exp_f32 v196, v196
    v_mfma_f32_16x16x32_bf16 a[4:7], a[132:135], v[220:223], a[4:7]
    ds_read_b64_tr_b16 a[226:227], v108 offset:53248
    v_mfma_f32_16x16x32_bf16 a[20:23], a[136:139], v[216:219], a[20:23]
    v_exp_f32 v197, v197
    v_mfma_f32_16x16x32_bf16 a[20:23], a[140:143], v[220:223], a[20:23]
    ds_read_b64_tr_b16 a[228:229], v108 offset:57344
    v_cvt_pk_bf16_f32 v210, v196, v197
    v_mfma_f32_16x16x32_bf16 a[36:39], a[144:147], v[216:219], a[36:39]
    v_exp_f32 v198, v198
    v_mfma_f32_16x16x32_bf16 a[36:39], a[148:151], v[220:223], a[36:39]
    buffer_load_dwordx4 v124, s[12:15], s43 offen offset:2048 sc1 lds
    v_mfma_f32_16x16x32_bf16 a[52:55], a[152:155], v[216:219], a[52:55]
    v_exp_f32 v199, v199
    v_mfma_f32_16x16x32_bf16 a[52:55], a[156:159], v[220:223], a[52:55]
    ds_read_b64_tr_b16 a[230:231], v108 offset:61440
    v_cvt_pk_bf16_f32 v211, v198, v199
    v_mfma_f32_16x16x32_bf16 a[68:71], a[160:163], v[216:219], a[68:71]
    v_exp_f32 v200, v200
    v_mfma_f32_16x16x32_bf16 a[68:71], a[164:167], v[220:223], a[68:71]
    ds_read_b64_tr_b16 a[232:233], v109 offset:49152
    v_mfma_f32_16x16x32_bf16 a[84:87], a[168:171], v[216:219], a[84:87]
    v_exp_f32 v201, v201
    v_mfma_f32_16x16x32_bf16 a[84:87], a[172:175], v[220:223], a[84:87]
    ds_read_b64_tr_b16 a[234:235], v109 offset:53248
    v_cvt_pk_bf16_f32 v212, v200, v201
    v_mfma_f32_16x16x32_bf16 a[100:103], a[176:179], v[216:219], a[100:103]
    v_exp_f32 v202, v202
    v_mfma_f32_16x16x32_bf16 a[100:103], a[180:183], v[220:223], a[100:103]
    buffer_load_dwordx4 v125, s[12:15], s43 offen offset:3072 sc1 lds
    v_mfma_f32_16x16x32_bf16 a[116:119], a[184:187], v[216:219], a[116:119]
    v_exp_f32 v203, v203
    v_mfma_f32_16x16x32_bf16 a[116:119], a[188:191], v[220:223], a[116:119]
    ds_read_b64_tr_b16 a[236:237], v109 offset:57344
    v_cvt_pk_bf16_f32 v213, v202, v203
    v_smfmac_f32_16x16x64_bf16 v[244:247], v[96:99], v[216:223], v119
    v_exp_f32 v204, v204
    v_mfma_f32_16x16x32_bf16 v[192:195], v[128:131], v[48:51], v[236:239]
    s_add_u32 s48, s48, s77
    s_add_u32 s43, s43, s58
    v_mfma_f32_16x16x32_bf16 v[192:195], v[132:135], v[52:55], v[192:195]
    v_exp_f32 v205, v205
    v_mfma_f32_16x16x32_bf16 v[192:195], v[136:139], v[56:59], v[192:195]
    ds_read_b128 v[128:131], v100 offset:49152
    v_cvt_pk_bf16_f32 v214, v204, v205
    v_mfma_f32_16x16x32_bf16 v[192:195], v[140:143], v[60:63], v[192:195]
    v_exp_f32 v206, v206
    v_mfma_f32_16x16x32_bf16 v[196:199], v[144:147], v[60:63], v[236:239]
    ds_read_b128 v[132:135], v101 offset:49152
    ds_read_b128 v[136:139], v102 offset:49152
    v_mfma_f32_16x16x32_bf16 v[196:199], v[148:151], v[56:59], v[196:199]
    v_exp_f32 v207, v207
    v_mfma_f32_16x16x32_bf16 v[196:199], v[152:155], v[52:55], v[196:199]
    ds_read_b128 v[140:143], v103 offset:49152
    v_cvt_pk_bf16_f32 v215, v206, v207
    v_mfma_f32_16x16x32_bf16 v[196:199], v[156:159], v[48:51], v[196:199]
    ds_read_b128 v[144:147], v103 offset:53248
    v_mfma_f32_16x16x32_bf16 v[200:203], v[160:163], v[48:51], v[236:239]
    v_exp_f32 v192, v192
    v_mfma_f32_16x16x32_bf16 v[200:203], v[164:167], v[52:55], v[200:203]
    ds_read_b128 v[148:151], v102 offset:53248
    v_mfma_f32_16x16x32_bf16 v[200:203], v[168:171], v[56:59], v[200:203]
    v_exp_f32 v193, v193
    v_mfma_f32_16x16x32_bf16 v[200:203], v[172:175], v[60:63], v[200:203]
    ds_read_b128 v[152:155], v101 offset:53248
    v_cvt_pk_bf16_f32 v216, v192, v193
    v_mfma_f32_16x16x32_bf16 v[204:207], v[176:179], v[60:63], v[236:239]
    v_exp_f32 v194, v194
    v_mfma_f32_16x16x32_bf16 v[204:207], v[180:183], v[56:59], v[204:207]
    ds_read_b128 v[156:159], v100 offset:53248
    v_mfma_f32_16x16x32_bf16 v[204:207], v[184:187], v[52:55], v[204:207]
    v_exp_f32 v195, v195
    v_mfma_f32_16x16x32_bf16 v[204:207], v[188:191], v[48:51], v[204:207]
    ds_read_b128 v[160:163], v100 offset:57344
    v_cvt_pk_bf16_f32 v217, v194, v195
    v_mfma_f32_16x16x32_bf16 a[8:11], a[128:131], v[208:211], a[8:11]
    v_exp_f32 v196, v196
    v_mfma_f32_16x16x32_bf16 a[8:11], a[132:135], v[212:215], a[8:11]
    ds_read_b128 v[164:167], v101 offset:57344
    v_mfma_f32_16x16x32_bf16 a[24:27], a[136:139], v[208:211], a[24:27]
    v_exp_f32 v197, v197
    v_mfma_f32_16x16x32_bf16 a[24:27], a[140:143], v[212:215], a[24:27]
    ds_read_b128 v[168:171], v102 offset:57344
    v_cvt_pk_bf16_f32 v218, v196, v197
    v_mfma_f32_16x16x32_bf16 a[40:43], a[144:147], v[208:211], a[40:43]
    v_exp_f32 v198, v198
    v_mfma_f32_16x16x32_bf16 a[40:43], a[148:151], v[212:215], a[40:43]
    ds_read_b128 v[172:175], v103 offset:57344
    v_mfma_f32_16x16x32_bf16 a[56:59], a[152:155], v[208:211], a[56:59]
    v_exp_f32 v199, v199
    v_mfma_f32_16x16x32_bf16 a[56:59], a[156:159], v[212:215], a[56:59]
    ds_read_b128 v[176:179], v103 offset:61440
    v_cvt_pk_bf16_f32 v219, v198, v199
    v_mfma_f32_16x16x32_bf16 a[72:75], a[160:163], v[208:211], a[72:75]
    v_exp_f32 v200, v200
    v_mfma_f32_16x16x32_bf16 a[72:75], a[164:167], v[212:215], a[72:75]
    ds_read_b128 v[180:183], v102 offset:61440
    v_mfma_f32_16x16x32_bf16 a[88:91], a[168:171], v[208:211], a[88:91]
    v_exp_f32 v201, v201
    v_mfma_f32_16x16x32_bf16 a[88:91], a[172:175], v[212:215], a[88:91]
    ds_read_b128 v[184:187], v101 offset:61440
    v_cvt_pk_bf16_f32 v220, v200, v201
    v_mfma_f32_16x16x32_bf16 a[104:107], a[176:179], v[208:211], a[104:107]
    v_exp_f32 v202, v202
    v_mfma_f32_16x16x32_bf16 a[104:107], a[180:183], v[212:215], a[104:107]
    ds_read_b128 v[188:191], v100 offset:61440
    v_mfma_f32_16x16x32_bf16 a[120:123], a[184:187], v[208:211], a[120:123]
    v_exp_f32 v203, v203
    v_mfma_f32_16x16x32_bf16 a[120:123], a[188:191], v[212:215], a[120:123]
    s_waitcnt lgkmcnt(3)
    v_cvt_pk_bf16_f32 v221, v202, v203
    v_smfmac_f32_16x16x64_bf16 v[248:251], v[96:99], v[208:215], v119
    v_exp_f32 v204, v204
    v_mfma_f32_16x16x32_bf16 v[192:195], v[128:131], v[0:3], v[224:227]
    ds_read_b64_tr_b16 a[238:239], v109 offset:61440
    v_mfma_f32_16x16x32_bf16 v[192:195], v[132:135], v[4:7], v[192:195]
    v_exp_f32 v205, v205
    v_mfma_f32_16x16x32_bf16 v[192:195], v[136:139], v[8:11], v[192:195]
    ds_read_b64_tr_b16 a[240:241], v110 offset:49152
    v_cvt_pk_bf16_f32 v222, v204, v205
    v_mfma_f32_16x16x32_bf16 v[192:195], v[140:143], v[12:15], v[192:195]
    v_exp_f32 v206, v206
    v_mfma_f32_16x16x32_bf16 v[196:199], v[144:147], v[12:15], v[224:227]
    ds_read_b64_tr_b16 a[242:243], v110 offset:53248
    v_mfma_f32_16x16x32_bf16 v[196:199], v[148:151], v[8:11], v[196:199]
    v_exp_f32 v207, v207
    v_mfma_f32_16x16x32_bf16 v[196:199], v[152:155], v[4:7], v[196:199]
    ds_read_b64_tr_b16 a[244:245], v110 offset:57344
    v_cvt_pk_bf16_f32 v223, v206, v207
    v_mfma_f32_16x16x32_bf16 v[196:199], v[156:159], v[0:3], v[196:199]
    s_waitcnt lgkmcnt(4)
    v_mfma_f32_16x16x32_bf16 v[200:203], v[160:163], v[0:3], v[224:227]
    v_exp_f32 v192, v192
    v_mfma_f32_16x16x32_bf16 v[200:203], v[164:167], v[4:7], v[200:203]
    ds_read_b64_tr_b16 a[246:247], v110 offset:61440
    v_mfma_f32_16x16x32_bf16 v[200:203], v[168:171], v[8:11], v[200:203]
    v_exp_f32 v193, v193
    v_mfma_f32_16x16x32_bf16 v[200:203], v[172:175], v[12:15], v[200:203]
    ds_read_b64_tr_b16 a[248:249], v111 offset:49152
    v_cvt_pk_bf16_f32 v208, v192, v193
    v_mfma_f32_16x16x32_bf16 v[204:207], v[176:179], v[12:15], v[224:227]
    v_exp_f32 v194, v194
    v_mfma_f32_16x16x32_bf16 v[204:207], v[180:183], v[8:11], v[204:207]
    ds_read_b64_tr_b16 a[250:251], v111 offset:53248
    v_mfma_f32_16x16x32_bf16 v[204:207], v[184:187], v[4:7], v[204:207]
    v_exp_f32 v195, v195
    v_mfma_f32_16x16x32_bf16 v[204:207], v[188:191], v[0:3], v[204:207]
    ds_read_b64_tr_b16 a[252:253], v111 offset:57344
    v_cvt_pk_bf16_f32 v209, v194, v195
    v_mfma_f32_16x16x32_bf16 a[12:15], a[128:131], v[216:219], a[12:15]
    v_exp_f32 v196, v196
    v_mfma_f32_16x16x32_bf16 a[12:15], a[132:135], v[220:223], a[12:15]
    ds_read_b64_tr_b16 a[254:255], v111 offset:61440
    v_mfma_f32_16x16x32_bf16 a[28:31], a[136:139], v[216:219], a[28:31]
    v_exp_f32 v197, v197
    v_mfma_f32_16x16x32_bf16 a[28:31], a[140:143], v[220:223], a[28:31]
    v_cvt_pk_bf16_f32 v210, v196, v197
    v_mfma_f32_16x16x32_bf16 a[44:47], a[144:147], v[216:219], a[44:47]
    v_exp_f32 v198, v198
    v_mfma_f32_16x16x32_bf16 a[44:47], a[148:151], v[220:223], a[44:47]
    buffer_load_dword v74, v91, s[16:19], s68 offen
    v_mfma_f32_16x16x32_bf16 a[60:63], a[152:155], v[216:219], a[60:63]
    v_exp_f32 v199, v199
    v_mfma_f32_16x16x32_bf16 a[60:63], a[156:159], v[220:223], a[60:63]
    s_add_u32 s68, s68, 384
    v_cvt_pk_bf16_f32 v211, v198, v199
    v_mfma_f32_16x16x32_bf16 a[76:79], a[160:163], v[216:219], a[76:79]
    v_exp_f32 v200, v200
    v_mfma_f32_16x16x32_bf16 a[76:79], a[164:167], v[220:223], a[76:79]
    buffer_store_dwordx4 v[80:83], v84, s[88:91], s46 offen offset:1024 sc1
    v_mfma_f32_16x16x32_bf16 a[92:95], a[168:171], v[216:219], a[92:95]
    v_exp_f32 v201, v201
    v_mfma_f32_16x16x32_bf16 a[92:95], a[172:175], v[220:223], a[92:95]
    v_cvt_pk_bf16_f32 v212, v200, v201
    v_mfma_f32_16x16x32_bf16 a[108:111], a[176:179], v[216:219], a[108:111]
    v_exp_f32 v202, v202
    v_mfma_f32_16x16x32_bf16 a[108:111], a[180:183], v[220:223], a[108:111]
    s_cmp_eq_u32 s54, 7
    v_mfma_f32_16x16x32_bf16 a[124:127], a[184:187], v[216:219], a[124:127]
    v_exp_f32 v203, v203
    v_mfma_f32_16x16x32_bf16 a[124:127], a[188:191], v[220:223], a[124:127]
    v_cvt_pk_bf16_f32 v213, v202, v203
    v_smfmac_f32_16x16x64_bf16 v[252:255], v[96:99], v[216:223], v119
    v_exp_f32 v204, v204
    v_mfma_f32_16x16x32_bf16 v[192:195], v[128:131], v[16:19], v[228:231]
    s_cbranch_scc1 K1_LAST
    v_mfma_f32_16x16x32_bf16 v[192:195], v[132:135], v[20:23], v[192:195]
    v_exp_f32 v205, v205
    v_mfma_f32_16x16x32_bf16 v[192:195], v[136:139], v[24:27], v[192:195]
    v_cvt_pk_bf16_f32 v214, v204, v205
    v_mfma_f32_16x16x32_bf16 v[192:195], v[140:143], v[28:31], v[192:195]
    v_exp_f32 v206, v206
    v_mfma_f32_16x16x32_bf16 v[196:199], v[144:147], v[28:31], v[228:231]
    s_waitcnt vmcnt(18) lgkmcnt(0)
    s_add_u32 m0, s52, 49152
    v_mfma_f32_16x16x32_bf16 v[196:199], v[148:151], v[24:27], v[196:199]
    v_exp_f32 v207, v207
    v_mfma_f32_16x16x32_bf16 v[196:199], v[152:155], v[20:23], v[196:199]
    v_cvt_pk_bf16_f32 v215, v206, v207
    v_mfma_f32_16x16x32_bf16 v[196:199], v[156:159], v[16:19], v[196:199]
    s_barrier
    v_mfma_f32_16x16x32_bf16 v[200:203], v[160:163], v[16:19], v[228:231]
    v_exp_f32 v192, v192
    v_mfma_f32_16x16x32_bf16 v[200:203], v[164:167], v[20:23], v[200:203]
    buffer_load_dwordx4 v120, s[8:11], s48 offen offset:0 sc1 lds
    v_mfma_f32_16x16x32_bf16 v[200:203], v[168:171], v[24:27], v[200:203]
    v_exp_f32 v193, v193
    v_mfma_f32_16x16x32_bf16 v[200:203], v[172:175], v[28:31], v[200:203]
    ds_read_b64_tr_b16 a[128:129], v104 offset:0
    v_cvt_pk_bf16_f32 v216, v192, v193
    v_mfma_f32_16x16x32_bf16 v[204:207], v[176:179], v[28:31], v[228:231]
    v_exp_f32 v194, v194
    v_mfma_f32_16x16x32_bf16 v[204:207], v[180:183], v[24:27], v[204:207]
    ds_read_b64_tr_b16 a[130:131], v104 offset:4096
    ds_read_b64_tr_b16 a[132:133], v104 offset:8192
    v_mfma_f32_16x16x32_bf16 v[204:207], v[184:187], v[20:23], v[204:207]
    v_exp_f32 v195, v195
    v_mfma_f32_16x16x32_bf16 v[204:207], v[188:191], v[16:19], v[204:207]
    ds_read_b64_tr_b16 a[134:135], v104 offset:12288
    v_cvt_pk_bf16_f32 v217, v194, v195
    v_mfma_f32_16x16x32_bf16 a[0:3], a[192:195], v[208:211], a[0:3]
    v_exp_f32 v196, v196
    v_mfma_f32_16x16x32_bf16 a[0:3], a[196:199], v[212:215], a[0:3]
    buffer_load_dwordx4 v121, s[8:11], s48 offen offset:1024 sc1 lds
    v_mfma_f32_16x16x32_bf16 a[16:19], a[200:203], v[208:211], a[16:19]
    v_exp_f32 v197, v197
    v_mfma_f32_16x16x32_bf16 a[16:19], a[204:207], v[212:215], a[16:19]
    ds_read_b64_tr_b16 a[136:137], v105 offset:0
    v_cvt_pk_bf16_f32 v218, v196, v197
    v_mfma_f32_16x16x32_bf16 a[32:35], a[208:211], v[208:211], a[32:35]
    v_exp_f32 v198, v198
    v_mfma_f32_16x16x32_bf16 a[32:35], a[212:215], v[212:215], a[32:35]
    buffer_load_dwordx4 v122, s[8:11], s48 offen offset:2048 sc1 lds
    v_mfma_f32_16x16x32_bf16 a[48:51], a[216:219], v[208:211], a[48:51]
    v_exp_f32 v199, v199
    v_mfma_f32_16x16x32_bf16 a[48:51], a[220:223], v[212:215], a[48:51]
    ds_read_b64_tr_b16 a[138:139], v105 offset:4096
    v_cvt_pk_bf16_f32 v219, v198, v199
    v_mfma_f32_16x16x32_bf16 a[64:67], a[224:227], v[208:211], a[64:67]
    v_exp_f32 v200, v200
    v_mfma_f32_16x16x32_bf16 a[64:67], a[228:231], v[212:215], a[64:67]
    ds_read_b64_tr_b16 a[140:141], v105 offset:8192
    ds_read_b64_tr_b16 a[142:143], v105 offset:12288
    v_mfma_f32_16x16x32_bf16 a[80:83], a[232:235], v[208:211], a[80:83]
    v_exp_f32 v201, v201
    v_mfma_f32_16x16x32_bf16 a[80:83], a[236:239], v[212:215], a[80:83]
    ds_read_b64_tr_b16 a[144:145], v106 offset:0
    v_cvt_pk_bf16_f32 v220, v200, v201
    v_mfma_f32_16x16x32_bf16 a[96:99], a[240:243], v[208:211], a[96:99]
    v_exp_f32 v202, v202
    v_mfma_f32_16x16x32_bf16 a[96:99], a[244:247], v[212:215], a[96:99]
    buffer_load_dwordx4 v123, s[8:11], s48 offen offset:3072 sc1 lds
    v_mfma_f32_16x16x32_bf16 a[112:115], a[248:251], v[208:211], a[112:115]
    v_exp_f32 v203, v203
    v_mfma_f32_16x16x32_bf16 a[112:115], a[252:255], v[212:215], a[112:115]
    ds_read_b64_tr_b16 a[146:147], v106 offset:4096
    v_cvt_pk_bf16_f32 v221, v202, v203
    v_smfmac_f32_16x16x64_bf16 v[240:243], v[96:99], v[208:215], v119
    v_exp_f32 v204, v204
    v_mfma_f32_16x16x32_bf16 v[192:195], v[128:131], v[32:35], v[232:235]
    s_add_u32 m0, s52, 114688
    ds_read_b64_tr_b16 a[148:149], v106 offset:8192
    v_mfma_f32_16x16x32_bf16 v[192:195], v[132:135], v[36:39], v[192:195]
    v_exp_f32 v205, v205
    v_mfma_f32_16x16x32_bf16 v[192:195], v[136:139], v[40:43], v[192:195]
    ds_read_b64_tr_b16 a[150:151], v106 offset:12288
    v_cvt_pk_bf16_f32 v222, v204, v205
    v_mfma_f32_16x16x32_bf16 v[192:195], v[140:143], v[44:47], v[192:195]
    v_exp_f32 v206, v206
    v_mfma_f32_16x16x32_bf16 v[196:199], v[144:147], v[44:47], v[232:235]
    buffer_load_dwordx4 v124, s[12:15], s43 offen offset:0 sc1 lds
    v_mfma_f32_16x16x32_bf16 v[196:199], v[148:151], v[40:43], v[196:199]
    v_exp_f32 v207, v207
    v_mfma_f32_16x16x32_bf16 v[196:199], v[152:155], v[36:39], v[196:199]
    ds_read_b64_tr_b16 a[152:153], v107 offset:0
    v_cvt_pk_bf16_f32 v223, v206, v207
    v_mfma_f32_16x16x32_bf16 v[196:199], v[156:159], v[32:35], v[196:199]
    ds_read_b64_tr_b16 a[154:155], v107 offset:4096
    v_mfma_f32_16x16x32_bf16 v[200:203], v[160:163], v[32:35], v[232:235]
    v_exp_f32 v192, v192
    v_mfma_f32_16x16x32_bf16 v[200:203], v[164:167], v[36:39], v[200:203]
    ds_read_b64_tr_b16 a[156:157], v107 offset:8192
    v_mfma_f32_16x16x32_bf16 v[200:203], v[168:171], v[40:43], v[200:203]
    v_exp_f32 v193, v193
    v_mfma_f32_16x16x32_bf16 v[200:203], v[172:175], v[44:47], v[200:203]
    ds_read_b64_tr_b16 a[158:159], v107 offset:12288
    v_cvt_pk_bf16_f32 v208, v192, v193
    v_mfma_f32_16x16x32_bf16 v[204:207], v[176:179], v[44:47], v[232:235]
    v_exp_f32 v194, v194
    v_mfma_f32_16x16x32_bf16 v[204:207], v[180:183], v[40:43], v[204:207]
    buffer_load_dwordx4 v125, s[12:15], s43 offen offset:1024 sc1 lds
    v_mfma_f32_16x16x32_bf16 v[204:207], v[184:187], v[36:39], v[204:207]
    v_exp_f32 v195, v195
    v_mfma_f32_16x16x32_bf16 v[204:207], v[188:191], v[32:35], v[204:207]
    ds_read_b64_tr_b16 a[160:161], v108 offset:0
    v_cvt_pk_bf16_f32 v209, v194, v195
    v_mfma_f32_16x16x32_bf16 a[4:7], a[192:195], v[216:219], a[4:7]
    v_exp_f32 v196, v196
    v_mfma_f32_16x16x32_bf16 a[4:7], a[196:199], v[220:223], a[4:7]
    ds_read_b64_tr_b16 a[162:163], v108 offset:4096
    v_mfma_f32_16x16x32_bf16 a[20:23], a[200:203], v[216:219], a[20:23]
    v_exp_f32 v197, v197
    v_mfma_f32_16x16x32_bf16 a[20:23], a[204:207], v[220:223], a[20:23]
    ds_read_b64_tr_b16 a[164:165], v108 offset:8192
    v_cvt_pk_bf16_f32 v210, v196, v197
    v_mfma_f32_16x16x32_bf16 a[36:39], a[208:211], v[216:219], a[36:39]
    v_exp_f32 v198, v198
    v_mfma_f32_16x16x32_bf16 a[36:39], a[212:215], v[220:223], a[36:39]
    buffer_load_dwordx4 v124, s[12:15], s43 offen offset:2048 sc1 lds
    v_mfma_f32_16x16x32_bf16 a[52:55], a[216:219], v[216:219], a[52:55]
    v_exp_f32 v199, v199
    v_mfma_f32_16x16x32_bf16 a[52:55], a[220:223], v[220:223], a[52:55]
    ds_read_b64_tr_b16 a[166:167], v108 offset:12288
    v_cvt_pk_bf16_f32 v211, v198, v199
    v_mfma_f32_16x16x32_bf16 a[68:71], a[224:227], v[216:219], a[68:71]
    v_exp_f32 v200, v200
    v_mfma_f32_16x16x32_bf16 a[68:71], a[228:231], v[220:223], a[68:71]
    ds_read_b64_tr_b16 a[168:169], v109 offset:0
    v_mfma_f32_16x16x32_bf16 a[84:87], a[232:235], v[216:219], a[84:87]
    v_exp_f32 v201, v201
    v_mfma_f32_16x16x32_bf16 a[84:87], a[236:239], v[220:223], a[84:87]
    ds_read_b64_tr_b16 a[170:171], v109 offset:4096
    v_cvt_pk_bf16_f32 v212, v200, v201
    v_mfma_f32_16x16x32_bf16 a[100:103], a[240:243], v[216:219], a[100:103]
    v_exp_f32 v202, v202
    v_mfma_f32_16x16x32_bf16 a[100:103], a[244:247], v[220:223], a[100:103]
    buffer_load_dwordx4 v125, s[12:15], s43 offen offset:3072 sc1 lds
    v_mfma_f32_16x16x32_bf16 a[116:119], a[248:251], v[216:219], a[116:119]
    v_exp_f32 v203, v203
    v_mfma_f32_16x16x32_bf16 a[116:119], a[252:255], v[220:223], a[116:119]
    ds_read_b64_tr_b16 a[172:173], v109 offset:8192
    v_cvt_pk_bf16_f32 v213, v202, v203
    v_smfmac_f32_16x16x64_bf16 v[244:247], v[96:99], v[216:223], v119
    v_exp_f32 v204, v204
    v_mfma_f32_16x16x32_bf16 v[192:195], v[128:131], v[48:51], v[236:239]
    s_add_u32 s48, s48, s77
    s_add_u32 s43, s43, s58
    v_mfma_f32_16x16x32_bf16 v[192:195], v[132:135], v[52:55], v[192:195]
    v_exp_f32 v205, v205
    v_mfma_f32_16x16x32_bf16 v[192:195], v[136:139], v[56:59], v[192:195]
    ds_read_b128 v[128:131], v100 offset:0
    v_cvt_pk_bf16_f32 v214, v204, v205
    v_mfma_f32_16x16x32_bf16 v[192:195], v[140:143], v[60:63], v[192:195]
    v_exp_f32 v206, v206
    v_mfma_f32_16x16x32_bf16 v[196:199], v[144:147], v[60:63], v[236:239]
    ds_read_b128 v[132:135], v101 offset:0
    ds_read_b128 v[136:139], v102 offset:0
    v_mfma_f32_16x16x32_bf16 v[196:199], v[148:151], v[56:59], v[196:199]
    v_exp_f32 v207, v207
    v_mfma_f32_16x16x32_bf16 v[196:199], v[152:155], v[52:55], v[196:199]
    ds_read_b128 v[140:143], v103 offset:0
    v_cvt_pk_bf16_f32 v215, v206, v207
    v_mfma_f32_16x16x32_bf16 v[196:199], v[156:159], v[48:51], v[196:199]
    ds_read_b128 v[144:147], v103 offset:4096
    v_mfma_f32_16x16x32_bf16 v[200:203], v[160:163], v[48:51], v[236:239]
    v_exp_f32 v192, v192
    v_mfma_f32_16x16x32_bf16 v[200:203], v[164:167], v[52:55], v[200:203]
    ds_read_b128 v[148:151], v102 offset:4096
    v_mfma_f32_16x16x32_bf16 v[200:203], v[168:171], v[56:59], v[200:203]
    v_exp_f32 v193, v193
    v_mfma_f32_16x16x32_bf16 v[200:203], v[172:175], v[60:63], v[200:203]
    ds_read_b128 v[152:155], v101 offset:4096
    v_cvt_pk_bf16_f32 v216, v192, v193
    v_mfma_f32_16x16x32_bf16 v[204:207], v[176:179], v[60:63], v[236:239]
    v_exp_f32 v194, v194
    v_mfma_f32_16x16x32_bf16 v[204:207], v[180:183], v[56:59], v[204:207]
    ds_read_b128 v[156:159], v100 offset:4096
    v_mfma_f32_16x16x32_bf16 v[204:207], v[184:187], v[52:55], v[204:207]
    v_exp_f32 v195, v195
    v_mfma_f32_16x16x32_bf16 v[204:207], v[188:191], v[48:51], v[204:207]
    ds_read_b128 v[160:163], v100 offset:8192
    v_cvt_pk_bf16_f32 v217, v194, v195
    v_mfma_f32_16x16x32_bf16 a[8:11], a[192:195], v[208:211], a[8:11]
    v_exp_f32 v196, v196
    v_mfma_f32_16x16x32_bf16 a[8:11], a[196:199], v[212:215], a[8:11]
    ds_read_b128 v[164:167], v101 offset:8192
    v_mfma_f32_16x16x32_bf16 a[24:27], a[200:203], v[208:211], a[24:27]
    v_exp_f32 v197, v197
    v_mfma_f32_16x16x32_bf16 a[24:27], a[204:207], v[212:215], a[24:27]
    ds_read_b128 v[168:171], v102 offset:8192
    v_cvt_pk_bf16_f32 v218, v196, v197
    v_mfma_f32_16x16x32_bf16 a[40:43], a[208:211], v[208:211], a[40:43]
    v_exp_f32 v198, v198
    v_mfma_f32_16x16x32_bf16 a[40:43], a[212:215], v[212:215], a[40:43]
    ds_read_b128 v[172:175], v103 offset:8192
    v_mfma_f32_16x16x32_bf16 a[56:59], a[216:219], v[208:211], a[56:59]
    v_exp_f32 v199, v199
    v_mfma_f32_16x16x32_bf16 a[56:59], a[220:223], v[212:215], a[56:59]
    ds_read_b128 v[176:179], v103 offset:12288
    v_cvt_pk_bf16_f32 v219, v198, v199
    v_mfma_f32_16x16x32_bf16 a[72:75], a[224:227], v[208:211], a[72:75]
    v_exp_f32 v200, v200
    v_mfma_f32_16x16x32_bf16 a[72:75], a[228:231], v[212:215], a[72:75]
    ds_read_b128 v[180:183], v102 offset:12288
    v_mfma_f32_16x16x32_bf16 a[88:91], a[232:235], v[208:211], a[88:91]
    v_exp_f32 v201, v201
    v_mfma_f32_16x16x32_bf16 a[88:91], a[236:239], v[212:215], a[88:91]
    ds_read_b128 v[184:187], v101 offset:12288
    v_cvt_pk_bf16_f32 v220, v200, v201
    v_mfma_f32_16x16x32_bf16 a[104:107], a[240:243], v[208:211], a[104:107]
    v_exp_f32 v202, v202
    v_mfma_f32_16x16x32_bf16 a[104:107], a[244:247], v[212:215], a[104:107]
    ds_read_b128 v[188:191], v100 offset:12288
    v_mfma_f32_16x16x32_bf16 a[120:123], a[248:251], v[208:211], a[120:123]
    v_exp_f32 v203, v203
    v_mfma_f32_16x16x32_bf16 a[120:123], a[252:255], v[212:215], a[120:123]
    s_waitcnt lgkmcnt(3)
    v_cvt_pk_bf16_f32 v221, v202, v203
    v_smfmac_f32_16x16x64_bf16 v[248:251], v[96:99], v[208:215], v119
    v_exp_f32 v204, v204
    v_mfma_f32_16x16x32_bf16 v[192:195], v[128:131], v[0:3], v[224:227]
    ds_read_b64_tr_b16 a[174:175], v109 offset:12288
    v_mfma_f32_16x16x32_bf16 v[192:195], v[132:135], v[4:7], v[192:195]
    v_exp_f32 v205, v205
    v_mfma_f32_16x16x32_bf16 v[192:195], v[136:139], v[8:11], v[192:195]
    ds_read_b64_tr_b16 a[176:177], v110 offset:0
    v_cvt_pk_bf16_f32 v222, v204, v205
    v_mfma_f32_16x16x32_bf16 v[192:195], v[140:143], v[12:15], v[192:195]
    v_exp_f32 v206, v206
    v_mfma_f32_16x16x32_bf16 v[196:199], v[144:147], v[12:15], v[224:227]
    ds_read_b64_tr_b16 a[178:179], v110 offset:4096
    v_mfma_f32_16x16x32_bf16 v[196:199], v[148:151], v[8:11], v[196:199]
    v_exp_f32 v207, v207
    v_mfma_f32_16x16x32_bf16 v[196:199], v[152:155], v[4:7], v[196:199]
    ds_read_b64_tr_b16 a[180:181], v110 offset:8192
    v_cvt_pk_bf16_f32 v223, v206, v207
    v_mfma_f32_16x16x32_bf16 v[196:199], v[156:159], v[0:3], v[196:199]
    s_waitcnt lgkmcnt(4)
    v_mfma_f32_16x16x32_bf16 v[200:203], v[160:163], v[0:3], v[224:227]
    v_exp_f32 v192, v192
    v_mfma_f32_16x16x32_bf16 v[200:203], v[164:167], v[4:7], v[200:203]
    ds_read_b64_tr_b16 a[182:183], v110 offset:12288
    v_mfma_f32_16x16x32_bf16 v[200:203], v[168:171], v[8:11], v[200:203]
    v_exp_f32 v193, v193
    v_mfma_f32_16x16x32_bf16 v[200:203], v[172:175], v[12:15], v[200:203]
    ds_read_b64_tr_b16 a[184:185], v111 offset:0
    v_cvt_pk_bf16_f32 v208, v192, v193
    v_mfma_f32_16x16x32_bf16 v[204:207], v[176:179], v[12:15], v[224:227]
    v_exp_f32 v194, v194
    v_mfma_f32_16x16x32_bf16 v[204:207], v[180:183], v[8:11], v[204:207]
    ds_read_b64_tr_b16 a[186:187], v111 offset:4096
    v_mfma_f32_16x16x32_bf16 v[204:207], v[184:187], v[4:7], v[204:207]
    v_exp_f32 v195, v195
    v_mfma_f32_16x16x32_bf16 v[204:207], v[188:191], v[0:3], v[204:207]
    ds_read_b64_tr_b16 a[188:189], v111 offset:8192
    v_cvt_pk_bf16_f32 v209, v194, v195
    v_mfma_f32_16x16x32_bf16 a[12:15], a[192:195], v[216:219], a[12:15]
    v_exp_f32 v196, v196
    v_mfma_f32_16x16x32_bf16 a[12:15], a[196:199], v[220:223], a[12:15]
    ds_read_b64_tr_b16 a[190:191], v111 offset:12288
    v_mfma_f32_16x16x32_bf16 a[28:31], a[200:203], v[216:219], a[28:31]
    v_exp_f32 v197, v197
    v_mfma_f32_16x16x32_bf16 a[28:31], a[204:207], v[220:223], a[28:31]
    s_add_u32 s46, s46, s47
    v_cvt_pk_bf16_f32 v210, v196, v197
    v_mfma_f32_16x16x32_bf16 a[44:47], a[208:211], v[216:219], a[44:47]
    v_exp_f32 v198, v198
    v_mfma_f32_16x16x32_bf16 a[44:47], a[212:215], v[220:223], a[44:47]
    buffer_load_dword v75, v90, s[20:23], s69 offen
    v_mfma_f32_16x16x32_bf16 a[60:63], a[216:219], v[216:219], a[60:63]
    v_exp_f32 v199, v199
    v_mfma_f32_16x16x32_bf16 a[60:63], a[220:223], v[220:223], a[60:63]
    s_add_u32 s69, s69, 512
    v_cvt_pk_bf16_f32 v211, v198, v199
    v_mfma_f32_16x16x32_bf16 a[76:79], a[224:227], v[216:219], a[76:79]
    v_exp_f32 v200, v200
    v_mfma_f32_16x16x32_bf16 a[76:79], a[228:231], v[220:223], a[76:79]
    s_add_u32 s54, s54, 1
    s_and_b32 s46, s46, 0x3ffff
    v_mfma_f32_16x16x32_bf16 a[92:95], a[232:235], v[216:219], a[92:95]
    v_exp_f32 v201, v201
    v_mfma_f32_16x16x32_bf16 a[92:95], a[236:239], v[220:223], a[92:95]
    s_sub_u32 s47, 0x10000, s47
    v_cvt_pk_bf16_f32 v212, v200, v201
    v_mfma_f32_16x16x32_bf16 a[108:111], a[240:243], v[216:219], a[108:111]
    v_exp_f32 v202, v202
    v_mfma_f32_16x16x32_bf16 a[108:111], a[244:247], v[220:223], a[108:111]
    s_cmp_lt_u32 s54, s56
    v_mfma_f32_16x16x32_bf16 a[124:127], a[248:251], v[216:219], a[124:127]
    v_exp_f32 v203, v203
    v_mfma_f32_16x16x32_bf16 a[124:127], a[252:255], v[220:223], a[124:127]
    v_cvt_pk_bf16_f32 v213, v202, v203
    v_smfmac_f32_16x16x64_bf16 v[252:255], v[96:99], v[216:223], v119
    v_exp_f32 v204, v204
    v_mfma_f32_16x16x32_bf16 v[192:195], v[128:131], v[16:19], v[228:231]
    s_cbranch_scc1 K1_LOOP
    s_cmp_eq_u32 s54, 7
    s_cbranch_scc1 K1_BLKL
    s_cmp_eq_u32 s54, 5
    s_cbranch_scc1 K1_BLKC
    s_mov_b32 s56, 5
    s_cmp_lg_u32 s3, 0
    s_cbranch_scc1 K1_LOOP
    v_mov_b32 v127, s62
    s_mov_b64 exec, 1
    buffer_store_dword v127, off, s[88:91], s63 offset:4 sc1
    s_mov_b64 exec, -1
    s_branch K1_LOOP
K1_BLKC:
    v_and_b32 v68, 31, v126
    v_and_b32 v69, 3, v68
    v_lshl_add_u32 v69, s78, 2, v69
    v_lshrrev_b32 v115, 2, v68
    v_lshl_add_u32 v115, v69, 3, v115
    v_lshlrev_b32 v115, 7, v115
    v_add_u32 v115, 149946368, v115
    s_and_b32 s6, s2, 0xfc
    v_and_b32 v68, 3, v126
    v_add_u32 v68, s6, v68
    v_cmp_gt_u32 vcc, 32, v126
    v_lshlrev_b32 v68, 7, v68
    v_add_u32 v68, 149946368, v68
    v_cndmask_b32 v115, v68, v115, vcc
    buffer_load_dword v114, v115, s[88:91], 0 offen offset:4 sc1
    s_mov_b32 s56, 7
    s_branch K1_LOOP
K1_BLKL:
    v_cmp_ne_u32 vcc, s62, v114
    s_mov_b32 s57, 0
    s_cbranch_vccz K1_D1OK
K1_D1POLL:
    buffer_load_dword v114, v115, s[88:91], 0 offen offset:4 sc1
    s_add_u32 s57, s57, 1
    s_sleep 8
    s_waitcnt vmcnt(0)
    v_cmp_ne_u32 vcc, s62, v114
    s_cmp_gt_u32 s57, 131072
    s_cbranch_scc1 K1_D1OK
    s_cbranch_vccnz K1_D1POLL
K1_D1OK:
    s_mov_b32 s12, s66
    s_mov_b32 s13, s67
    s_mov_b32 s14, 0
    s_mov_b32 s15, 0x00020000
    s_mov_b32 s14, s75
    s_mov_b32 s53, 0
    s_mov_b32 s8, s36
    s_mov_b32 s9, s37
    s_mov_b32 s10, s38
    v_lshrrev_b32 v85, 3, v126
    v_and_b32 v86, 7, v126
    v_and_b32 v87, 6, v85
    v_xor_b32 v86, v86, v87
    v_lshlrev_b32 v85, 10, v85
    v_lshl_add_u32 v120, v86, 4, v85
    v_add_u32 v121, 7168, v120
    v_add_u32 v122, 14336, v120
    v_add_u32 v123, 21504, v120
    v_mov_b32 v124, v118
    v_mov_b32 v125, v118
    s_mul_i32 s48, s74, 360448
    s_mov_b32 s77, 65536
    s_mul_i32 s43, s74, 45056
    s_add_u32 s43, s43, 524288
    s_movk_i32 s58, 8192
    s_lshr_b32 s6, s3, 1
    s_lshl_b32 s6, s6, 12
    s_add_u32 s6, s6, 65536
    s_lshl_b32 s7, s74, 10
    v_add_u32 v85, s6, v118
    v_add_u32 v68, s7, v85
    s_add_u32 s7, s7, 1024
    s_and_b32 s7, s7, 0xc00
    v_add_u32 v69, s7, v85
    s_add_u32 s7, s7, 1024
    s_and_b32 s7, s7, 0xc00
    v_add_u32 v70, s7, v85
    s_add_u32 s7, s7, 1024
    s_and_b32 s7, s7, 0xc00
    v_add_u32 v71, s7, v85
    s_and_b32 s6, s3, 1
    s_lshl_b32 s6, s6, 12
    v_lshrrev_b32 v85, 2, v126
    v_and_b32 v86, 3, v126
    v_bfe_u32 v87, v126, 3, 2
    v_lshlrev_b32 v85, 7, v85
    v_lshl_add_u32 v85, v86, 3, v85
    v_add_u32 v85, s6, v85
    v_xor_b32 v86, 0, v87
    v_lshl_add_u32 v76, v86, 5, v85
    v_xor_b32 v86, 1, v87
    v_lshl_add_u32 v77, v86, 5, v85
    v_xor_b32 v86, 2, v87
    v_lshl_add_u32 v78, v86, 5, v85
    v_xor_b32 v86, 3, v87
    v_lshl_add_u32 v79, v86, 5, v85
    s_mov_b32 s56, 8
    s_branch K1_LOOP
K1_SLOW:
    v_mov_b32 v64, 0xff800000
    v_mov_b32 v65, 0xff800000
    v_mov_b32 v66, 0xff800000
    v_mov_b32 v67, 0xff800000
    s_mov_b32 s48, 0
    s_waitcnt vmcnt(0)
    s_mov_b32 s8, s98
    s_mov_b32 s9, s99
    s_mov_b32 s10, 524288
    s_mov_b32 s11, 0x00020000
    s_mov_b32 s12, s100
    s_mov_b32 s13, s101
    s_mov_b32 s14, 524288
    s_mov_b32 s15, 0x00020000
    s_movk_i32 s77, 16384
    s_movk_i32 s58, 16384
    s_mov_b32 s43, 0
    v_and_b32 v72, 15, v126
    v_lshrrev_b32 v73, 4, v126
    s_lshl_b32 s6, s3, 4
    v_add_u32 v74, s6, v73
    v_lshlrev_b32 v74, 8, v74
    v_xor_b32 v75, v72, v73
    v_xor_b32 v76, 0, v75
    v_lshl_add_u32 v120, v76, 4, v74
    v_xor_b32 v76, 4, v75
    v_lshl_add_u32 v121, v76, 4, v74
    v_xor_b32 v76, 8, v75
    v_lshl_add_u32 v122, v76, 4, v74
    v_xor_b32 v76, 12, v75
    v_lshl_add_u32 v123, v76, 4, v74
    v_lshlrev_b32 v75, 1, v73
    v_xor_b32 v75, v75, v72
    v_xor_b32 v76, 0, v75
    v_lshl_add_u32 v124, v76, 4, v74
    v_xor_b32 v76, 8, v75
    v_lshl_add_u32 v125, v76, 4, v74
    v_and_b32 v72, 15, v126
    v_lshrrev_b32 v73, 4, v126
    v_lshrrev_b32 v74, 2, v72
    v_and_b32 v75, 3, v126
    v_lshlrev_b32 v76, 8, v72
    v_and_b32 v78, 1, v73
    v_lshrrev_b32 v79, 1, v73
    v_lshl_add_u32 v78, v78, 1, v79
    v_xor_b32 v78, v78, v72
    v_xor_b32 v77, 0, v78
    v_lshl_add_u32 v100, v77, 4, v76
    v_xor_b32 v77, 4, v78
    v_lshl_add_u32 v101, v77, 4, v76
    v_xor_b32 v77, 8, v78
    v_lshl_add_u32 v102, v77, 4, v76
    v_xor_b32 v77, 12, v78
    v_lshl_add_u32 v103, v77, 4, v76
    v_lshl_add_u32 v76, v73, 2, v74
    v_and_b32 v77, 7, v76
    v_lshlrev_b32 v76, 8, v76
    v_lshl_add_u32 v76, v75, 3, v76
    v_add_u32 v76, 65536, v76
    v_xor_b32 v78, 0, v77
    v_lshl_add_u32 v104, v78, 5, v76
    v_xor_b32 v78, 1, v77
    v_lshl_add_u32 v105, v78, 5, v76
    v_xor_b32 v78, 2, v77
    v_lshl_add_u32 v106, v78, 5, v76
    v_xor_b32 v78, 3, v77
    v_lshl_add_u32 v107, v78, 5, v76
    v_xor_b32 v78, 4, v77
    v_lshl_add_u32 v108, v78, 5, v76
    v_xor_b32 v78, 5, v77
    v_lshl_add_u32 v109, v78, 5, v76
    v_xor_b32 v78, 6, v77
    v_lshl_add_u32 v110, v78, 5, v76
    v_xor_b32 v78, 7, v77
    v_lshl_add_u32 v111, v78, 5, v76
K1_SLOWLOOP:
    s_barrier
    s_mov_b32 m0, s52
    s_nop 0
    buffer_load_dwordx4 v120, s[8:11], s48 offen offset:0 lds
    buffer_load_dwordx4 v121, s[8:11], s48 offen offset:1024 lds
    buffer_load_dwordx4 v122, s[8:11], s48 offen offset:2048 lds
    buffer_load_dwordx4 v123, s[8:11], s48 offen offset:3072 lds
    s_waitcnt vmcnt(0)
    s_barrier
    ds_read_b128 v[128:131], v100 offset:0
    ds_read_b128 v[132:135], v101 offset:0
    ds_read_b128 v[136:139], v102 offset:0
    ds_read_b128 v[140:143], v103 offset:0
    ds_read_b128 v[144:147], v103 offset:4096
    ds_read_b128 v[148:151], v102 offset:4096
    ds_read_b128 v[152:155], v101 offset:4096
    ds_read_b128 v[156:159], v100 offset:4096
    ds_read_b128 v[160:163], v100 offset:8192
    ds_read_b128 v[164:167], v101 offset:8192
    ds_read_b128 v[168:171], v102 offset:8192
    ds_read_b128 v[172:175], v103 offset:8192
    ds_read_b128 v[176:179], v103 offset:12288
    ds_read_b128 v[180:183], v102 offset:12288
    ds_read_b128 v[184:187], v101 offset:12288
    ds_read_b128 v[188:191], v100 offset:12288
    s_waitcnt lgkmcnt(0)
    v_mfma_f32_16x16x32_bf16 v[192:195], v[128:131], v[0:3], 0
    v_mfma_f32_16x16x32_bf16 v[192:195], v[132:135], v[4:7], v[192:195]
    v_mfma_f32_16x16x32_bf16 v[192:195], v[136:139], v[8:11], v[192:195]
    v_mfma_f32_16x16x32_bf16 v[192:195], v[140:143], v[12:15], v[192:195]
    v_mfma_f32_16x16x32_bf16 v[196:199], v[144:147], v[12:15], 0
    v_mfma_f32_16x16x32_bf16 v[196:199], v[148:151], v[8:11], v[196:199]
    v_mfma_f32_16x16x32_bf16 v[196:199], v[152:155], v[4:7], v[196:199]
    v_mfma_f32_16x16x32_bf16 v[196:199], v[156:159], v[0:3], v[196:199]
    v_mfma_f32_16x16x32_bf16 v[200:203], v[160:163], v[0:3], 0
    v_mfma_f32_16x16x32_bf16 v[200:203], v[164:167], v[4:7], v[200:203]
    v_mfma_f32_16x16x32_bf16 v[200:203], v[168:171], v[8:11], v[200:203]
    v_mfma_f32_16x16x32_bf16 v[200:203], v[172:175], v[12:15], v[200:203]
    v_mfma_f32_16x16x32_bf16 v[204:207], v[176:179], v[12:15], 0
    v_mfma_f32_16x16x32_bf16 v[204:207], v[180:183], v[8:11], v[204:207]
    v_mfma_f32_16x16x32_bf16 v[204:207], v[184:187], v[4:7], v[204:207]
    v_mfma_f32_16x16x32_bf16 v[204:207], v[188:191], v[0:3], v[204:207]
    s_nop 7
    v_max3_f32 v64, v64, v192, v193
    v_max3_f32 v64, v64, v194, v195
    v_max3_f32 v64, v64, v196, v197
    v_max3_f32 v64, v64, v198, v199
    v_max3_f32 v64, v64, v200, v201
    v_max3_f32 v64, v64, v202, v203
    v_max3_f32 v64, v64, v204, v205
    v_max3_f32 v64, v64, v206, v207
    s_nop 3
    v_mfma_f32_16x16x32_bf16 v[192:195], v[128:131], v[16:19], 0
    v_mfma_f32_16x16x32_bf16 v[192:195], v[132:135], v[20:23], v[192:195]
    v_mfma_f32_16x16x32_bf16 v[192:195], v[136:139], v[24:27], v[192:195]
    v_mfma_f32_16x16x32_bf16 v[192:195], v[140:143], v[28:31], v[192:195]
    v_mfma_f32_16x16x32_bf16 v[196:199], v[144:147], v[28:31], 0
    v_mfma_f32_16x16x32_bf16 v[196:199], v[148:151], v[24:27], v[196:199]
    v_mfma_f32_16x16x32_bf16 v[196:199], v[152:155], v[20:23], v[196:199]
    v_mfma_f32_16x16x32_bf16 v[196:199], v[156:159], v[16:19], v[196:199]
    v_mfma_f32_16x16x32_bf16 v[200:203], v[160:163], v[16:19], 0
    v_mfma_f32_16x16x32_bf16 v[200:203], v[164:167], v[20:23], v[200:203]
    v_mfma_f32_16x16x32_bf16 v[200:203], v[168:171], v[24:27], v[200:203]
    v_mfma_f32_16x16x32_bf16 v[200:203], v[172:175], v[28:31], v[200:203]
    v_mfma_f32_16x16x32_bf16 v[204:207], v[176:179], v[28:31], 0
    v_mfma_f32_16x16x32_bf16 v[204:207], v[180:183], v[24:27], v[204:207]
    v_mfma_f32_16x16x32_bf16 v[204:207], v[184:187], v[20:23], v[204:207]
    v_mfma_f32_16x16x32_bf16 v[204:207], v[188:191], v[16:19], v[204:207]
    s_nop 7
    v_max3_f32 v65, v65, v192, v193
    v_max3_f32 v65, v65, v194, v195
    v_max3_f32 v65, v65, v196, v197
    v_max3_f32 v65, v65, v198, v199
    v_max3_f32 v65, v65, v200, v201
    v_max3_f32 v65, v65, v202, v203
    v_max3_f32 v65, v65, v204, v205
    v_max3_f32 v65, v65, v206, v207
    s_nop 3
    v_mfma_f32_16x16x32_bf16 v[192:195], v[128:131], v[32:35], 0
    v_mfma_f32_16x16x32_bf16 v[192:195], v[132:135], v[36:39], v[192:195]
    v_mfma_f32_16x16x32_bf16 v[192:195], v[136:139], v[40:43], v[192:195]
    v_mfma_f32_16x16x32_bf16 v[192:195], v[140:143], v[44:47], v[192:195]
    v_mfma_f32_16x16x32_bf16 v[196:199], v[144:147], v[44:47], 0
    v_mfma_f32_16x16x32_bf16 v[196:199], v[148:151], v[40:43], v[196:199]
    v_mfma_f32_16x16x32_bf16 v[196:199], v[152:155], v[36:39], v[196:199]
    v_mfma_f32_16x16x32_bf16 v[196:199], v[156:159], v[32:35], v[196:199]
    v_mfma_f32_16x16x32_bf16 v[200:203], v[160:163], v[32:35], 0
    v_mfma_f32_16x16x32_bf16 v[200:203], v[164:167], v[36:39], v[200:203]
    v_mfma_f32_16x16x32_bf16 v[200:203], v[168:171], v[40:43], v[200:203]
    v_mfma_f32_16x16x32_bf16 v[200:203], v[172:175], v[44:47], v[200:203]
    v_mfma_f32_16x16x32_bf16 v[204:207], v[176:179], v[44:47], 0
    v_mfma_f32_16x16x32_bf16 v[204:207], v[180:183], v[40:43], v[204:207]
    v_mfma_f32_16x16x32_bf16 v[204:207], v[184:187], v[36:39], v[204:207]
    v_mfma_f32_16x16x32_bf16 v[204:207], v[188:191], v[32:35], v[204:207]
    s_nop 7
    v_max3_f32 v66, v66, v192, v193
    v_max3_f32 v66, v66, v194, v195
    v_max3_f32 v66, v66, v196, v197
    v_max3_f32 v66, v66, v198, v199
    v_max3_f32 v66, v66, v200, v201
    v_max3_f32 v66, v66, v202, v203
    v_max3_f32 v66, v66, v204, v205
    v_max3_f32 v66, v66, v206, v207
    s_nop 3
    v_mfma_f32_16x16x32_bf16 v[192:195], v[128:131], v[48:51], 0
    v_mfma_f32_16x16x32_bf16 v[192:195], v[132:135], v[52:55], v[192:195]
    v_mfma_f32_16x16x32_bf16 v[192:195], v[136:139], v[56:59], v[192:195]
    v_mfma_f32_16x16x32_bf16 v[192:195], v[140:143], v[60:63], v[192:195]
    v_mfma_f32_16x16x32_bf16 v[196:199], v[144:147], v[60:63], 0
    v_mfma_f32_16x16x32_bf16 v[196:199], v[148:151], v[56:59], v[196:199]
    v_mfma_f32_16x16x32_bf16 v[196:199], v[152:155], v[52:55], v[196:199]
    v_mfma_f32_16x16x32_bf16 v[196:199], v[156:159], v[48:51], v[196:199]
    v_mfma_f32_16x16x32_bf16 v[200:203], v[160:163], v[48:51], 0
    v_mfma_f32_16x16x32_bf16 v[200:203], v[164:167], v[52:55], v[200:203]
    v_mfma_f32_16x16x32_bf16 v[200:203], v[168:171], v[56:59], v[200:203]
    v_mfma_f32_16x16x32_bf16 v[200:203], v[172:175], v[60:63], v[200:203]
    v_mfma_f32_16x16x32_bf16 v[204:207], v[176:179], v[60:63], 0
    v_mfma_f32_16x16x32_bf16 v[204:207], v[180:183], v[56:59], v[204:207]
    v_mfma_f32_16x16x32_bf16 v[204:207], v[184:187], v[52:55], v[204:207]
    v_mfma_f32_16x16x32_bf16 v[204:207], v[188:191], v[48:51], v[204:207]
    s_nop 7
    v_max3_f32 v67, v67, v192, v193
    v_max3_f32 v67, v67, v194, v195
    v_max3_f32 v67, v67, v196, v197
    v_max3_f32 v67, v67, v198, v199
    v_max3_f32 v67, v67, v200, v201
    v_max3_f32 v67, v67, v202, v203
    v_max3_f32 v67, v67, v204, v205
    v_max3_f32 v67, v67, v206, v207
    s_nop 3
    s_add_u32 s48, s48, 16384
    s_cmp_lt_u32 s48, 524288
    s_cbranch_scc1 K1_SLOWLOOP
    v_mov_b32 v68, v64
    v_mov_b32 v69, v65
    v_mov_b32 v70, v66
    v_mov_b32 v71, v67
    v_permlane32_swap_b32 v64, v68
    v_permlane32_swap_b32 v65, v69
    v_permlane32_swap_b32 v66, v70
    v_permlane32_swap_b32 v67, v71
    v_max_f32 v64, v64, v68
    v_max_f32 v65, v65, v69
    v_max_f32 v66, v66, v70
    v_max_f32 v67, v67, v71
    v_mov_b32 v68, v64
    v_mov_b32 v69, v65
    v_mov_b32 v70, v66
    v_mov_b32 v71, v67
    v_permlane16_swap_b32 v64, v68
    v_permlane16_swap_b32 v65, v69
    v_permlane16_swap_b32 v66, v70
    v_permlane16_swap_b32 v67, v71
    v_max_f32 v64, v64, v68
    v_max_f32 v65, v65, v69
    v_max_f32 v66, v66, v70
    v_max_f32 v67, v67, v71
    v_sub_f32 v224, 0, v64
    v_sub_f32 v225, 0, v64
    v_sub_f32 v226, 0, v64
    v_sub_f32 v227, 0, v64
    v_sub_f32 v228, 0, v65
    v_sub_f32 v229, 0, v65
    v_sub_f32 v230, 0, v65
    v_sub_f32 v231, 0, v65
    v_sub_f32 v232, 0, v66
    v_sub_f32 v233, 0, v66
    v_sub_f32 v234, 0, v66
    v_sub_f32 v235, 0, v66
    v_sub_f32 v236, 0, v67
    v_sub_f32 v237, 0, v67
    v_sub_f32 v238, 0, v67
    v_sub_f32 v239, 0, v67
    s_mov_b32 s59, 1
    s_mov_b32 s48, 0
    s_barrier
    s_add_u32 m0, s52, 0
    s_nop 0
    buffer_load_dwordx4 v120, s[8:11], s48 offen offset:0 sc1 lds
    buffer_load_dwordx4 v121, s[8:11], s48 offen offset:1024 sc1 lds
    buffer_load_dwordx4 v122, s[8:11], s48 offen offset:2048 sc1 lds
    buffer_load_dwordx4 v123, s[8:11], s48 offen offset:3072 sc1 lds
    s_add_u32 m0, s52, 65536
    s_nop 0
    buffer_load_dwordx4 v124, s[12:15], s43 offen offset:0 sc1 lds
    buffer_load_dwordx4 v125, s[12:15], s43 offen offset:1024 sc1 lds
    buffer_load_dwordx4 v124, s[12:15], s43 offen offset:2048 sc1 lds
    buffer_load_dwordx4 v125, s[12:15], s43 offen offset:3072 sc1 lds
    s_add_u32 s48, s48, s77
    s_add_u32 s43, s43, s58
    s_add_u32 m0, s52, 16384
    s_nop 0
    buffer_load_dwordx4 v120, s[8:11], s48 offen offset:0 sc1 lds
    buffer_load_dwordx4 v121, s[8:11], s48 offen offset:1024 sc1 lds
    buffer_load_dwordx4 v122, s[8:11], s48 offen offset:2048 sc1 lds
    buffer_load_dwordx4 v123, s[8:11], s48 offen offset:3072 sc1 lds
    s_add_u32 m0, s52, 81920
    s_nop 0
    buffer_load_dwordx4 v124, s[12:15], s43 offen offset:0 sc1 lds
    buffer_load_dwordx4 v125, s[12:15], s43 offen offset:1024 sc1 lds
    buffer_load_dwordx4 v124, s[12:15], s43 offen offset:2048 sc1 lds
    buffer_load_dwordx4 v125, s[12:15], s43 offen offset:3072 sc1 lds
    s_add_u32 s48, s48, s77
    s_add_u32 s43, s43, s58
    s_add_u32 m0, s52, 32768
    s_nop 0
    buffer_load_dwordx4 v120, s[8:11], s48 offen offset:0 sc1 lds
    buffer_load_dwordx4 v121, s[8:11], s48 offen offset:1024 sc1 lds
    buffer_load_dwordx4 v122, s[8:11], s48 offen offset:2048 sc1 lds
    buffer_load_dwordx4 v123, s[8:11], s48 offen offset:3072 sc1 lds
    s_add_u32 m0, s52, 98304
    s_nop 0
    buffer_load_dwordx4 v124, s[12:15], s43 offen offset:0 sc1 lds
    buffer_load_dwordx4 v125, s[12:15], s43 offen offset:1024 sc1 lds
    buffer_load_dwordx4 v124, s[12:15], s43 offen offset:2048 sc1 lds
    buffer_load_dwordx4 v125, s[12:15], s43 offen offset:3072 sc1 lds
    s_add_u32 s48, s48, s77
    s_add_u32 s43, s43, s58
    s_add_u32 m0, s52, 49152
    s_nop 0
    buffer_load_dwordx4 v120, s[8:11], s48 offen offset:0 sc1 lds
    buffer_load_dwordx4 v121, s[8:11], s48 offen offset:1024 sc1 lds
    buffer_load_dwordx4 v122, s[8:11], s48 offen offset:2048 sc1 lds
    buffer_load_dwordx4 v123, s[8:11], s48 offen offset:3072 sc1 lds
    s_add_u32 m0, s52, 114688
    s_nop 0
    buffer_load_dwordx4 v124, s[12:15], s43 offen offset:0 sc1 lds
    buffer_load_dwordx4 v125, s[12:15], s43 offen offset:1024 sc1 lds
    buffer_load_dwordx4 v124, s[12:15], s43 offen offset:2048 sc1 lds
    buffer_load_dwordx4 v125, s[12:15], s43 offen offset:3072 sc1 lds
    s_add_u32 s48, s48, s77
    s_add_u32 s43, s43, s58
    s_waitcnt vmcnt(0)
    s_barrier
    ds_read_b128 v[128:131], v100 offset:0
    ds_read_b128 v[132:135], v101 offset:0
    ds_read_b128 v[136:139], v102 offset:0
    ds_read_b128 v[140:143], v103 offset:0
    ds_read_b128 v[144:147], v103 offset:4096
    ds_read_b128 v[148:151], v102 offset:4096
    ds_read_b128 v[152:155], v101 offset:4096
    ds_read_b128 v[156:159], v100 offset:4096
    ds_read_b128 v[160:163], v100 offset:8192
    ds_read_b128 v[164:167], v101 offset:8192
    ds_read_b128 v[168:171], v102 offset:8192
    ds_read_b128 v[172:175], v103 offset:8192
    ds_read_b128 v[176:179], v103 offset:12288
    ds_read_b128 v[180:183], v102 offset:12288
    ds_read_b128 v[184:187], v101 offset:12288
    ds_read_b128 v[188:191], v100 offset:12288
    ds_read_b64_tr_b16 a[128:129], v104 offset:0
    ds_read_b64_tr_b16 a[130:131], v104 offset:4096
    ds_read_b64_tr_b16 a[132:133], v104 offset:8192
    ds_read_b64_tr_b16 a[134:135], v104 offset:12288
    ds_read_b64_tr_b16 a[136:137], v105 offset:0
    ds_read_b64_tr_b16 a[138:139], v105 offset:4096
    ds_read_b64_tr_b16 a[140:141], v105 offset:8192
    ds_read_b64_tr_b16 a[142:143], v105 offset:12288
    ds_read_b64_tr_b16 a[144:145], v106 offset:0
    ds_read_b64_tr_b16 a[146:147], v106 offset:4096
    ds_read_b64_tr_b16 a[148:149], v106 offset:8192
    ds_read_b64_tr_b16 a[150:151], v106 offset:12288
    ds_read_b64_tr_b16 a[152:153], v107 offset:0
    ds_read_b64_tr_b16 a[154:155], v107 offset:4096
    ds_read_b64_tr_b16 a[156:157], v107 offset:8192
    ds_read_b64_tr_b16 a[158:159], v107 offset:12288
    ds_read_b64_tr_b16 a[160:161], v108 offset:0
    ds_read_b64_tr_b16 a[162:163], v108 offset:4096
    ds_read_b64_tr_b16 a[164:165], v108 offset:8192
    ds_read_b64_tr_b16 a[166:167], v108 offset:12288
    ds_read_b64_tr_b16 a[168:169], v109 offset:0
    ds_read_b64_tr_b16 a[170:171], v109 offset:4096
    ds_read_b64_tr_b16 a[172:173], v109 offset:8192
    ds_read_b64_tr_b16 a[174:175], v109 offset:12288
    ds_read_b64_tr_b16 a[176:177], v110 offset:0
    ds_read_b64_tr_b16 a[178:179], v110 offset:4096
    ds_read_b64_tr_b16 a[180:181], v110 offset:8192
    ds_read_b64_tr_b16 a[182:183], v110 offset:12288
    ds_read_b64_tr_b16 a[184:185], v111 offset:0
    ds_read_b64_tr_b16 a[186:187], v111 offset:4096
    ds_read_b64_tr_b16 a[188:189], v111 offset:8192
    ds_read_b64_tr_b16 a[190:191], v111 offset:12288
    v_mov_b32 v240, 0
    v_mov_b32 v241, 0
    v_mov_b32 v242, 0
    v_mov_b32 v243, 0
    v_mov_b32 v244, 0
    v_mov_b32 v245, 0
    v_mov_b32 v246, 0
    v_mov_b32 v247, 0
    v_mov_b32 v248, 0
    v_mov_b32 v249, 0
    v_mov_b32 v250, 0
    v_mov_b32 v251, 0
    v_mov_b32 v252, 0
    v_mov_b32 v253, 0
    v_mov_b32 v254, 0
    v_mov_b32 v255, 0
    v_mfma_f32_32x32x16_bf16 a[0:15], v[240:243], v[240:243], 0
    v_mfma_f32_32x32x16_bf16 a[16:31], v[240:243], v[240:243], 0
    v_mfma_f32_32x32x16_bf16 a[32:47], v[240:243], v[240:243], 0
    v_mfma_f32_32x32x16_bf16 a[48:63], v[240:243], v[240:243], 0
    v_mfma_f32_32x32x16_bf16 a[64:79], v[240:243], v[240:243], 0
    v_mfma_f32_32x32x16_bf16 a[80:95], v[240:243], v[240:243], 0
    v_mfma_f32_32x32x16_bf16 a[96:111], v[240:243], v[240:243], 0
    v_mfma_f32_32x32x16_bf16 a[112:127], v[240:243], v[240:243], 0
    s_branch K1_HAVEMAX
K1_D0POLL:
    s_mov_b32 s54, 0
K1_D0LOOP:
    buffer_load_dword v114, v78, s[88:91], 0 offen offset:0 sc1
    s_add_u32 s54, s54, 1
    s_sleep 4
    s_waitcnt vmcnt(0)
    v_cmp_ne_u32 vcc, s62, v114
    s_cmp_gt_u32 s54, 131072
    s_cbranch_scc1 K1_D0OK
    s_cbranch_vccnz K1_D0LOOP
    s_branch K1_D0OK
K1_NPOLL:
    s_mov_b32 s54, 0
K1_NLOOP:
    buffer_load_dword v81, off, s[84:87], 0 sc1
    s_add_u32 s54, s54, 1
    s_sleep 4
    s_waitcnt vmcnt(0)
    v_cmp_eq_u32 vcc, 0, v81
    s_cmp_gt_u32 s54, 131072
    s_cbranch_scc1 K1_NOK
    s_cbranch_vccnz K1_NLOOP
    s_branch K1_NOK
K1_LAST:
    v_mfma_f32_16x16x32_bf16 v[192:195], v[132:135], v[20:23], v[192:195]
    v_exp_f32 v205, v205
    v_mfma_f32_16x16x32_bf16 v[192:195], v[136:139], v[24:27], v[192:195]
    v_cvt_pk_bf16_f32 v214, v204, v205
    v_mfma_f32_16x16x32_bf16 v[192:195], v[140:143], v[28:31], v[192:195]
    v_exp_f32 v206, v206
    v_mfma_f32_16x16x32_bf16 v[196:199], v[144:147], v[28:31], v[228:231]
    s_waitcnt vmcnt(16) lgkmcnt(0)
    s_barrier
    v_mfma_f32_16x16x32_bf16 v[196:199], v[148:151], v[24:27], v[196:199]
    v_exp_f32 v207, v207
    v_mfma_f32_16x16x32_bf16 v[196:199], v[152:155], v[20:23], v[196:199]
    s_add_u32 m0, s52, 49152
    v_cvt_pk_bf16_f32 v215, v206, v207
    v_mfma_f32_16x16x32_bf16 v[196:199], v[156:159], v[16:19], v[196:199]
    buffer_load_dwordx4 v120, s[8:11], s48 offen offset:0 sc1 lds
    v_mfma_f32_16x16x32_bf16 v[200:203], v[160:163], v[16:19], v[228:231]
    v_exp_f32 v192, v192
    v_mfma_f32_16x16x32_bf16 v[200:203], v[164:167], v[20:23], v[200:203]
    buffer_load_dwordx4 v121, s[8:11], s48 offen offset:1024 sc1 lds
    v_mfma_f32_16x16x32_bf16 v[200:203], v[168:171], v[24:27], v[200:203]
    v_exp_f32 v193, v193
    v_mfma_f32_16x16x32_bf16 v[200:203], v[172:175], v[28:31], v[200:203]
    s_lshl_b32 s56, s4, 14
    v_cvt_pk_bf16_f32 v216, v192, v193
    v_mfma_f32_16x16x32_bf16 v[204:207], v[176:179], v[28:31], v[228:231]
    v_exp_f32 v194, v194
    v_mfma_f32_16x16x32_bf16 v[204:207], v[180:183], v[24:27], v[204:207]
    buffer_load_dwordx4 v122, s[8:11], s48 offen offset:2048 sc1 lds
    v_mfma_f32_16x16x32_bf16 v[204:207], v[184:187], v[20:23], v[204:207]
    v_exp_f32 v195, v195
    v_mfma_f32_16x16x32_bf16 v[204:207], v[188:191], v[16:19], v[204:207]
    v_cvt_pk_bf16_f32 v217, v194, v195
    v_mfma_f32_16x16x32_bf16 a[0:3], a[192:195], v[208:211], a[0:3]
    v_exp_f32 v196, v196
    v_mfma_f32_16x16x32_bf16 a[0:3], a[196:199], v[212:215], a[0:3]
    buffer_load_dwordx4 v123, s[8:11], s48 offen offset:3072 sc1 lds
    v_mfma_f32_16x16x32_bf16 a[16:19], a[200:203], v[208:211], a[16:19]
    v_exp_f32 v197, v197
    v_mfma_f32_16x16x32_bf16 a[16:19], a[204:207], v[212:215], a[16:19]
    s_add_u32 m0, s52, 114688
    v_cvt_pk_bf16_f32 v218, v196, v197
    v_mfma_f32_16x16x32_bf16 a[32:35], a[208:211], v[208:211], a[32:35]
    v_exp_f32 v198, v198
    v_mfma_f32_16x16x32_bf16 a[32:35], a[212:215], v[212:215], a[32:35]
    buffer_load_dwordx4 v124, s[12:15], s43 offen offset:0 sc1 lds
    v_mfma_f32_16x16x32_bf16 a[48:51], a[216:219], v[208:211], a[48:51]
    v_exp_f32 v199, v199
    v_mfma_f32_16x16x32_bf16 a[48:51], a[220:223], v[212:215], a[48:51]
    v_cvt_pk_bf16_f32 v219, v198, v199
    v_mfma_f32_16x16x32_bf16 a[64:67], a[224:227], v[208:211], a[64:67]
    v_exp_f32 v200, v200
    v_mfma_f32_16x16x32_bf16 a[64:67], a[228:231], v[212:215], a[64:67]
    buffer_load_dwordx4 v125, s[12:15], s43 offen offset:1024 sc1 lds
    v_mfma_f32_16x16x32_bf16 a[80:83], a[232:235], v[208:211], a[80:83]
    v_exp_f32 v201, v201
    v_mfma_f32_16x16x32_bf16 a[80:83], a[236:239], v[212:215], a[80:83]
    v_cvt_pk_bf16_f32 v220, v200, v201
    v_mfma_f32_16x16x32_bf16 a[96:99], a[240:243], v[208:211], a[96:99]
    v_exp_f32 v202, v202
    v_mfma_f32_16x16x32_bf16 a[96:99], a[244:247], v[212:215], a[96:99]
    buffer_load_dwordx4 v124, s[12:15], s43 offen offset:2048 sc1 lds
    v_mfma_f32_16x16x32_bf16 a[112:115], a[248:251], v[208:211], a[112:115]
    v_exp_f32 v203, v203
    v_mfma_f32_16x16x32_bf16 a[112:115], a[252:255], v[212:215], a[112:115]
    buffer_load_dwordx4 v125, s[12:15], s43 offen offset:3072 sc1 lds
    v_cvt_pk_bf16_f32 v221, v202, v203
    v_smfmac_f32_16x16x64_bf16 v[240:243], v[96:99], v[208:215], v119
    v_exp_f32 v204, v204
    s_add_u32 s48, s48, s77
    s_add_u32 s43, s43, s58
    s_cmp_ge_u32 s3, 2
    s_cselect_b32 s6, 0x3000, s52
    s_cselect_b32 s46, 0x40000000, s48
    s_cselect_b32 s47, 0x40000000, s43
    s_add_u32 m0, s6, 131072
    v_mfma_f32_16x16x32_bf16 v[192:195], v[128:131], v[32:35], v[232:235]
    buffer_load_dwordx4 v120, s[8:11], s46 offen offset:0 lds
    v_accvgpr_read_b32 v88, a0
    v_accvgpr_read_b32 v89, a1
    v_mfma_f32_16x16x32_bf16 v[192:195], v[132:135], v[36:39], v[192:195]
    buffer_load_dwordx4 v121, s[8:11], s46 offen offset:1024 lds
    v_exp_f32 v205, v205
    v_mfma_f32_16x16x32_bf16 v[192:195], v[136:139], v[40:43], v[192:195]
    buffer_load_dwordx4 v122, s[8:11], s46 offen offset:2048 lds
    v_cvt_pk_bf16_f32 v222, v204, v205
    v_accvgpr_read_b32 v90, a2
    v_mfma_f32_16x16x32_bf16 v[192:195], v[140:143], v[44:47], v[192:195]
    buffer_load_dwordx4 v123, s[8:11], s46 offen offset:3072 lds
    v_exp_f32 v206, v206
    v_mfma_f32_16x16x32_bf16 v[196:199], v[144:147], v[44:47], v[232:235]
    s_add_u32 m0, s52, 147456
    v_accvgpr_read_b32 v91, a3
    v_accvgpr_read_b32 v92, a16
    v_accvgpr_read_b32 v93, a17
    v_mfma_f32_16x16x32_bf16 v[196:199], v[148:151], v[40:43], v[196:199]
    buffer_load_dwordx4 v118, s[12:15], s47 offen offset:0 sc1 lds
    v_exp_f32 v207, v207
    v_mfma_f32_16x16x32_bf16 v[196:199], v[152:155], v[36:39], v[196:199]
    buffer_load_dwordx4 v118, s[12:15], s47 offen offset:1024 sc1 lds
    v_cvt_pk_bf16_f32 v223, v206, v207
    v_accvgpr_read_b32 v94, a18
    v_mfma_f32_16x16x32_bf16 v[196:199], v[156:159], v[32:35], v[196:199]
    buffer_load_dwordx4 v118, s[12:15], s47 offen offset:2048 sc1 lds
    v_accvgpr_read_b32 v95, a19
    v_add_f32 v240, v240, v241
    v_mfma_f32_16x16x32_bf16 v[200:203], v[160:163], v[32:35], v[232:235]
    buffer_load_dwordx4 v118, s[12:15], s47 offen offset:3072 sc1 lds
    v_exp_f32 v192, v192
    v_mfma_f32_16x16x32_bf16 v[200:203], v[164:167], v[36:39], v[200:203]
    ds_read_b64_tr_b16 a[128:129], v76 offset:0
    v_rcp_f32 v242, v240
    s_add_u32 s57, s56, 0
    v_mfma_f32_16x16x32_bf16 v[200:203], v[168:171], v[40:43], v[200:203]
    v_exp_f32 v193, v193
    v_pk_mul_f32 v[88:89], v[88:89], v[242:243] op_sel_hi:[1,0]
    v_pk_mul_f32 v[90:91], v[90:91], v[242:243] op_sel_hi:[1,0]
    v_mfma_f32_16x16x32_bf16 v[200:203], v[172:175], v[44:47], v[200:203]
    ds_read_b64_tr_b16 a[130:131], v76 offset:2048
    v_cvt_pk_bf16_f32 v208, v192, v193
    v_pk_mul_f32 v[92:93], v[92:93], v[242:243] op_sel_hi:[1,0]
    v_pk_mul_f32 v[94:95], v[94:95], v[242:243] op_sel_hi:[1,0]
    v_mfma_f32_16x16x32_bf16 v[204:207], v[176:179], v[44:47], v[232:235]
    v_exp_f32 v194, v194
    v_cvt_pk_bf16_f32 v100, v88, v89
    v_cvt_pk_bf16_f32 v101, v90, v91
    v_mfma_f32_16x16x32_bf16 v[204:207], v[180:183], v[40:43], v[204:207]
    ds_read_b128 a[144:147], v68 offset:0
    v_cvt_pk_bf16_f32 v102, v92, v93
    v_cvt_pk_bf16_f32 v103, v94, v95
    v_mfma_f32_16x16x32_bf16 v[204:207], v[184:187], v[36:39], v[204:207]
    buffer_store_dwordx4 v[100:103], v118, s[28:31], s57 offen offset:0 sc1
    v_exp_f32 v195, v195
    v_mfma_f32_16x16x32_bf16 v[204:207], v[188:191], v[32:35], v[204:207]
    ds_read_b64_tr_b16 a[132:133], v77 offset:0
    v_cvt_pk_bf16_f32 v209, v194, v195
    v_accvgpr_read_b32 v88, a32
    v_accvgpr_read_b32 v89, a33
    v_mfma_f32_16x16x32_bf16 a[4:7], a[192:195], v[216:219], a[4:7]
    v_exp_f32 v196, v196
    v_accvgpr_read_b32 v90, a34
    v_accvgpr_read_b32 v91, a35
    v_mfma_f32_16x16x32_bf16 a[4:7], a[196:199], v[220:223], a[4:7]
    ds_read_b64_tr_b16 a[134:135], v77 offset:2048
    v_accvgpr_read_b32 v92, a48
    v_accvgpr_read_b32 v93, a49
    v_accvgpr_read_b32 v94, a50
    v_mfma_f32_16x16x32_bf16 a[20:23], a[200:203], v[216:219], a[20:23]
    v_exp_f32 v197, v197
    v_accvgpr_read_b32 v95, a51
    s_add_u32 s57, s56, 4096
    v_mfma_f32_16x16x32_bf16 a[20:23], a[204:207], v[220:223], a[20:23]
    ds_read_b128 a[148:151], v69 offset:0
    v_cvt_pk_bf16_f32 v210, v196, v197
    v_pk_mul_f32 v[88:89], v[88:89], v[242:243] op_sel_hi:[1,0]
    v_pk_mul_f32 v[90:91], v[90:91], v[242:243] op_sel_hi:[1,0]
    v_mfma_f32_16x16x32_bf16 a[36:39], a[208:211], v[216:219], a[36:39]
    v_exp_f32 v198, v198
    v_pk_mul_f32 v[92:93], v[92:93], v[242:243] op_sel_hi:[1,0]
    v_pk_mul_f32 v[94:95], v[94:95], v[242:243] op_sel_hi:[1,0]
    v_mfma_f32_16x16x32_bf16 a[36:39], a[212:215], v[220:223], a[36:39]
    ds_read_b64_tr_b16 a[136:137], v78 offset:0
    v_cvt_pk_bf16_f32 v104, v88, v89
    v_cvt_pk_bf16_f32 v105, v90, v91
    v_cvt_pk_bf16_f32 v106, v92, v93
    v_mfma_f32_16x16x32_bf16 a[52:55], a[216:219], v[216:219], a[52:55]
    v_exp_f32 v199, v199
    v_cvt_pk_bf16_f32 v107, v94, v95
    v_mfma_f32_16x16x32_bf16 a[52:55], a[220:223], v[220:223], a[52:55]
    buffer_store_dwordx4 v[104:107], v118, s[28:31], s57 offen offset:0 sc1
    ds_read_b64_tr_b16 a[138:139], v78 offset:2048
    v_cvt_pk_bf16_f32 v211, v198, v199
    v_mfma_f32_16x16x32_bf16 a[68:71], a[224:227], v[216:219], a[68:71]
    v_exp_f32 v200, v200
    v_accvgpr_read_b32 v88, a64
    v_accvgpr_read_b32 v89, a65
    v_mfma_f32_16x16x32_bf16 a[68:71], a[228:231], v[220:223], a[68:71]
    ds_read_b128 a[152:155], v70 offset:0
    v_accvgpr_read_b32 v90, a66
    v_accvgpr_read_b32 v91, a67
    v_accvgpr_read_b32 v92, a80
    v_mfma_f32_16x16x32_bf16 a[84:87], a[232:235], v[216:219], a[84:87]
    v_exp_f32 v201, v201
    v_accvgpr_read_b32 v93, a81
    v_accvgpr_read_b32 v94, a82
    v_mfma_f32_16x16x32_bf16 a[84:87], a[236:239], v[220:223], a[84:87]
    ds_read_b64_tr_b16 a[140:141], v79 offset:0
    v_cvt_pk_bf16_f32 v212, v200, v201
    v_accvgpr_read_b32 v95, a83
    s_add_u32 s57, s56, 8192
    v_mfma_f32_16x16x32_bf16 a[100:103], a[240:243], v[216:219], a[100:103]
    v_exp_f32 v202, v202
    v_pk_mul_f32 v[88:89], v[88:89], v[242:243] op_sel_hi:[1,0]
    v_pk_mul_f32 v[90:91], v[90:91], v[242:243] op_sel_hi:[1,0]
    v_mfma_f32_16x16x32_bf16 a[100:103], a[244:247], v[220:223], a[100:103]
    ds_read_b64_tr_b16 a[142:143], v79 offset:2048
    v_pk_mul_f32 v[92:93], v[92:93], v[242:243] op_sel_hi:[1,0]
    v_pk_mul_f32 v[94:95], v[94:95], v[242:243] op_sel_hi:[1,0]
    v_cvt_pk_bf16_f32 v108, v88, v89
    v_mfma_f32_16x16x32_bf16 a[116:119], a[248:251], v[216:219], a[116:119]
    v_exp_f32 v203, v203
    v_cvt_pk_bf16_f32 v109, v90, v91
    v_cvt_pk_bf16_f32 v110, v92, v93
    v_mfma_f32_16x16x32_bf16 a[116:119], a[252:255], v[220:223], a[116:119]
    ds_read_b128 a[156:159], v71 offset:0
    v_cvt_pk_bf16_f32 v213, v202, v203
    v_cvt_pk_bf16_f32 v111, v94, v95
    v_smfmac_f32_16x16x64_bf16 v[244:247], v[96:99], v[216:223], v119
    buffer_store_dwordx4 v[108:111], v118, s[28:31], s57 offen offset:0 sc1
    v_exp_f32 v204, v204
    v_accvgpr_read_b32 v88, a96
    v_accvgpr_read_b32 v89, a97
    v_accvgpr_read_b32 v90, a98
    v_accvgpr_read_b32 v91, a99
    v_accvgpr_read_b32 v92, a112
    v_accvgpr_read_b32 v93, a113
    v_accvgpr_read_b32 v94, a114
    v_accvgpr_read_b32 v95, a115
    s_add_u32 s57, s56, 12288
    v_pk_mul_f32 v[88:89], v[88:89], v[242:243] op_sel_hi:[1,0]
    v_pk_mul_f32 v[90:91], v[90:91], v[242:243] op_sel_hi:[1,0]
    v_pk_mul_f32 v[92:93], v[92:93], v[242:243] op_sel_hi:[1,0]
    v_pk_mul_f32 v[94:95], v[94:95], v[242:243] op_sel_hi:[1,0]
    v_cvt_pk_bf16_f32 v100, v88, v89
    v_cvt_pk_bf16_f32 v101, v90, v91
    v_cvt_pk_bf16_f32 v102, v92, v93
    v_cvt_pk_bf16_f32 v103, v94, v95
    buffer_store_dwordx4 v[100:103], v118, s[28:31], s57 offen offset:0 sc1
    v_mfma_f32_16x16x32_bf16 v[192:195], v[128:131], v[48:51], v[236:239]
    v_accvgpr_read_b32 v88, a4
    v_accvgpr_read_b32 v89, a5
    v_accvgpr_read_b32 v90, a6
    v_accvgpr_read_b32 v91, a7
    v_mfma_f32_16x16x32_bf16 v[192:195], v[132:135], v[52:55], v[192:195]
    ds_read_b64_tr_b16 a[160:161], v76 offset:8192
    v_exp_f32 v205, v205
    v_accvgpr_read_b32 v92, a20
    v_mfma_f32_16x16x32_bf16 v[192:195], v[136:139], v[56:59], v[192:195]
    v_cvt_pk_bf16_f32 v214, v204, v205
    v_accvgpr_read_b32 v93, a21
    v_accvgpr_read_b32 v94, a22
    v_accvgpr_read_b32 v95, a23
    v_mfma_f32_16x16x32_bf16 v[192:195], v[140:143], v[60:63], v[192:195]
    ds_read_b64_tr_b16 a[162:163], v76 offset:10240
    v_exp_f32 v206, v206
    v_add_f32 v244, v244, v245
    v_mfma_f32_16x16x32_bf16 v[196:199], v[144:147], v[60:63], v[236:239]
    v_rcp_f32 v246, v244
    s_add_u32 s57, s56, 0
    v_pk_mul_f32 v[88:89], v[88:89], v[246:247] op_sel_hi:[1,0]
    v_mfma_f32_16x16x32_bf16 v[196:199], v[148:151], v[56:59], v[196:199]
    ds_read_b128 a[176:179], v68 offset:8192
    v_exp_f32 v207, v207
    v_pk_mul_f32 v[90:91], v[90:91], v[246:247] op_sel_hi:[1,0]
    v_mfma_f32_16x16x32_bf16 v[196:199], v[152:155], v[52:55], v[196:199]
    v_cvt_pk_bf16_f32 v215, v206, v207
    v_pk_mul_f32 v[92:93], v[92:93], v[246:247] op_sel_hi:[1,0]
    v_pk_mul_f32 v[94:95], v[94:95], v[246:247] op_sel_hi:[1,0]
    v_cvt_pk_bf16_f32 v104, v88, v89
    v_mfma_f32_16x16x32_bf16 v[196:199], v[156:159], v[48:51], v[196:199]
    ds_read_b64_tr_b16 a[164:165], v77 offset:8192
    v_cvt_pk_bf16_f32 v105, v90, v91
    v_cvt_pk_bf16_f32 v106, v92, v93
    v_cvt_pk_bf16_f32 v107, v94, v95
    v_mfma_f32_16x16x32_bf16 v[200:203], v[160:163], v[48:51], v[236:239]
    buffer_store_dwordx4 v[104:107], v118, s[28:31], s57 offen offset:1024 sc1
    v_exp_f32 v192, v192
    v_mfma_f32_16x16x32_bf16 v[200:203], v[164:167], v[52:55], v[200:203]
    ds_read_b64_tr_b16 a[166:167], v77 offset:10240
    v_accvgpr_read_b32 v88, a36
    v_accvgpr_read_b32 v89, a37
    v_accvgpr_read_b32 v90, a38
    v_mfma_f32_16x16x32_bf16 v[200:203], v[168:171], v[56:59], v[200:203]
    v_exp_f32 v193, v193
    v_accvgpr_read_b32 v91, a39
    v_accvgpr_read_b32 v92, a52
    v_mfma_f32_16x16x32_bf16 v[200:203], v[172:175], v[60:63], v[200:203]
    ds_read_b128 a[180:183], v69 offset:8192
    v_cvt_pk_bf16_f32 v216, v192, v193
    v_accvgpr_read_b32 v93, a53
    v_accvgpr_read_b32 v94, a54
    v_mfma_f32_16x16x32_bf16 v[204:207], v[176:179], v[60:63], v[236:239]
    v_exp_f32 v194, v194
    v_accvgpr_read_b32 v95, a55
    s_add_u32 s57, s56, 4096
    v_mfma_f32_16x16x32_bf16 v[204:207], v[180:183], v[56:59], v[204:207]
    ds_read_b64_tr_b16 a[168:169], v78 offset:8192
    v_pk_mul_f32 v[88:89], v[88:89], v[246:247] op_sel_hi:[1,0]
    v_pk_mul_f32 v[90:91], v[90:91], v[246:247] op_sel_hi:[1,0]
    v_pk_mul_f32 v[92:93], v[92:93], v[246:247] op_sel_hi:[1,0]
    v_mfma_f32_16x16x32_bf16 v[204:207], v[184:187], v[52:55], v[204:207]
    v_exp_f32 v195, v195
    v_pk_mul_f32 v[94:95], v[94:95], v[246:247] op_sel_hi:[1,0]
    v_cvt_pk_bf16_f32 v108, v88, v89
    v_mfma_f32_16x16x32_bf16 v[204:207], v[188:191], v[48:51], v[204:207]
    ds_read_b64_tr_b16 a[170:171], v78 offset:10240
    v_cvt_pk_bf16_f32 v217, v194, v195
    v_cvt_pk_bf16_f32 v109, v90, v91
    v_cvt_pk_bf16_f32 v110, v92, v93
    v_mfma_f32_16x16x32_bf16 a[8:11], a[192:195], v[208:211], a[8:11]
    v_exp_f32 v196, v196
    v_cvt_pk_bf16_f32 v111, v94, v95
    v_mfma_f32_16x16x32_bf16 a[8:11], a[196:199], v[212:215], a[8:11]
    buffer_store_dwordx4 v[108:111], v118, s[28:31], s57 offen offset:1024 sc1
    ds_read_b128 a[184:187], v70 offset:8192
    v_accvgpr_read_b32 v88, a68
    v_mfma_f32_16x16x32_bf16 a[24:27], a[200:203], v[208:211], a[24:27]
    v_exp_f32 v197, v197
    v_accvgpr_read_b32 v89, a69
    v_accvgpr_read_b32 v90, a70
    v_mfma_f32_16x16x32_bf16 a[24:27], a[204:207], v[212:215], a[24:27]
    ds_read_b64_tr_b16 a[172:173], v79 offset:8192
    v_cvt_pk_bf16_f32 v218, v196, v197
    v_accvgpr_read_b32 v91, a71
    v_accvgpr_read_b32 v92, a84
    v_mfma_f32_16x16x32_bf16 a[40:43], a[208:211], v[208:211], a[40:43]
    v_exp_f32 v198, v198
    v_accvgpr_read_b32 v93, a85
    v_accvgpr_read_b32 v94, a86
    v_mfma_f32_16x16x32_bf16 a[40:43], a[212:215], v[212:215], a[40:43]
    ds_read_b64_tr_b16 a[174:175], v79 offset:10240
    v_accvgpr_read_b32 v95, a87
    s_add_u32 s57, s56, 8192
    v_pk_mul_f32 v[88:89], v[88:89], v[246:247] op_sel_hi:[1,0]
    v_mfma_f32_16x16x32_bf16 a[56:59], a[216:219], v[208:211], a[56:59]
    v_exp_f32 v199, v199
    v_pk_mul_f32 v[90:91], v[90:91], v[246:247] op_sel_hi:[1,0]
    v_pk_mul_f32 v[92:93], v[92:93], v[246:247] op_sel_hi:[1,0]
    v_mfma_f32_16x16x32_bf16 a[56:59], a[220:223], v[212:215], a[56:59]
    ds_read_b128 a[188:191], v71 offset:8192
    v_cvt_pk_bf16_f32 v219, v198, v199
    v_pk_mul_f32 v[94:95], v[94:95], v[246:247] op_sel_hi:[1,0]
    v_cvt_pk_bf16_f32 v100, v88, v89
    v_mfma_f32_16x16x32_bf16 a[72:75], a[224:227], v[208:211], a[72:75]
    v_exp_f32 v200, v200
    v_cvt_pk_bf16_f32 v101, v90, v91
    v_cvt_pk_bf16_f32 v102, v92, v93
    v_mfma_f32_16x16x32_bf16 a[72:75], a[228:231], v[212:215], a[72:75]
    v_cvt_pk_bf16_f32 v103, v94, v95
    v_mfma_f32_16x16x32_bf16 a[88:91], a[232:235], v[208:211], a[88:91]
    buffer_store_dwordx4 v[100:103], v118, s[28:31], s57 offen offset:1024 sc1
    v_exp_f32 v201, v201
    v_mfma_f32_16x16x32_bf16 a[88:91], a[236:239], v[212:215], a[88:91]
    v_cvt_pk_bf16_f32 v220, v200, v201
    v_accvgpr_read_b32 v88, a100
    v_accvgpr_read_b32 v89, a101
    v_accvgpr_read_b32 v90, a102
    v_mfma_f32_16x16x32_bf16 a[104:107], a[240:243], v[208:211], a[104:107]
    v_exp_f32 v202, v202
    v_accvgpr_read_b32 v91, a103
    v_accvgpr_read_b32 v92, a116
    v_mfma_f32_16x16x32_bf16 a[104:107], a[244:247], v[212:215], a[104:107]
    v_accvgpr_read_b32 v93, a117
    v_accvgpr_read_b32 v94, a118
    v_accvgpr_read_b32 v95, a119
    s_add_u32 s57, s56, 12288
    v_mfma_f32_16x16x32_bf16 a[120:123], a[248:251], v[208:211], a[120:123]
    v_exp_f32 v203, v203
    v_pk_mul_f32 v[88:89], v[88:89], v[246:247] op_sel_hi:[1,0]
    v_pk_mul_f32 v[90:91], v[90:91], v[246:247] op_sel_hi:[1,0]
    v_mfma_f32_16x16x32_bf16 a[120:123], a[252:255], v[212:215], a[120:123]
    v_cvt_pk_bf16_f32 v221, v202, v203
    v_pk_mul_f32 v[92:93], v[92:93], v[246:247] op_sel_hi:[1,0]
    v_pk_mul_f32 v[94:95], v[94:95], v[246:247] op_sel_hi:[1,0]
    v_cvt_pk_bf16_f32 v104, v88, v89
    v_smfmac_f32_16x16x64_bf16 v[248:251], v[96:99], v[208:215], v119
    v_exp_f32 v204, v204
    v_cvt_pk_bf16_f32 v105, v90, v91
    v_cvt_pk_bf16_f32 v106, v92, v93
    v_cvt_pk_bf16_f32 v107, v94, v95
    buffer_store_dwordx4 v[104:107], v118, s[28:31], s57 offen offset:1024 sc1
    v_exp_f32 v205, v205
    v_exp_f32 v206, v206
    v_exp_f32 v207, v207
    v_cvt_pk_bf16_f32 v222, v204, v205
    v_cvt_pk_bf16_f32 v223, v206, v207
    v_accvgpr_read_b32 v88, a8
    v_accvgpr_read_b32 v89, a9
    v_mfma_f32_16x16x32_bf16 a[12:15], a[192:195], v[216:219], a[12:15]
    v_accvgpr_read_b32 v90, a10
    v_accvgpr_read_b32 v91, a11
    v_accvgpr_read_b32 v92, a24
    v_accvgpr_read_b32 v93, a25
    v_mfma_f32_16x16x32_bf16 a[12:15], a[196:199], v[220:223], a[12:15]
    v_accvgpr_read_b32 v94, a26
    v_accvgpr_read_b32 v95, a27
    v_add_f32 v248, v248, v249
    v_mfma_f32_16x16x32_bf16 a[28:31], a[200:203], v[216:219], a[28:31]
    v_rcp_f32 v250, v248
    s_add_u32 s57, s56, 0
    v_pk_mul_f32 v[88:89], v[88:89], v[250:251] op_sel_hi:[1,0]
    v_mfma_f32_16x16x32_bf16 a[28:31], a[204:207], v[220:223], a[28:31]
    v_pk_mul_f32 v[90:91], v[90:91], v[250:251] op_sel_hi:[1,0]
    v_pk_mul_f32 v[92:93], v[92:93], v[250:251] op_sel_hi:[1,0]
    v_pk_mul_f32 v[94:95], v[94:95], v[250:251] op_sel_hi:[1,0]
    v_cvt_pk_bf16_f32 v108, v88, v89
    v_mfma_f32_16x16x32_bf16 a[44:47], a[208:211], v[216:219], a[44:47]
    v_cvt_pk_bf16_f32 v109, v90, v91
    v_cvt_pk_bf16_f32 v110, v92, v93
    v_cvt_pk_bf16_f32 v111, v94, v95
    v_mfma_f32_16x16x32_bf16 a[44:47], a[212:215], v[220:223], a[44:47]
    buffer_store_dwordx4 v[108:111], v118, s[28:31], s57 offen offset:2048 sc1
    v_accvgpr_read_b32 v88, a40
    v_accvgpr_read_b32 v89, a41
    v_mfma_f32_16x16x32_bf16 a[60:63], a[216:219], v[216:219], a[60:63]
    v_accvgpr_read_b32 v90, a42
    v_accvgpr_read_b32 v91, a43
    v_accvgpr_read_b32 v92, a56
    v_accvgpr_read_b32 v93, a57
    v_mfma_f32_16x16x32_bf16 a[60:63], a[220:223], v[220:223], a[60:63]
    v_accvgpr_read_b32 v94, a58
    v_accvgpr_read_b32 v95, a59
    s_add_u32 s57, s56, 4096
    v_pk_mul_f32 v[88:89], v[88:89], v[250:251] op_sel_hi:[1,0]
    v_mfma_f32_16x16x32_bf16 a[76:79], a[224:227], v[216:219], a[76:79]
    v_pk_mul_f32 v[90:91], v[90:91], v[250:251] op_sel_hi:[1,0]
    v_pk_mul_f32 v[92:93], v[92:93], v[250:251] op_sel_hi:[1,0]
    v_pk_mul_f32 v[94:95], v[94:95], v[250:251] op_sel_hi:[1,0]
    v_cvt_pk_bf16_f32 v100, v88, v89
    v_mfma_f32_16x16x32_bf16 a[76:79], a[228:231], v[220:223], a[76:79]
    v_cvt_pk_bf16_f32 v101, v90, v91
    v_cvt_pk_bf16_f32 v102, v92, v93
    v_cvt_pk_bf16_f32 v103, v94, v95
    v_mfma_f32_16x16x32_bf16 a[92:95], a[232:235], v[216:219], a[92:95]
    buffer_store_dwordx4 v[100:103], v118, s[28:31], s57 offen offset:2048 sc1
    v_accvgpr_read_b32 v88, a72
    v_accvgpr_read_b32 v89, a73
    v_mfma_f32_16x16x32_bf16 a[92:95], a[236:239], v[220:223], a[92:95]
    v_accvgpr_read_b32 v90, a74
    v_accvgpr_read_b32 v91, a75
    v_accvgpr_read_b32 v92, a88
    v_accvgpr_read_b32 v93, a89
    v_mfma_f32_16x16x32_bf16 a[108:111], a[240:243], v[216:219], a[108:111]
    v_accvgpr_read_b32 v94, a90
    v_accvgpr_read_b32 v95, a91
    s_add_u32 s57, s56, 8192
    v_pk_mul_f32 v[88:89], v[88:89], v[250:251] op_sel_hi:[1,0]
    v_mfma_f32_16x16x32_bf16 a[108:111], a[244:247], v[220:223], a[108:111]
    v_pk_mul_f32 v[90:91], v[90:91], v[250:251] op_sel_hi:[1,0]
    v_pk_mul_f32 v[92:93], v[92:93], v[250:251] op_sel_hi:[1,0]
    v_pk_mul_f32 v[94:95], v[94:95], v[250:251] op_sel_hi:[1,0]
    v_cvt_pk_bf16_f32 v104, v88, v89
    v_mfma_f32_16x16x32_bf16 a[124:127], a[248:251], v[216:219], a[124:127]
    v_cvt_pk_bf16_f32 v105, v90, v91
    v_cvt_pk_bf16_f32 v106, v92, v93
    v_cvt_pk_bf16_f32 v107, v94, v95
    v_mfma_f32_16x16x32_bf16 a[124:127], a[252:255], v[220:223], a[124:127]
    buffer_store_dwordx4 v[104:107], v118, s[28:31], s57 offen offset:2048 sc1
    v_accvgpr_read_b32 v88, a104
    v_accvgpr_read_b32 v89, a105
    v_smfmac_f32_16x16x64_bf16 v[252:255], v[96:99], v[216:223], v119
    v_accvgpr_read_b32 v90, a106
    v_accvgpr_read_b32 v91, a107
    v_accvgpr_read_b32 v92, a120
    v_accvgpr_read_b32 v93, a121
    v_accvgpr_read_b32 v94, a122
    v_accvgpr_read_b32 v95, a123
    s_add_u32 s57, s56, 12288
    v_pk_mul_f32 v[88:89], v[88:89], v[250:251] op_sel_hi:[1,0]
    v_pk_mul_f32 v[90:91], v[90:91], v[250:251] op_sel_hi:[1,0]
    v_pk_mul_f32 v[92:93], v[92:93], v[250:251] op_sel_hi:[1,0]
    v_pk_mul_f32 v[94:95], v[94:95], v[250:251] op_sel_hi:[1,0]
    v_cvt_pk_bf16_f32 v108, v88, v89
    v_cvt_pk_bf16_f32 v109, v90, v91
    v_cvt_pk_bf16_f32 v110, v92, v93
    v_cvt_pk_bf16_f32 v111, v94, v95
    buffer_store_dwordx4 v[108:111], v118, s[28:31], s57 offen offset:2048 sc1
    s_nop 11
    v_add_f32 v252, v252, v253
    v_rcp_f32 v254, v252
    v_mov_b32 v88, 0x53800000
    v_cmp_nle_f32 vcc, v240, v88
    v_cmp_nle_f32 s[6:7], v244, v88
    v_cmp_nle_f32 s[44:45], v248, v88
    v_cmp_nle_f32 s[46:47], v252, v88
    s_nop 1
    s_or_b64 s[6:7], s[6:7], vcc
    s_or_b64 s[44:45], s[44:45], s[46:47]
    s_or_b64 s[6:7], s[6:7], s[44:45]
    s_cselect_b32 s6, 1, 0
    v_mov_b32 v88, s6
    s_lshl_b32 s7, s3, 2
    s_add_u32 s7, s7, 139264
    v_mov_b32 v89, s7
    v_mov_b32 v90, 139264
    ds_write_b32 v89, v88
    s_waitcnt vmcnt(12) lgkmcnt(0)
    s_barrier
    ds_read_b128 v[92:95], v90
    s_waitcnt lgkmcnt(0)
    v_or_b32 v92, v92, v93
    v_or3_b32 v92, v92, v94, v95
    s_nop 0
    v_readfirstlane_b32 s6, v92
    s_nop 1
    s_cmp_gt_u32 s6, s59
    s_cbranch_scc1 K1_SLOW
    s_add_u32 s44, s43, 4096
    s_add_u32 s45, s48, 32768
    v_mfma_f32_16x16x32_bf16 v[132:135], a[128:131], a[148:151], 0
    ds_read_b64_tr_b16 a[192:193], v76 offset:16384
    ds_read_b64_tr_b16 a[194:195], v76 offset:18432
    v_accvgpr_read_b32 v88, a12
    v_accvgpr_read_b32 v89, a13
    v_accvgpr_read_b32 v90, a14
    v_accvgpr_read_b32 v91, a15
    v_accvgpr_read_b32 v92, a28
    v_accvgpr_read_b32 v93, a29
    v_accvgpr_read_b32 v94, a30
    v_accvgpr_read_b32 v95, a31
    s_add_u32 s57, s56, 0
    v_pk_mul_f32 v[88:89], v[88:89], v[254:255] op_sel_hi:[1,0]
    v_pk_mul_f32 v[90:91], v[90:91], v[254:255] op_sel_hi:[1,0]
    v_pk_mul_f32 v[92:93], v[92:93], v[254:255] op_sel_hi:[1,0]
    v_pk_mul_f32 v[94:95], v[94:95], v[254:255] op_sel_hi:[1,0]
    v_cvt_pk_bf16_f32 v100, v88, v89
    v_cvt_pk_bf16_f32 v101, v90, v91
    v_cvt_pk_bf16_f32 v102, v92, v93
    v_cvt_pk_bf16_f32 v103, v94, v95
    v_mfma_f32_16x16x32_bf16 v[132:135], a[160:163], a[180:183], v[132:135]
    buffer_store_dwordx4 v[100:103], v118, s[28:31], s57 offen offset:3072 sc1
    ds_read_b128 a[208:211], v68 offset:16384
    s_add_u32 m0, s52, 0
    v_accvgpr_read_b32 v88, a44
    v_accvgpr_read_b32 v89, a45
    v_accvgpr_read_b32 v90, a46
    v_accvgpr_read_b32 v91, a47
    v_accvgpr_read_b32 v92, a60
    v_accvgpr_read_b32 v93, a61
    v_accvgpr_read_b32 v94, a62
    v_accvgpr_read_b32 v95, a63
    s_add_u32 s57, s56, 4096
    v_pk_mul_f32 v[88:89], v[88:89], v[254:255] op_sel_hi:[1,0]
    v_pk_mul_f32 v[90:91], v[90:91], v[254:255] op_sel_hi:[1,0]
    v_pk_mul_f32 v[92:93], v[92:93], v[254:255] op_sel_hi:[1,0]
    v_pk_mul_f32 v[94:95], v[94:95], v[254:255] op_sel_hi:[1,0]
    v_cvt_pk_bf16_f32 v104, v88, v89
    v_cvt_pk_bf16_f32 v105, v90, v91
    v_cvt_pk_bf16_f32 v106, v92, v93
    v_cvt_pk_bf16_f32 v107, v94, v95
    v_mfma_f32_16x16x32_bf16 v[148:151], a[164:167], a[180:183], 0
    buffer_store_dwordx4 v[104:107], v118, s[28:31], s57 offen offset:3072 sc1
    ds_read_b64_tr_b16 a[196:197], v77 offset:16384
    v_accvgpr_read_b32 v88, a76
    v_accvgpr_read_b32 v89, a77
    v_accvgpr_read_b32 v90, a78
    v_accvgpr_read_b32 v91, a79
    v_accvgpr_read_b32 v92, a92
    v_accvgpr_read_b32 v93, a93
    v_accvgpr_read_b32 v94, a94
    v_accvgpr_read_b32 v95, a95
    s_add_u32 s57, s56, 8192
    v_pk_mul_f32 v[88:89], v[88:89], v[254:255] op_sel_hi:[1,0]
    v_pk_mul_f32 v[90:91], v[90:91], v[254:255] op_sel_hi:[1,0]
    v_pk_mul_f32 v[92:93], v[92:93], v[254:255] op_sel_hi:[1,0]
    v_pk_mul_f32 v[94:95], v[94:95], v[254:255] op_sel_hi:[1,0]
    v_cvt_pk_bf16_f32 v108, v88, v89
    v_cvt_pk_bf16_f32 v109, v90, v91
    v_cvt_pk_bf16_f32 v110, v92, v93
    v_cvt_pk_bf16_f32 v111, v94, v95
    v_mfma_f32_16x16x32_bf16 v[148:151], a[132:135], a[148:151], v[148:151]
    buffer_store_dwordx4 v[108:111], v118, s[28:31], s57 offen offset:3072 sc1
    buffer_load_dwordx4 v120, s[36:39], s45 offen offset:0 lds
    v_accvgpr_read_b32 v88, a108
    v_accvgpr_read_b32 v89, a109
    v_accvgpr_read_b32 v90, a110
    v_accvgpr_read_b32 v91, a111
    v_accvgpr_read_b32 v92, a124
    v_accvgpr_read_b32 v93, a125
    v_accvgpr_read_b32 v94, a126
    v_accvgpr_read_b32 v95, a127
    s_add_u32 s57, s56, 12288
    v_pk_mul_f32 v[88:89], v[88:89], v[254:255] op_sel_hi:[1,0]
    v_pk_mul_f32 v[90:91], v[90:91], v[254:255] op_sel_hi:[1,0]
    v_pk_mul_f32 v[92:93], v[92:93], v[254:255] op_sel_hi:[1,0]
    v_pk_mul_f32 v[94:95], v[94:95], v[254:255] op_sel_hi:[1,0]
    v_cvt_pk_bf16_f32 v100, v88, v89
    v_cvt_pk_bf16_f32 v101, v90, v91
    v_cvt_pk_bf16_f32 v102, v92, v93
    v_cvt_pk_bf16_f32 v103, v94, v95
    v_mfma_f32_16x16x32_bf16 v[164:167], a[136:139], a[148:151], 0
    buffer_store_dwordx4 v[100:103], v118, s[28:31], s57 offen offset:3072 sc1
    ds_read_b64_tr_b16 a[198:199], v77 offset:18432
    v_mfma_f32_16x16x32_bf16 v[164:167], a[168:171], a[180:183], v[164:167]
    ds_read_b128 a[212:215], v69 offset:16384
    buffer_load_dwordx4 v121, s[36:39], s45 offen offset:1024 lds
    v_mfma_f32_16x16x32_bf16 v[180:183], a[172:175], a[180:183], 0
    ds_read_b64_tr_b16 a[200:201], v78 offset:16384
    ds_read_b64_tr_b16 a[202:203], v78 offset:18432
    v_mfma_f32_16x16x32_bf16 v[180:183], a[140:143], a[148:151], v[180:183]
    v_mfma_f32_16x16x32_bf16 v[136:139], a[128:131], a[152:155], 0
    ds_read_b128 a[216:219], v70 offset:16384
    v_mfma_f32_16x16x32_bf16 v[136:139], a[160:163], a[184:187], v[136:139]
    ds_read_b64_tr_b16 a[204:205], v79 offset:16384
    buffer_load_dwordx4 v122, s[36:39], s45 offen offset:2048 lds
    v_mfma_f32_16x16x32_bf16 v[152:155], a[164:167], a[184:187], 0
    ds_read_b64_tr_b16 a[206:207], v79 offset:18432
    v_mfma_f32_16x16x32_bf16 v[152:155], a[132:135], a[152:155], v[152:155]
    v_mfma_f32_16x16x32_bf16 v[168:171], a[136:139], a[152:155], 0
    ds_read_b128 a[220:223], v71 offset:16384
    v_mfma_f32_16x16x32_bf16 v[168:171], a[168:171], a[184:187], v[168:171]
    ds_read_b64_tr_b16 a[224:225], v76 offset:24576
    ds_read_b64_tr_b16 a[226:227], v76 offset:26624
    buffer_load_dwordx4 v123, s[36:39], s45 offen offset:3072 lds
    v_mfma_f32_16x16x32_bf16 v[184:187], a[172:175], a[184:187], 0
    ds_read_b128 a[240:243], v68 offset:24576
    v_mfma_f32_16x16x32_bf16 v[184:187], a[140:143], a[152:155], v[184:187]
    s_lshl_b32 s45, s53, 3
    s_lshl_b32 s48, s53, 3
    s_add_u32 m0, s52, 65536
    v_mfma_f32_16x16x32_bf16 v[140:143], a[128:131], a[156:159], 0
    ds_read_b64_tr_b16 a[228:229], v77 offset:24576
    v_mfma_f32_16x16x32_bf16 v[140:143], a[160:163], a[188:191], v[140:143]
    ds_read_b64_tr_b16 a[230:231], v77 offset:26624
    buffer_load_dwordx4 v118, s[12:15], s44 offen offset:0 sc1 lds
    v_mfma_f32_16x16x32_bf16 v[156:159], a[164:167], a[188:191], 0
    ds_read_b128 a[244:247], v69 offset:24576
    v_mfma_f32_16x16x32_bf16 v[156:159], a[132:135], a[156:159], v[156:159]
    v_mfma_f32_16x16x32_bf16 v[172:175], a[136:139], a[156:159], 0
    ds_read_b64_tr_b16 a[232:233], v78 offset:24576
    ds_read_b64_tr_b16 a[234:235], v78 offset:26624
    v_mfma_f32_16x16x32_bf16 v[172:175], a[168:171], a[188:191], v[172:175]
    ds_read_b128 a[248:251], v70 offset:24576
    buffer_load_dwordx4 v118, s[12:15], s44 offen offset:1024 sc1 lds
    v_mfma_f32_16x16x32_bf16 v[188:191], a[172:175], a[188:191], 0
    ds_read_b64_tr_b16 a[236:237], v79 offset:24576
    v_mfma_f32_16x16x32_bf16 v[188:191], a[140:143], a[156:159], v[188:191]
    v_mfma_f32_16x16x32_bf16 v[128:131], a[128:131], a[144:147], 0
    ds_read_b64_tr_b16 a[238:239], v79 offset:26624
    v_mfma_f32_16x16x32_bf16 v[128:131], a[160:163], a[176:179], v[128:131]
    ds_read_b128 a[252:255], v71 offset:24576
    buffer_load_dwordx4 v118, s[12:15], s44 offen offset:2048 sc1 lds
    v_mfma_f32_16x16x32_bf16 v[144:147], a[164:167], a[176:179], 0
    v_mfma_f32_16x16x32_bf16 v[144:147], a[132:135], a[144:147], v[144:147]
    v_mfma_f32_16x16x32_bf16 v[160:163], a[136:139], a[144:147], 0
    v_mfma_f32_16x16x32_bf16 v[160:163], a[168:171], a[176:179], v[160:163]
    buffer_load_dwordx4 v118, s[12:15], s44 offen offset:3072 sc1 lds
    v_mfma_f32_16x16x32_bf16 v[176:179], a[172:175], a[176:179], 0
    s_mov_b32 s44, s53
    s_lshl_b32 s43, s74, 17
    s_add_u32 s12, s12, s43
    s_addc_u32 s13, s13, 0
    v_mfma_f32_16x16x32_bf16 v[176:179], a[140:143], a[144:147], v[176:179]
    s_waitcnt lgkmcnt(0)
    s_barrier
    v_mfma_f32_16x16x32_bf16 v[132:135], a[192:195], a[212:215], v[132:135]
    ds_read_b64_tr_b16 a[128:129], v76 offset:32768
    ds_read_b64_tr_b16 a[130:131], v76 offset:34816
    v_mfma_f32_16x16x32_bf16 v[132:135], a[224:227], a[244:247], v[132:135]
    ds_read_b128 a[144:147], v68 offset:32768
    s_add_u32 m0, s52, 16384
    v_mfma_f32_16x16x32_bf16 v[148:151], a[228:231], a[244:247], v[148:151]
    ds_read_b64_tr_b16 a[132:133], v77 offset:32768
    v_add_u32 v72, 65536, v68
    v_mfma_f32_16x16x32_bf16 v[148:151], a[196:199], a[212:215], v[148:151]
    buffer_load_dwordx4 v120, s[32:35], s45 offen offset:0 lds
    v_mfma_f32_16x16x32_bf16 v[164:167], a[200:203], a[212:215], v[164:167]
    ds_read_b64_tr_b16 a[134:135], v77 offset:34816
    v_add_u32 v84, 131072, v76
    v_mfma_f32_16x16x32_bf16 v[164:167], a[232:235], a[244:247], v[164:167]
    ds_read_b128 a[148:151], v69 offset:32768
    buffer_load_dwordx4 v121, s[32:35], s45 offen offset:1024 lds
    v_mfma_f32_16x16x32_bf16 v[180:183], a[236:239], a[244:247], v[180:183]
    ds_read_b64_tr_b16 a[136:137], v78 offset:32768
    ds_read_b64_tr_b16 a[138:139], v78 offset:34816
    v_mfma_f32_16x16x32_bf16 v[180:183], a[204:207], a[212:215], v[180:183]
    v_add_u32 v73, 65536, v69
    v_add_u32 v85, 131072, v77
    v_mfma_f32_16x16x32_bf16 v[136:139], a[192:195], a[216:219], v[136:139]
    ds_read_b128 a[152:155], v70 offset:32768
    v_add_u32 v74, 65536, v70
    v_mfma_f32_16x16x32_bf16 v[136:139], a[224:227], a[248:251], v[136:139]
    ds_read_b64_tr_b16 a[140:141], v79 offset:32768
    buffer_load_dwordx4 v122, s[32:35], s45 offen offset:2048 lds
    v_mfma_f32_16x16x32_bf16 v[152:155], a[228:231], a[248:251], v[152:155]
    ds_read_b64_tr_b16 a[142:143], v79 offset:34816
    v_add_u32 v86, 131072, v78
    v_mfma_f32_16x16x32_bf16 v[152:155], a[196:199], a[216:219], v[152:155]
    v_add_u32 v75, 65536, v71
    v_add_u32 v87, 131072, v79
    v_mfma_f32_16x16x32_bf16 v[168:171], a[200:203], a[216:219], v[168:171]
    ds_read_b128 a[156:159], v71 offset:32768
    v_subrev_u32 v64, 65536, v68
    v_mfma_f32_16x16x32_bf16 v[168:171], a[232:235], a[248:251], v[168:171]
    ds_read_b64_tr_b16 a[160:161], v76 offset:40960
    ds_read_b64_tr_b16 a[162:163], v76 offset:43008
    buffer_load_dwordx4 v123, s[32:35], s45 offen offset:3072 lds
    v_mfma_f32_16x16x32_bf16 v[184:187], a[236:239], a[248:251], v[184:187]
    ds_read_b128 a[176:179], v68 offset:40960
    v_add_u32 v80, 65536, v76
    v_mfma_f32_16x16x32_bf16 v[184:187], a[204:207], a[216:219], v[184:187]
    s_xor_b32 s45, s48, 65536
    s_add_u32 m0, s52, 81920
    v_mfma_f32_16x16x32_bf16 v[140:143], a[192:195], a[220:223], v[140:143]
    ds_read_b64_tr_b16 a[164:165], v77 offset:40960
    v_subrev_u32 v65, 65536, v69
    v_mfma_f32_16x16x32_bf16 v[140:143], a[224:227], a[252:255], v[140:143]
    ds_read_b64_tr_b16 a[166:167], v77 offset:43008
    buffer_load_dwordx4 v120, s[32:35], s45 offen offset:0 lds
    v_mfma_f32_16x16x32_bf16 v[156:159], a[228:231], a[252:255], v[156:159]
    ds_read_b128 a[180:183], v69 offset:40960
    v_add_u32 v81, 65536, v77
    v_mfma_f32_16x16x32_bf16 v[156:159], a[196:199], a[220:223], v[156:159]
    v_subrev_u32 v66, 65536, v70
    v_add_u32 v82, 65536, v78
    v_mfma_f32_16x16x32_bf16 v[172:175], a[200:203], a[220:223], v[172:175]
    ds_read_b64_tr_b16 a[168:169], v78 offset:40960
    ds_read_b64_tr_b16 a[170:171], v78 offset:43008
    v_mfma_f32_16x16x32_bf16 v[172:175], a[232:235], a[252:255], v[172:175]
    ds_read_b128 a[184:187], v70 offset:40960
    buffer_load_dwordx4 v121, s[32:35], s45 offen offset:1024 lds
    v_mfma_f32_16x16x32_bf16 v[188:191], a[236:239], a[252:255], v[188:191]
    ds_read_b64_tr_b16 a[172:173], v79 offset:40960
    v_subrev_u32 v67, 65536, v71
    v_mfma_f32_16x16x32_bf16 v[188:191], a[204:207], a[220:223], v[188:191]
    v_add_u32 v83, 65536, v79
    v_and_b32 v89, 7, v126
    v_mfma_f32_16x16x32_bf16 v[128:131], a[192:195], a[208:211], v[128:131]
    ds_read_b64_tr_b16 a[174:175], v79 offset:43008
    v_lshl_add_u32 v89, s74, 3, v89
    v_mfma_f32_16x16x32_bf16 v[128:131], a[224:227], a[240:243], v[128:131]
    ds_read_b128 a[188:191], v71 offset:40960
    buffer_load_dwordx4 v122, s[32:35], s45 offen offset:2048 lds
    v_mfma_f32_16x16x32_bf16 v[144:147], a[228:231], a[240:243], v[144:147]
    v_and_b32 v90, 3, v89
    v_lshl_add_u32 v90, s78, 2, v90
    v_mfma_f32_16x16x32_bf16 v[144:147], a[196:199], a[208:211], v[144:147]
    v_lshrrev_b32 v116, 2, v89
    v_lshl_add_u32 v116, v90, 3, v116
    v_mfma_f32_16x16x32_bf16 v[160:163], a[200:203], a[208:211], v[160:163]
    v_lshlrev_b32 v116, 7, v116
    v_add_u32 v116, 149946368, v116
    v_mfma_f32_16x16x32_bf16 v[160:163], a[232:235], a[240:243], v[160:163]
    buffer_load_dwordx4 v123, s[32:35], s45 offen offset:3072 lds
    v_mfma_f32_16x16x32_bf16 v[176:179], a[236:239], a[240:243], v[176:179]
    s_xor_b32 s45, s48, 131072
    s_and_b32 s6, s2, 0xfc
    v_mfma_f32_16x16x32_bf16 v[176:179], a[204:207], a[208:211], v[176:179]
    v_and_b32 v89, 3, v126
    v_add_u32 v89, s6, v89
    v_lshlrev_b32 v89, 7, v89
    v_add_u32 v114, 149946368, v89
    s_mov_b32 s16, s64
    s_mov_b32 s17, s65
    s_mov_b32 s18, 2097152
    s_mov_b32 s19, 0x00020000
    s_mov_b32 s20, s82
    s_mov_b32 s21, s83
    s_mov_b32 s22, 2097152
    s_mov_b32 s23, 0x00020000
    v_and_b32 v89, 15, v126
    v_lshrrev_b32 v90, 4, v126
    v_lshlrev_b32 v89, 10, v89
    v_lshl_add_u32 v112, v90, 3, v89
    s_add_u32 s6, s74, 1
    s_and_b32 s6, s6, 3
    s_lshl_b32 s7, s74, 2
    s_add_u32 s6, s6, s7
    s_lshl_b32 s6, s6, 14
    s_add_u32 s49, s6, s70
    s_add_u32 s6, s74, 2
    s_and_b32 s6, s6, 3
    s_lshl_b32 s7, s74, 2
    s_add_u32 s6, s6, s7
    s_lshl_b32 s6, s6, 14
    s_add_u32 s50, s6, s70
    s_add_u32 s6, s74, 3
    s_and_b32 s6, s6, 3
    s_lshl_b32 s7, s74, 2
    s_add_u32 s6, s6, s7
    s_lshl_b32 s6, s6, 14
    s_add_u32 s51, s6, s70
    v_mov_b32 v113, s49
    v_writelane_b32 v113, s50, 1
    v_writelane_b32 v113, s51, 2
    v_mov_b32 v88, s62
    s_waitcnt vmcnt(15) lgkmcnt(0)
    s_barrier
    s_cmp_lg_u32 s3, 0
    s_cbranch_scc1 P2_NOSIG
    s_mov_b64 exec, 1
    buffer_store_dword v88, off, s[88:91], s63 offset:8 sc1
    s_mov_b64 exec, -1
P2_NOSIG:
    v_mfma_f32_16x16x32_bf16 v[132:135], a[128:131], a[148:151], v[132:135]
    ds_read_b64_tr_b16 a[192:193], v76 offset:49152
    ds_read_b64_tr_b16 a[194:195], v76 offset:51200
    v_mfma_f32_16x16x32_bf16 v[132:135], a[160:163], a[180:183], v[132:135]
    ds_read_b128 a[208:211], v68 offset:49152
    s_add_u32 m0, s52, 32768
    v_mfma_f32_16x16x32_bf16 v[148:151], a[164:167], a[180:183], v[148:151]
    ds_read_b64_tr_b16 a[196:197], v77 offset:49152
    v_mfma_f32_16x16x32_bf16 v[148:151], a[132:135], a[148:151], v[148:151]
    buffer_load_dwordx4 v120, s[32:35], s45 offen offset:0 lds
    v_mfma_f32_16x16x32_bf16 v[164:167], a[136:139], a[148:151], v[164:167]
    ds_read_b64_tr_b16 a[198:199], v77 offset:51200
    v_mfma_f32_16x16x32_bf16 v[164:167], a[168:171], a[180:183], v[164:167]
    ds_read_b128 a[212:215], v69 offset:49152
    buffer_load_dwordx4 v121, s[32:35], s45 offen offset:1024 lds
    v_mfma_f32_16x16x32_bf16 v[180:183], a[172:175], a[180:183], v[180:183]
    ds_read_b64_tr_b16 a[200:201], v78 offset:49152
    ds_read_b64_tr_b16 a[202:203], v78 offset:51200
    v_mfma_f32_16x16x32_bf16 v[180:183], a[140:143], a[148:151], v[180:183]
    v_mfma_f32_16x16x32_bf16 v[136:139], a[128:131], a[152:155], v[136:139]
    ds_read_b128 a[216:219], v70 offset:49152
    v_mfma_f32_16x16x32_bf16 v[136:139], a[160:163], a[184:187], v[136:139]
    ds_read_b64_tr_b16 a[204:205], v79 offset:49152
    buffer_load_dwordx4 v122, s[32:35], s45 offen offset:2048 lds
    v_mfma_f32_16x16x32_bf16 v[152:155], a[164:167], a[184:187], v[152:155]
    ds_read_b64_tr_b16 a[206:207], v79 offset:51200
    v_mfma_f32_16x16x32_bf16 v[152:155], a[132:135], a[152:155], v[152:155]
    v_mfma_f32_16x16x32_bf16 v[168:171], a[136:139], a[152:155], v[168:171]
    ds_read_b128 a[220:223], v71 offset:49152
    v_mfma_f32_16x16x32_bf16 v[168:171], a[168:171], a[184:187], v[168:171]
    ds_read_b64_tr_b16 a[224:225], v76 offset:57344
    ds_read_b64_tr_b16 a[226:227], v76 offset:59392
    buffer_load_dwordx4 v123, s[32:35], s45 offen offset:3072 lds
    v_mfma_f32_16x16x32_bf16 v[184:187], a[172:175], a[184:187], v[184:187]
    ds_read_b128 a[240:243], v68 offset:57344
    v_mfma_f32_16x16x32_bf16 v[184:187], a[140:143], a[152:155], v[184:187]
    s_xor_b32 s45, s48, 196608
    s_add_u32 m0, s52, 98304
    v_mfma_f32_16x16x32_bf16 v[140:143], a[128:131], a[156:159], v[140:143]
    ds_read_b64_tr_b16 a[228:229], v77 offset:57344
    v_mfma_f32_16x16x32_bf16 v[140:143], a[160:163], a[188:191], v[140:143]
    ds_read_b64_tr_b16 a[230:231], v77 offset:59392
    buffer_load_dwordx4 v120, s[32:35], s45 offen offset:0 lds
    v_mfma_f32_16x16x32_bf16 v[156:159], a[164:167], a[188:191], v[156:159]
    ds_read_b128 a[244:247], v69 offset:57344
    v_mfma_f32_16x16x32_bf16 v[156:159], a[132:135], a[156:159], v[156:159]
    v_mfma_f32_16x16x32_bf16 v[172:175], a[136:139], a[156:159], v[172:175]
    ds_read_b64_tr_b16 a[232:233], v78 offset:57344
    ds_read_b64_tr_b16 a[234:235], v78 offset:59392
    v_mfma_f32_16x16x32_bf16 v[172:175], a[168:171], a[188:191], v[172:175]
    ds_read_b128 a[248:251], v70 offset:57344
    buffer_load_dwordx4 v121, s[32:35], s45 offen offset:1024 lds
    v_mfma_f32_16x16x32_bf16 v[188:191], a[172:175], a[188:191], v[188:191]
    ds_read_b64_tr_b16 a[236:237], v79 offset:57344
    v_mfma_f32_16x16x32_bf16 v[188:191], a[140:143], a[156:159], v[188:191]
    v_mfma_f32_16x16x32_bf16 v[128:131], a[128:131], a[144:147], v[128:131]
    ds_read_b64_tr_b16 a[238:239], v79 offset:59392
    v_mfma_f32_16x16x32_bf16 v[128:131], a[160:163], a[176:179], v[128:131]
    ds_read_b128 a[252:255], v71 offset:57344
    buffer_load_dwordx4 v122, s[32:35], s45 offen offset:2048 lds
    v_mfma_f32_16x16x32_bf16 v[144:147], a[164:167], a[176:179], v[144:147]
    v_mfma_f32_16x16x32_bf16 v[144:147], a[132:135], a[144:147], v[144:147]
    v_mfma_f32_16x16x32_bf16 v[160:163], a[136:139], a[144:147], v[160:163]
    v_mfma_f32_16x16x32_bf16 v[160:163], a[168:171], a[176:179], v[160:163]
    buffer_load_dwordx4 v123, s[32:35], s45 offen offset:3072 lds
    v_mfma_f32_16x16x32_bf16 v[176:179], a[172:175], a[176:179], v[176:179]
    s_xor_b32 s45, s48, 262144
    v_mfma_f32_16x16x32_bf16 v[176:179], a[140:143], a[144:147], v[176:179]
    s_waitcnt lgkmcnt(0)
    s_barrier
    v_mfma_f32_16x16x32_bf16 v[132:135], a[192:195], a[212:215], v[132:135]
    ds_read_b64_tr_b16 a[128:129], v84 offset:0
    v_mfma_f32_16x16x32_bf16 v[132:135], a[224:227], a[244:247], v[132:135]
    ds_read_b64_tr_b16 a[130:131], v84 offset:2048
    s_add_u32 m0, s52, 49152
    v_mfma_f32_16x16x32_bf16 v[148:151], a[228:231], a[244:247], v[148:151]
    v_mfma_f32_16x16x32_bf16 v[148:151], a[196:199], a[212:215], v[148:151]
    buffer_load_dwordx4 v120, s[32:35], s45 offen offset:0 lds
    v_mfma_f32_16x16x32_bf16 v[164:167], a[200:203], a[212:215], v[164:167]
    ds_read_b128 a[144:147], v72 offset:16384
    v_mfma_f32_16x16x32_bf16 v[164:167], a[232:235], a[244:247], v[164:167]
    buffer_load_dwordx4 v121, s[32:35], s45 offen offset:1024 lds
    v_mfma_f32_16x16x32_bf16 v[180:183], a[236:239], a[244:247], v[180:183]
    ds_read_b64_tr_b16 a[132:133], v85 offset:0
    v_mfma_f32_16x16x32_bf16 v[180:183], a[204:207], a[212:215], v[180:183]
    v_mfma_f32_16x16x32_bf16 v[136:139], a[192:195], a[216:219], v[136:139]
    ds_read_b64_tr_b16 a[134:135], v85 offset:2048
    v_mfma_f32_16x16x32_bf16 v[136:139], a[224:227], a[248:251], v[136:139]
    buffer_load_dwordx4 v122, s[32:35], s45 offen offset:2048 lds
    v_mfma_f32_16x16x32_bf16 v[152:155], a[228:231], a[248:251], v[152:155]
    ds_read_b128 a[148:151], v73 offset:16384
    v_mfma_f32_16x16x32_bf16 v[152:155], a[196:199], a[216:219], v[152:155]
    v_mfma_f32_16x16x32_bf16 v[168:171], a[200:203], a[216:219], v[168:171]
    v_mfma_f32_16x16x32_bf16 v[168:171], a[232:235], a[248:251], v[168:171]
    ds_read_b64_tr_b16 a[136:137], v86 offset:0
    buffer_load_dwordx4 v123, s[32:35], s45 offen offset:3072 lds
    v_mfma_f32_16x16x32_bf16 v[184:187], a[236:239], a[248:251], v[184:187]
    ds_read_b64_tr_b16 a[138:139], v86 offset:2048
    v_mfma_f32_16x16x32_bf16 v[184:187], a[204:207], a[216:219], v[184:187]
    s_xor_b32 s45, s48, 327680
    s_add_u32 m0, s52, 114688
    v_mfma_f32_16x16x32_bf16 v[140:143], a[192:195], a[220:223], v[140:143]
    v_mfma_f32_16x16x32_bf16 v[140:143], a[224:227], a[252:255], v[140:143]
    ds_read_b128 a[152:155], v74 offset:16384
    buffer_load_dwordx4 v120, s[32:35], s45 offen offset:0 lds
    v_mfma_f32_16x16x32_bf16 v[156:159], a[228:231], a[252:255], v[156:159]
    v_mfma_f32_16x16x32_bf16 v[156:159], a[196:199], a[220:223], v[156:159]
    v_mfma_f32_16x16x32_bf16 v[172:175], a[200:203], a[220:223], v[172:175]
    ds_read_b64_tr_b16 a[140:141], v87 offset:0
    v_mfma_f32_16x16x32_bf16 v[172:175], a[232:235], a[252:255], v[172:175]
    ds_read_b64_tr_b16 a[142:143], v87 offset:2048
    buffer_load_dwordx4 v121, s[32:35], s45 offen offset:1024 lds
    v_mfma_f32_16x16x32_bf16 v[188:191], a[236:239], a[252:255], v[188:191]
    v_mfma_f32_16x16x32_bf16 v[188:191], a[204:207], a[220:223], v[188:191]
    v_mfma_f32_16x16x32_bf16 v[128:131], a[192:195], a[208:211], v[128:131]
    ds_read_b128 a[156:159], v75 offset:16384
    v_mfma_f32_16x16x32_bf16 v[128:131], a[224:227], a[240:243], v[128:131]
    buffer_load_dwordx4 v122, s[32:35], s45 offen offset:2048 lds
    v_mfma_f32_16x16x32_bf16 v[144:147], a[228:231], a[240:243], v[144:147]
    v_mfma_f32_16x16x32_bf16 v[144:147], a[196:199], a[208:211], v[144:147]
    v_mfma_f32_16x16x32_bf16 v[160:163], a[200:203], a[208:211], v[160:163]
    v_mfma_f32_16x16x32_bf16 v[160:163], a[232:235], a[240:243], v[160:163]
    buffer_load_dwordx4 v123, s[32:35], s45 offen offset:3072 lds
    v_mfma_f32_16x16x32_bf16 v[176:179], a[236:239], a[240:243], v[176:179]
    s_xor_b32 s45, s48, 393216
    v_mfma_f32_16x16x32_bf16 v[176:179], a[204:207], a[208:211], v[176:179]
    s_waitcnt vmcnt(16) lgkmcnt(0)
    s_barrier
    v_mfma_f32_16x16x32_bf16 v[132:135], a[128:131], a[148:151], v[132:135]
    ds_read_b64_tr_b16 a[192:193], v76 offset:0
    ds_read_b64_tr_b16 a[194:195], v76 offset:2048
    ds_read_b128 a[208:211], v68 offset:0
    ds_read_b64_tr_b16 a[196:197], v77 offset:0
    ds_read_b64_tr_b16 a[198:199], v77 offset:2048
    ds_read_b128 a[212:215], v69 offset:0
    ds_read_b64_tr_b16 a[200:201], v78 offset:0
    ds_read_b64_tr_b16 a[202:203], v78 offset:2048
    ds_read_b128 a[216:219], v70 offset:0
    ds_read_b64_tr_b16 a[204:205], v79 offset:0
    ds_read_b64_tr_b16 a[206:207], v79 offset:2048
    ds_read_b128 a[220:223], v71 offset:0
    v_mfma_f32_16x16x32_bf16 v[148:151], a[132:135], a[148:151], v[148:151]
    buffer_load_dword v117, v116, s[88:91], 0 offen offset:8 sc1
    s_add_u32 m0, s52, 131072
    s_nop 0
    buffer_load_dwordx4 v120, s[32:35], s45 offen offset:0 lds
    v_mfma_f32_16x16x32_bf16 v[164:167], a[136:139], a[148:151], v[164:167]
    ds_read_b64_tr_b16 a[224:225], v76 offset:8192
    ds_read_b64_tr_b16 a[226:227], v76 offset:10240
    ds_read_b128 a[240:243], v68 offset:8192
    ds_read_b64_tr_b16 a[228:229], v77 offset:8192
    ds_read_b64_tr_b16 a[230:231], v77 offset:10240
    ds_read_b128 a[244:247], v69 offset:8192
    ds_read_b64_tr_b16 a[232:233], v78 offset:8192
    ds_read_b64_tr_b16 a[234:235], v78 offset:10240
    ds_read_b128 a[248:251], v70 offset:8192
    ds_read_b64_tr_b16 a[236:237], v79 offset:8192
    ds_read_b64_tr_b16 a[238:239], v79 offset:10240
    ds_read_b128 a[252:255], v71 offset:8192
    v_mfma_f32_16x16x32_bf16 v[180:183], a[140:143], a[148:151], v[180:183]
    buffer_load_dwordx4 v121, s[32:35], s45 offen offset:1024 lds
    buffer_load_dwordx4 v122, s[32:35], s45 offen offset:2048 lds
    v_mfma_f32_16x16x32_bf16 v[136:139], a[128:131], a[152:155], v[136:139]
    ds_read_b64_tr_b16 a[0:1], v76 offset:16384
    ds_read_b64_tr_b16 a[2:3], v76 offset:18432
    ds_read_b64_tr_b16 a[4:5], v77 offset:16384
    ds_read_b64_tr_b16 a[6:7], v77 offset:18432
    ds_read_b64_tr_b16 a[8:9], v78 offset:16384
    ds_read_b64_tr_b16 a[10:11], v78 offset:18432
    ds_read_b64_tr_b16 a[12:13], v79 offset:16384
    ds_read_b64_tr_b16 a[14:15], v79 offset:18432
    ds_read_b64_tr_b16 a[16:17], v76 offset:24576
    ds_read_b64_tr_b16 a[18:19], v76 offset:26624
    ds_read_b64_tr_b16 a[20:21], v77 offset:24576
    ds_read_b64_tr_b16 a[22:23], v77 offset:26624
    v_mfma_f32_16x16x32_bf16 v[152:155], a[132:135], a[152:155], v[152:155]
    buffer_load_dwordx4 v123, s[32:35], s45 offen offset:3072 lds
    s_xor_b32 s45, s48, 458752
    s_add_u32 m0, s52, 147456
    s_nop 0
    buffer_load_dwordx4 v120, s[32:35], s45 offen offset:0 lds
    v_mfma_f32_16x16x32_bf16 v[168:171], a[136:139], a[152:155], v[168:171]
    ds_read_b64_tr_b16 a[24:25], v78 offset:24576
    ds_read_b64_tr_b16 a[26:27], v78 offset:26624
    ds_read_b64_tr_b16 a[28:29], v79 offset:24576
    ds_read_b64_tr_b16 a[30:31], v79 offset:26624
    ds_read_b64_tr_b16 a[32:33], v80 offset:16384
    ds_read_b64_tr_b16 a[34:35], v80 offset:18432
    ds_read_b64_tr_b16 a[36:37], v81 offset:16384
    ds_read_b64_tr_b16 a[38:39], v81 offset:18432
    ds_read_b64_tr_b16 a[40:41], v82 offset:16384
    ds_read_b64_tr_b16 a[42:43], v82 offset:18432
    ds_read_b64_tr_b16 a[44:45], v83 offset:16384
    ds_read_b64_tr_b16 a[46:47], v83 offset:18432
    v_mfma_f32_16x16x32_bf16 v[184:187], a[140:143], a[152:155], v[184:187]
    buffer_load_dwordx4 v121, s[32:35], s45 offen offset:1024 lds
    buffer_load_dwordx4 v122, s[32:35], s45 offen offset:2048 lds
    v_mfma_f32_16x16x32_bf16 v[140:143], a[128:131], a[156:159], v[140:143]
    ds_read_b64_tr_b16 a[48:49], v80 offset:24576
    ds_read_b64_tr_b16 a[50:51], v80 offset:26624
    ds_read_b64_tr_b16 a[52:53], v81 offset:24576
    ds_read_b64_tr_b16 a[54:55], v81 offset:26624
    ds_read_b64_tr_b16 a[56:57], v82 offset:24576
    ds_read_b64_tr_b16 a[58:59], v82 offset:26624
    ds_read_b64_tr_b16 a[60:61], v83 offset:24576
    ds_read_b64_tr_b16 a[62:63], v83 offset:26624
    v_mfma_f32_16x16x32_bf16 v[156:159], a[132:135], a[156:159], v[156:159]
    buffer_load_dwordx4 v123, s[32:35], s45 offen offset:3072 lds
    s_xor_b32 s45, s48, 524288
    v_mfma_f32_16x16x32_bf16 v[172:175], a[136:139], a[156:159], v[172:175]
    v_mfma_f32_16x16x32_bf16 v[188:191], a[140:143], a[156:159], v[188:191]
    v_mfma_f32_16x16x32_bf16 v[128:131], a[128:131], a[144:147], v[128:131]
    v_mfma_f32_16x16x32_bf16 v[144:147], a[132:135], a[144:147], v[144:147]
    v_mfma_f32_16x16x32_bf16 v[160:163], a[136:139], a[144:147], v[160:163]
    v_mfma_f32_16x16x32_bf16 v[176:179], a[140:143], a[144:147], v[176:179]
    s_waitcnt vmcnt(8) lgkmcnt(0)
    s_barrier
    v_cmp_ne_u32 vcc, s62, v117
    s_mov_b32 s56, s44
    s_cmp_eq_u64 vcc, 0
    s_cselect_b32 s14, s75, 0
    v_mfma_f32_16x16x32_bf16 v[132:135], a[192:195], a[212:215], v[132:135]
    ds_read_b64_tr_b16 a[64:65], v76 offset:32768
    ds_read_b64_tr_b16 a[66:67], v76 offset:34816
    ds_read_b64_tr_b16 a[68:69], v77 offset:32768
    v_mfma_f32_16x16x32_bf16 v[132:135], a[224:227], a[244:247], v[132:135]
    s_add_u32 m0, s52, 0
    s_nop 0
    buffer_load_dwordx4 v118, s[12:15], s44 offen offset:0 sc1 lds
    v_mfma_f32_16x16x32_bf16 v[148:151], a[228:231], a[244:247], v[148:151]
    ds_read_b64_tr_b16 a[70:71], v77 offset:34816
    ds_read_b64_tr_b16 a[72:73], v78 offset:32768
    ds_read_b64_tr_b16 a[74:75], v78 offset:34816
    v_mfma_f32_16x16x32_bf16 v[148:151], a[196:199], a[212:215], v[148:151]
    buffer_load_dwordx4 v118, s[12:15], s44 offen offset:1024 sc1 lds
    v_mfma_f32_16x16x32_bf16 v[164:167], a[200:203], a[212:215], v[164:167]
    ds_read_b64_tr_b16 a[76:77], v79 offset:32768
    ds_read_b64_tr_b16 a[78:79], v79 offset:34816
    ds_read_b64_tr_b16 a[80:81], v76 offset:40960
    v_mfma_f32_16x16x32_bf16 v[164:167], a[232:235], a[244:247], v[164:167]
    buffer_load_dwordx4 v118, s[12:15], s44 offen offset:2048 sc1 lds
    v_mfma_f32_16x16x32_bf16 v[180:183], a[236:239], a[244:247], v[180:183]
    ds_read_b64_tr_b16 a[82:83], v76 offset:43008
    ds_read_b64_tr_b16 a[84:85], v77 offset:40960
    ds_read_b64_tr_b16 a[86:87], v77 offset:43008
    v_mfma_f32_16x16x32_bf16 v[180:183], a[204:207], a[212:215], v[180:183]
    buffer_load_dwordx4 v118, s[12:15], s44 offen offset:3072 sc1 lds
    v_mfma_f32_16x16x32_bf16 v[136:139], a[192:195], a[216:219], v[136:139]
    ds_read_b64_tr_b16 a[88:89], v78 offset:40960
    ds_read_b64_tr_b16 a[90:91], v78 offset:43008
    ds_read_b64_tr_b16 a[92:93], v79 offset:40960
    v_mfma_f32_16x16x32_bf16 v[136:139], a[224:227], a[248:251], v[136:139]
    s_xor_b32 s44, s53, 8192
    s_add_u32 m0, s52, 65536
    s_nop 0
    buffer_load_dwordx4 v118, s[12:15], s44 offen offset:0 sc1 lds
    v_mfma_f32_16x16x32_bf16 v[152:155], a[228:231], a[248:251], v[152:155]
    ds_read_b64_tr_b16 a[94:95], v79 offset:43008
    ds_read_b64_tr_b16 a[96:97], v80 offset:32768
    ds_read_b64_tr_b16 a[98:99], v80 offset:34816
    v_mfma_f32_16x16x32_bf16 v[152:155], a[196:199], a[216:219], v[152:155]
    buffer_load_dwordx4 v118, s[12:15], s44 offen offset:1024 sc1 lds
    v_mfma_f32_16x16x32_bf16 v[168:171], a[200:203], a[216:219], v[168:171]
    ds_read_b64_tr_b16 a[100:101], v81 offset:32768
    ds_read_b64_tr_b16 a[102:103], v81 offset:34816
    ds_read_b64_tr_b16 a[104:105], v82 offset:32768
    v_cvt_pk_bf16_f32 v192, v132, v133
    v_cvt_pk_bf16_f32 v193, v134, v135
    v_mfma_f32_16x16x32_bf16 v[168:171], a[232:235], a[248:251], v[168:171]
    buffer_load_dwordx4 v118, s[12:15], s44 offen offset:2048 sc1 lds
    v_cvt_pk_bf16_f32 v194, v148, v149
    v_cvt_pk_bf16_f32 v195, v150, v151
    v_mfma_f32_16x16x32_bf16 v[184:187], a[236:239], a[248:251], v[184:187]
    ds_read_b64_tr_b16 a[106:107], v82 offset:34816
    ds_read_b64_tr_b16 a[108:109], v83 offset:32768
    ds_read_b64_tr_b16 a[110:111], v83 offset:34816
    v_cvt_pk_bf16_f32 v196, v164, v165
    v_cvt_pk_bf16_f32 v197, v166, v167
    v_mfma_f32_16x16x32_bf16 v[184:187], a[204:207], a[216:219], v[184:187]
    buffer_load_dwordx4 v118, s[12:15], s44 offen offset:3072 sc1 lds
    v_cvt_pk_bf16_f32 v198, v180, v181
    v_cvt_pk_bf16_f32 v199, v182, v183
    v_mfma_f32_16x16x32_bf16 v[140:143], a[192:195], a[220:223], v[140:143]
    ds_read_b64_tr_b16 a[112:113], v80 offset:40960
    ds_read_b64_tr_b16 a[114:115], v80 offset:43008
    ds_read_b64_tr_b16 a[116:117], v81 offset:40960
    v_mfma_f32_16x16x32_bf16 v[140:143], a[224:227], a[252:255], v[140:143]
    s_xor_b32 s44, s53, 16384
    s_add_u32 m0, s52, 16384
    s_nop 0
    buffer_load_dwordx4 v118, s[12:15], s44 offen offset:0 sc1 lds
    v_mfma_f32_16x16x32_bf16 v[156:159], a[228:231], a[252:255], v[156:159]
    ds_read_b64_tr_b16 a[118:119], v81 offset:43008
    ds_read_b64_tr_b16 a[120:121], v82 offset:40960
    ds_read_b64_tr_b16 a[122:123], v82 offset:43008
    v_mfma_f32_16x16x32_bf16 v[156:159], a[196:199], a[220:223], v[156:159]
    buffer_load_dwordx4 v118, s[12:15], s44 offen offset:1024 sc1 lds
    v_mfma_f32_16x16x32_bf16 v[172:175], a[200:203], a[220:223], v[172:175]
    ds_read_b64_tr_b16 a[124:125], v83 offset:40960
    ds_read_b64_tr_b16 a[126:127], v83 offset:43008
    v_cvt_pk_bf16_f32 v200, v136, v137
    v_cvt_pk_bf16_f32 v201, v138, v139
    v_mfma_f32_16x16x32_bf16 v[172:175], a[232:235], a[252:255], v[172:175]
    buffer_load_dwordx4 v118, s[12:15], s44 offen offset:2048 sc1 lds
    v_cvt_pk_bf16_f32 v202, v152, v153
    v_cvt_pk_bf16_f32 v203, v154, v155
    v_mfma_f32_16x16x32_bf16 v[188:191], a[236:239], a[252:255], v[188:191]
    v_cvt_pk_bf16_f32 v204, v168, v169
    v_cvt_pk_bf16_f32 v205, v170, v171
    v_mfma_f32_16x16x32_bf16 v[188:191], a[204:207], a[220:223], v[188:191]
    buffer_load_dwordx4 v118, s[12:15], s44 offen offset:3072 sc1 lds
    v_cvt_pk_bf16_f32 v206, v184, v185
    v_cvt_pk_bf16_f32 v207, v186, v187
    v_mfma_f32_16x16x32_bf16 v[128:131], a[192:195], a[208:211], v[128:131]
    v_mfma_f32_16x16x32_bf16 v[128:131], a[224:227], a[240:243], v[128:131]
    s_xor_b32 s44, s53, 24576
    s_add_u32 m0, s52, 81920
    s_nop 0
    buffer_load_dwordx4 v118, s[12:15], s44 offen offset:0 sc1 lds
    v_mfma_f32_16x16x32_bf16 v[144:147], a[228:231], a[240:243], v[144:147]
    v_mfma_f32_16x16x32_bf16 v[144:147], a[196:199], a[208:211], v[144:147]
    buffer_load_dwordx4 v118, s[12:15], s44 offen offset:1024 sc1 lds
    v_mfma_f32_16x16x32_bf16 v[160:163], a[200:203], a[208:211], v[160:163]
    v_mfma_f32_16x16x32_bf16 v[160:163], a[232:235], a[240:243], v[160:163]
    buffer_load_dwordx4 v118, s[12:15], s44 offen offset:2048 sc1 lds
    v_mfma_f32_16x16x32_bf16 v[176:179], a[236:239], a[240:243], v[176:179]
    v_mfma_f32_16x16x32_bf16 v[176:179], a[204:207], a[208:211], v[176:179]
    buffer_load_dwordx4 v118, s[12:15], s44 offen offset:3072 sc1 lds
    s_xor_b32 s44, s53, 32768
    v_cvt_pk_bf16_f32 v208, v140, v141
    v_cvt_pk_bf16_f32 v209, v142, v143
    v_cvt_pk_bf16_f32 v210, v156, v157
    v_cvt_pk_bf16_f32 v211, v158, v159
    v_cvt_pk_bf16_f32 v212, v172, v173
    v_cvt_pk_bf16_f32 v213, v174, v175
    v_cvt_pk_bf16_f32 v214, v188, v189
    v_cvt_pk_bf16_f32 v215, v190, v191
    s_mov_b32 s54, 0
    v_mov_b32 v89, v118
    s_cmp_lg_u32 s14, 0
    s_cbranch_scc1 P2_RUN
    buffer_store_dwordx4 v[192:195], v118, s[88:91], s40 offen offset:2048 sc1
    buffer_store_dwordx4 v[196:199], v118, s[88:91], s40 offen offset:3072 sc1
    buffer_store_dwordx4 v[200:203], v118, s[88:91], s41 offen offset:2048 sc1
    buffer_store_dwordx4 v[204:207], v118, s[88:91], s41 offen offset:3072 sc1
    buffer_store_dwordx4 v[208:211], v118, s[88:91], s42 offen offset:2048 sc1
    buffer_store_dwordx4 v[212:215], v118, s[88:91], s42 offen offset:3072 sc1
    v_mov_b32 v89, 0x40000000
    s_mov_b32 s14, s75
    s_mov_b32 s44, s56
P2_POLL:
    buffer_load_dword v117, v116, s[88:91], 0 offen offset:8 sc1
    s_add_u32 s54, s54, 1
    s_waitcnt vmcnt(0)
    v_cmp_ne_u32 vcc, s62, v117
    s_cmp_gt_u32 s54, 131072
    s_cbranch_scc1 P2_GO
    s_cbranch_vccnz P2_POLL
P2_GO:
    s_add_u32 m0, s52, 0
    s_nop 0
    buffer_load_dwordx4 v118, s[12:15], s44 offen offset:0 sc1 lds
    buffer_load_dwordx4 v118, s[12:15], s44 offen offset:1024 sc1 lds
    buffer_load_dwordx4 v118, s[12:15], s44 offen offset:2048 sc1 lds
    buffer_load_dwordx4 v118, s[12:15], s44 offen offset:3072 sc1 lds
    s_xor_b32 s44, s53, 8192
    s_add_u32 m0, s52, 65536
    s_nop 0
    buffer_load_dwordx4 v118, s[12:15], s44 offen offset:0 sc1 lds
    buffer_load_dwordx4 v118, s[12:15], s44 offen offset:1024 sc1 lds
    buffer_load_dwordx4 v118, s[12:15], s44 offen offset:2048 sc1 lds
    buffer_load_dwordx4 v118, s[12:15], s44 offen offset:3072 sc1 lds
    s_xor_b32 s44, s53, 16384
    s_add_u32 m0, s52, 16384
    s_nop 0
    buffer_load_dwordx4 v118, s[12:15], s44 offen offset:0 sc1 lds
    buffer_load_dwordx4 v118, s[12:15], s44 offen offset:1024 sc1 lds
    buffer_load_dwordx4 v118, s[12:15], s44 offen offset:2048 sc1 lds
    buffer_load_dwordx4 v118, s[12:15], s44 offen offset:3072 sc1 lds
    s_xor_b32 s44, s53, 24576
    s_add_u32 m0, s52, 81920
    s_nop 0
    buffer_load_dwordx4 v118, s[12:15], s44 offen offset:0 sc1 lds
    buffer_load_dwordx4 v118, s[12:15], s44 offen offset:1024 sc1 lds
    buffer_load_dwordx4 v118, s[12:15], s44 offen offset:2048 sc1 lds
    buffer_load_dwordx4 v118, s[12:15], s44 offen offset:3072 sc1 lds
    s_xor_b32 s44, s53, 32768
P2_RUN:
    s_waitcnt vmcnt(12) lgkmcnt(0)
    s_barrier
    ds_read_b128 a[144:147], v64 offset:0
    ds_read_b128 a[148:151], v65 offset:0
    ds_read_b128 a[152:155], v66 offset:0
    ds_read_b128 a[156:159], v67 offset:0
    ds_read_b128 a[176:179], v64 offset:8192
    ds_read_b128 a[180:183], v65 offset:8192
    ds_read_b128 a[184:187], v66 offset:8192
    ds_read_b128 a[188:191], v67 offset:8192
    s_add_u32 m0, s52, 32768
    s_nop 0
    buffer_load_dwordx4 v118, s[12:15], s44 offen offset:0 sc1 lds
    buffer_load_dwordx4 v118, s[12:15], s44 offen offset:1024 sc1 lds
    buffer_load_dwordx4 v118, s[12:15], s44 offen offset:2048 sc1 lds
    buffer_load_dwordx4 v118, s[12:15], s44 offen offset:3072 sc1 lds
    s_xor_b32 s44, s53, 40960
    s_waitcnt vmcnt(12) lgkmcnt(0)
    s_barrier
    v_mfma_f32_16x16x32_bf16 v[4:7], a[0:3], a[148:151], 0
    ds_read_b128 a[208:211], v68 offset:0
    v_mfma_f32_16x16x32_bf16 v[4:7], a[16:19], a[180:183], v[4:7]
    s_add_u32 m0, s52, 98304
    v_mfma_f32_16x16x32_bf16 v[20:23], a[20:23], a[180:183], 0
    ds_read_b128 a[212:215], v69 offset:0
    v_mfma_f32_16x16x32_bf16 v[20:23], a[4:7], a[148:151], v[20:23]
    buffer_load_dwordx4 v118, s[12:15], s44 offen offset:0 sc1 lds
    v_mfma_f32_16x16x32_bf16 v[36:39], a[8:11], a[148:151], 0
    v_mfma_f32_16x16x32_bf16 v[36:39], a[24:27], a[180:183], v[36:39]
    buffer_load_dwordx4 v118, s[12:15], s44 offen offset:1024 sc1 lds
    v_mfma_f32_16x16x32_bf16 v[52:55], a[28:31], a[180:183], 0
    ds_read_b128 a[216:219], v70 offset:0
    v_mfma_f32_16x16x32_bf16 v[52:55], a[12:15], a[148:151], v[52:55]
    v_mfma_f32_16x16x32_bf16 v[8:11], a[0:3], a[152:155], 0
    v_mfma_f32_16x16x32_bf16 v[8:11], a[16:19], a[184:187], v[8:11]
    ds_read_b128 a[220:223], v71 offset:0
    buffer_load_dwordx4 v118, s[12:15], s44 offen offset:2048 sc1 lds
    v_mfma_f32_16x16x32_bf16 v[24:27], a[20:23], a[184:187], 0
    v_mfma_f32_16x16x32_bf16 v[24:27], a[4:7], a[152:155], v[24:27]
    v_mfma_f32_16x16x32_bf16 v[40:43], a[8:11], a[152:155], 0
    v_mfma_f32_16x16x32_bf16 v[40:43], a[24:27], a[184:187], v[40:43]
    ds_read_b128 a[240:243], v68 offset:8192
    buffer_load_dwordx4 v118, s[12:15], s44 offen offset:3072 sc1 lds
    v_mfma_f32_16x16x32_bf16 v[56:59], a[28:31], a[184:187], 0
    v_mfma_f32_16x16x32_bf16 v[56:59], a[12:15], a[152:155], v[56:59]
    s_xor_b32 s44, s53, 49152
    s_add_u32 m0, s52, 0
    v_mfma_f32_16x16x32_bf16 v[12:15], a[0:3], a[156:159], 0
    ds_read_b128 a[244:247], v69 offset:8192
    v_mfma_f32_16x16x32_bf16 v[12:15], a[16:19], a[188:191], v[12:15]
    buffer_load_dwordx4 v118, s[12:15], s44 offen offset:0 sc1 lds
    v_mfma_f32_16x16x32_bf16 v[28:31], a[20:23], a[188:191], 0
    v_mfma_f32_16x16x32_bf16 v[28:31], a[4:7], a[156:159], v[28:31]
    v_mfma_f32_16x16x32_bf16 v[44:47], a[8:11], a[156:159], 0
    ds_read_b128 a[248:251], v70 offset:8192
    v_mfma_f32_16x16x32_bf16 v[44:47], a[24:27], a[188:191], v[44:47]
    buffer_load_dwordx4 v118, s[12:15], s44 offen offset:1024 sc1 lds
    v_mfma_f32_16x16x32_bf16 v[60:63], a[28:31], a[188:191], 0
    ds_read_b128 a[252:255], v71 offset:8192
    v_mfma_f32_16x16x32_bf16 v[60:63], a[12:15], a[156:159], v[60:63]
    v_mfma_f32_16x16x32_bf16 v[0:3], a[0:3], a[144:147], 0
    v_mfma_f32_16x16x32_bf16 v[0:3], a[16:19], a[176:179], v[0:3]
    buffer_load_dwordx4 v118, s[12:15], s44 offen offset:2048 sc1 lds
    v_mfma_f32_16x16x32_bf16 v[16:19], a[20:23], a[176:179], 0
    v_mfma_f32_16x16x32_bf16 v[16:19], a[4:7], a[144:147], v[16:19]
    v_mfma_f32_16x16x32_bf16 v[32:35], a[8:11], a[144:147], 0
    v_mfma_f32_16x16x32_bf16 v[32:35], a[24:27], a[176:179], v[32:35]
    buffer_load_dwordx4 v118, s[12:15], s44 offen offset:3072 sc1 lds
    v_mfma_f32_16x16x32_bf16 v[48:51], a[28:31], a[176:179], 0
    s_xor_b32 s44, s53, 57344
    v_mfma_f32_16x16x32_bf16 v[48:51], a[12:15], a[144:147], v[48:51]
    s_waitcnt vmcnt(16) lgkmcnt(0)
    s_barrier
    v_mfma_f32_16x16x32_bf16 v[4:7], a[32:35], a[212:215], v[4:7]
    ds_read_b128 a[144:147], v64 offset:16384
    v_mfma_f32_16x16x32_bf16 v[4:7], a[48:51], a[244:247], v[4:7]
    s_add_u32 m0, s52, 65536
    v_mfma_f32_16x16x32_bf16 v[20:23], a[52:55], a[244:247], v[20:23]
    ds_read_b128 a[148:151], v65 offset:16384
    v_mfma_f32_16x16x32_bf16 v[20:23], a[36:39], a[212:215], v[20:23]
    buffer_load_dwordx4 v118, s[12:15], s44 offen offset:0 sc1 lds
    v_mfma_f32_16x16x32_bf16 v[36:39], a[40:43], a[212:215], v[36:39]
    v_mfma_f32_16x16x32_bf16 v[36:39], a[56:59], a[244:247], v[36:39]
    v_mfma_f32_16x16x32_bf16 v[52:55], a[60:63], a[244:247], v[52:55]
    ds_read_b128 a[152:155], v66 offset:16384
    v_mfma_f32_16x16x32_bf16 v[52:55], a[44:47], a[212:215], v[52:55]
    v_mfma_f32_16x16x32_bf16 v[8:11], a[32:35], a[216:219], v[8:11]
    v_mfma_f32_16x16x32_bf16 v[8:11], a[48:51], a[248:251], v[8:11]
    ds_read_b128 a[156:159], v67 offset:16384
    buffer_load_dwordx4 v118, s[12:15], s44 offen offset:1024 sc1 lds
    v_mfma_f32_16x16x32_bf16 v[24:27], a[52:55], a[248:251], v[24:27]
    v_mfma_f32_16x16x32_bf16 v[24:27], a[36:39], a[216:219], v[24:27]
    v_mfma_f32_16x16x32_bf16 v[40:43], a[40:43], a[216:219], v[40:43]
    v_mfma_f32_16x16x32_bf16 v[40:43], a[56:59], a[248:251], v[40:43]
    ds_read_b128 a[176:179], v64 offset:24576
    v_mfma_f32_16x16x32_bf16 v[56:59], a[60:63], a[248:251], v[56:59]
    v_mfma_f32_16x16x32_bf16 v[56:59], a[44:47], a[216:219], v[56:59]
    v_mfma_f32_16x16x32_bf16 v[12:15], a[32:35], a[220:223], v[12:15]
    ds_read_b128 a[180:183], v65 offset:24576
    v_mfma_f32_16x16x32_bf16 v[12:15], a[48:51], a[252:255], v[12:15]
    buffer_load_dwordx4 v118, s[12:15], s44 offen offset:2048 sc1 lds
    v_mfma_f32_16x16x32_bf16 v[28:31], a[52:55], a[252:255], v[28:31]
    v_mfma_f32_16x16x32_bf16 v[28:31], a[36:39], a[220:223], v[28:31]
    v_mfma_f32_16x16x32_bf16 v[44:47], a[40:43], a[220:223], v[44:47]
    ds_read_b128 a[184:187], v66 offset:24576
    v_mfma_f32_16x16x32_bf16 v[44:47], a[56:59], a[252:255], v[44:47]
    v_mfma_f32_16x16x32_bf16 v[60:63], a[60:63], a[252:255], v[60:63]
    ds_read_b128 a[188:191], v67 offset:24576
    v_mfma_f32_16x16x32_bf16 v[60:63], a[44:47], a[220:223], v[60:63]
    v_mfma_f32_16x16x32_bf16 v[0:3], a[32:35], a[208:211], v[0:3]
    v_mfma_f32_16x16x32_bf16 v[0:3], a[48:51], a[240:243], v[0:3]
    buffer_load_dwordx4 v118, s[12:15], s44 offen offset:3072 sc1 lds
    v_mfma_f32_16x16x32_bf16 v[16:19], a[52:55], a[240:243], v[16:19]
    s_xor_b32 s44, s53, 65536
    v_mfma_f32_16x16x32_bf16 v[16:19], a[36:39], a[208:211], v[16:19]
    v_mfma_f32_16x16x32_bf16 v[32:35], a[40:43], a[208:211], v[32:35]
    v_mfma_f32_16x16x32_bf16 v[32:35], a[56:59], a[240:243], v[32:35]
    v_mfma_f32_16x16x32_bf16 v[48:51], a[60:63], a[240:243], v[48:51]
    v_mfma_f32_16x16x32_bf16 v[48:51], a[44:47], a[208:211], v[48:51]
    s_waitcnt vmcnt(16) lgkmcnt(0)
    s_barrier
    v_mfma_f32_16x16x32_bf16 v[4:7], a[64:67], a[148:151], v[4:7]
    ds_read_b128 a[208:211], v68 offset:16384
    v_mfma_f32_16x16x32_bf16 v[4:7], a[80:83], a[180:183], v[4:7]
    s_add_u32 m0, s52, 16384
    v_mfma_f32_16x16x32_bf16 v[20:23], a[84:87], a[180:183], v[20:23]
    ds_read_b128 a[212:215], v69 offset:16384
    v_mfma_f32_16x16x32_bf16 v[20:23], a[68:71], a[148:151], v[20:23]
    buffer_load_dwordx4 v118, s[12:15], s44 offen offset:0 sc1 lds
    v_mfma_f32_16x16x32_bf16 v[36:39], a[72:75], a[148:151], v[36:39]
    v_mfma_f32_16x16x32_bf16 v[36:39], a[88:91], a[180:183], v[36:39]
    v_mfma_f32_16x16x32_bf16 v[52:55], a[92:95], a[180:183], v[52:55]
    ds_read_b128 a[216:219], v70 offset:16384
    v_mfma_f32_16x16x32_bf16 v[52:55], a[76:79], a[148:151], v[52:55]
    buffer_load_dwordx4 v118, s[12:15], s44 offen offset:1024 sc1 lds
    v_mfma_f32_16x16x32_bf16 v[8:11], a[64:67], a[152:155], v[8:11]
    v_mfma_f32_16x16x32_bf16 v[8:11], a[80:83], a[184:187], v[8:11]
    ds_read_b128 a[220:223], v71 offset:16384
    v_mfma_f32_16x16x32_bf16 v[24:27], a[84:87], a[184:187], v[24:27]
    v_mfma_f32_16x16x32_bf16 v[24:27], a[68:71], a[152:155], v[24:27]
    v_mfma_f32_16x16x32_bf16 v[40:43], a[72:75], a[152:155], v[40:43]
    v_mfma_f32_16x16x32_bf16 v[40:43], a[88:91], a[184:187], v[40:43]
    ds_read_b128 a[240:243], v68 offset:24576
    buffer_load_dwordx4 v118, s[12:15], s44 offen offset:2048 sc1 lds
    v_mfma_f32_16x16x32_bf16 v[56:59], a[92:95], a[184:187], v[56:59]
    v_mfma_f32_16x16x32_bf16 v[56:59], a[76:79], a[152:155], v[56:59]
    v_mfma_f32_16x16x32_bf16 v[12:15], a[64:67], a[156:159], v[12:15]
    ds_read_b128 a[244:247], v69 offset:24576
    v_mfma_f32_16x16x32_bf16 v[12:15], a[80:83], a[188:191], v[12:15]
    buffer_load_dwordx4 v118, s[12:15], s44 offen offset:3072 sc1 lds
    v_mfma_f32_16x16x32_bf16 v[28:31], a[84:87], a[188:191], v[28:31]
    v_mfma_f32_16x16x32_bf16 v[28:31], a[68:71], a[156:159], v[28:31]
    v_mfma_f32_16x16x32_bf16 v[44:47], a[72:75], a[156:159], v[44:47]
    ds_read_b128 a[248:251], v70 offset:24576
    v_mfma_f32_16x16x32_bf16 v[44:47], a[88:91], a[188:191], v[44:47]
    s_xor_b32 s44, s53, 73728
    v_mfma_f32_16x16x32_bf16 v[60:63], a[92:95], a[188:191], v[60:63]
    ds_read_b128 a[252:255], v71 offset:24576
    v_mfma_f32_16x16x32_bf16 v[60:63], a[76:79], a[156:159], v[60:63]
    buffer_store_dwordx4 v[192:195], v89, s[88:91], s40 offen offset:2048 sc1
    v_mfma_f32_16x16x32_bf16 v[0:3], a[64:67], a[144:147], v[0:3]
    v_mfma_f32_16x16x32_bf16 v[0:3], a[80:83], a[176:179], v[0:3]
    v_mfma_f32_16x16x32_bf16 v[16:19], a[84:87], a[176:179], v[16:19]
    v_mfma_f32_16x16x32_bf16 v[16:19], a[68:71], a[144:147], v[16:19]
    buffer_store_dwordx4 v[196:199], v89, s[88:91], s40 offen offset:3072 sc1
    v_mfma_f32_16x16x32_bf16 v[32:35], a[72:75], a[144:147], v[32:35]
    v_mfma_f32_16x16x32_bf16 v[32:35], a[88:91], a[176:179], v[32:35]
    v_mfma_f32_16x16x32_bf16 v[48:51], a[92:95], a[176:179], v[48:51]
    v_mfma_f32_16x16x32_bf16 v[48:51], a[76:79], a[144:147], v[48:51]
    s_waitcnt vmcnt(18) lgkmcnt(0)
    s_barrier
    v_mfma_f32_16x16x32_bf16 v[4:7], a[96:99], a[212:215], v[4:7]
    ds_read_b64_tr_b16 a[128:129], v76 offset:49152
    ds_read_b64_tr_b16 a[130:131], v76 offset:51200
    v_mfma_f32_16x16x32_bf16 v[4:7], a[112:115], a[244:247], v[4:7]
    ds_read_b128 a[144:147], v64 offset:32768
    s_add_u32 m0, s52, 81920
    v_mfma_f32_16x16x32_bf16 v[20:23], a[116:119], a[244:247], v[20:23]
    ds_read_b64_tr_b16 a[132:133], v77 offset:49152
    v_mfma_f32_16x16x32_bf16 v[20:23], a[100:103], a[212:215], v[20:23]
    buffer_load_dwordx4 v120, s[32:35], s45 offen offset:0 lds
    v_mfma_f32_16x16x32_bf16 v[36:39], a[104:107], a[212:215], v[36:39]
    ds_read_b64_tr_b16 a[134:135], v77 offset:51200
    v_mfma_f32_16x16x32_bf16 v[36:39], a[120:123], a[244:247], v[36:39]
    ds_read_b128 a[148:151], v65 offset:32768
    v_mfma_f32_16x16x32_bf16 v[52:55], a[124:127], a[244:247], v[52:55]
    ds_read_b64_tr_b16 a[136:137], v78 offset:49152
    ds_read_b64_tr_b16 a[138:139], v78 offset:51200
    v_mfma_f32_16x16x32_bf16 v[52:55], a[108:111], a[212:215], v[52:55]
    buffer_load_dwordx4 v121, s[32:35], s45 offen offset:1024 lds
    v_mfma_f32_16x16x32_bf16 v[8:11], a[96:99], a[216:219], v[8:11]
    ds_read_b128 a[152:155], v66 offset:32768
    v_mfma_f32_16x16x32_bf16 v[8:11], a[112:115], a[248:251], v[8:11]
    ds_read_b64_tr_b16 a[140:141], v79 offset:49152
    v_mfma_f32_16x16x32_bf16 v[24:27], a[116:119], a[248:251], v[24:27]
    ds_read_b64_tr_b16 a[142:143], v79 offset:51200
    v_mfma_f32_16x16x32_bf16 v[24:27], a[100:103], a[216:219], v[24:27]
    v_mfma_f32_16x16x32_bf16 v[40:43], a[104:107], a[216:219], v[40:43]
    ds_read_b128 a[156:159], v67 offset:32768
    v_mfma_f32_16x16x32_bf16 v[40:43], a[120:123], a[248:251], v[40:43]
    ds_read_b64_tr_b16 a[160:161], v76 offset:57344
    ds_read_b64_tr_b16 a[162:163], v76 offset:59392
    buffer_load_dwordx4 v122, s[32:35], s45 offen offset:2048 lds
    v_mfma_f32_16x16x32_bf16 v[56:59], a[124:127], a[248:251], v[56:59]
    ds_read_b128 a[176:179], v64 offset:40960
    v_mfma_f32_16x16x32_bf16 v[56:59], a[108:111], a[216:219], v[56:59]
    v_mfma_f32_16x16x32_bf16 v[12:15], a[96:99], a[220:223], v[12:15]
    ds_read_b64_tr_b16 a[164:165], v77 offset:57344
    v_mfma_f32_16x16x32_bf16 v[12:15], a[112:115], a[252:255], v[12:15]
    ds_read_b64_tr_b16 a[166:167], v77 offset:59392
    buffer_load_dwordx4 v123, s[32:35], s45 offen offset:3072 lds
    v_mfma_f32_16x16x32_bf16 v[28:31], a[116:119], a[252:255], v[28:31]
    ds_read_b128 a[180:183], v65 offset:40960
    v_mfma_f32_16x16x32_bf16 v[28:31], a[100:103], a[220:223], v[28:31]
    v_mfma_f32_16x16x32_bf16 v[44:47], a[104:107], a[220:223], v[44:47]
    ds_read_b64_tr_b16 a[168:169], v78 offset:57344
    ds_read_b64_tr_b16 a[170:171], v78 offset:59392
    v_mfma_f32_16x16x32_bf16 v[44:47], a[120:123], a[252:255], v[44:47]
    ds_read_b128 a[184:187], v66 offset:40960
    s_xor_b32 s45, s48, 589824
    v_mfma_f32_16x16x32_bf16 v[60:63], a[124:127], a[252:255], v[60:63]
    ds_read_b64_tr_b16 a[172:173], v79 offset:57344
    v_mfma_f32_16x16x32_bf16 v[60:63], a[108:111], a[220:223], v[60:63]
    buffer_store_dwordx4 v[200:203], v89, s[88:91], s41 offen offset:2048 sc1
    v_mfma_f32_16x16x32_bf16 v[0:3], a[96:99], a[208:211], v[0:3]
    ds_read_b64_tr_b16 a[174:175], v79 offset:59392
    v_mfma_f32_16x16x32_bf16 v[0:3], a[112:115], a[240:243], v[0:3]
    ds_read_b128 a[188:191], v67 offset:40960
    v_mfma_f32_16x16x32_bf16 v[16:19], a[116:119], a[240:243], v[16:19]
    v_mfma_f32_16x16x32_bf16 v[16:19], a[100:103], a[208:211], v[16:19]
    buffer_store_dwordx4 v[204:207], v89, s[88:91], s41 offen offset:3072 sc1
    v_mfma_f32_16x16x32_bf16 v[32:35], a[104:107], a[208:211], v[32:35]
    v_mfma_f32_16x16x32_bf16 v[32:35], a[120:123], a[240:243], v[32:35]
    v_mfma_f32_16x16x32_bf16 v[48:51], a[124:127], a[240:243], v[48:51]
    v_mfma_f32_16x16x32_bf16 v[48:51], a[108:111], a[208:211], v[48:51]
    s_waitcnt vmcnt(20) lgkmcnt(0)
    s_barrier
    v_mfma_f32_16x16x32_bf16 v[4:7], a[128:131], a[148:151], v[4:7]
    ds_read_b64_tr_b16 a[192:193], v80 offset:49152
    ds_read_b64_tr_b16 a[194:195], v80 offset:51200
    v_mfma_f32_16x16x32_bf16 v[4:7], a[160:163], a[180:183], v[4:7]
    ds_read_b128 a[208:211], v68 offset:32768
    s_add_u32 m0, s52, 32768
    v_mfma_f32_16x16x32_bf16 v[20:23], a[164:167], a[180:183], v[20:23]
    ds_read_b64_tr_b16 a[196:197], v81 offset:49152
    v_mfma_f32_16x16x32_bf16 v[20:23], a[132:135], a[148:151], v[20:23]
    buffer_load_dwordx4 v118, s[12:15], s44 offen offset:0 sc1 lds
    v_mfma_f32_16x16x32_bf16 v[36:39], a[136:139], a[148:151], v[36:39]
    ds_read_b64_tr_b16 a[198:199], v81 offset:51200
    v_mfma_f32_16x16x32_bf16 v[36:39], a[168:171], a[180:183], v[36:39]
    ds_read_b128 a[212:215], v69 offset:32768
    buffer_load_dwordx4 v118, s[12:15], s44 offen offset:1024 sc1 lds
    v_mfma_f32_16x16x32_bf16 v[52:55], a[172:175], a[180:183], v[52:55]
    ds_read_b64_tr_b16 a[200:201], v82 offset:49152
    ds_read_b64_tr_b16 a[202:203], v82 offset:51200
    v_mfma_f32_16x16x32_bf16 v[52:55], a[140:143], a[148:151], v[52:55]
    v_mfma_f32_16x16x32_bf16 v[8:11], a[128:131], a[152:155], v[8:11]
    ds_read_b128 a[216:219], v70 offset:32768
    v_mfma_f32_16x16x32_bf16 v[8:11], a[160:163], a[184:187], v[8:11]
    ds_read_b64_tr_b16 a[204:205], v83 offset:49152
    buffer_load_dwordx4 v118, s[12:15], s44 offen offset:2048 sc1 lds
    v_mfma_f32_16x16x32_bf16 v[24:27], a[164:167], a[184:187], v[24:27]
    ds_read_b64_tr_b16 a[206:207], v83 offset:51200
    v_mfma_f32_16x16x32_bf16 v[24:27], a[132:135], a[152:155], v[24:27]
    buffer_load_dwordx4 v118, s[12:15], s44 offen offset:3072 sc1 lds
    v_mfma_f32_16x16x32_bf16 v[40:43], a[136:139], a[152:155], v[40:43]
    ds_read_b128 a[220:223], v71 offset:32768
    v_mfma_f32_16x16x32_bf16 v[40:43], a[168:171], a[184:187], v[40:43]
    ds_read_b64_tr_b16 a[224:225], v80 offset:57344
    ds_read_b64_tr_b16 a[226:227], v80 offset:59392
    s_xor_b32 s44, s53, 81920
    s_add_u32 m0, s52, 49152
    v_mfma_f32_16x16x32_bf16 v[56:59], a[172:175], a[184:187], v[56:59]
    ds_read_b128 a[240:243], v68 offset:40960
    v_mfma_f32_16x16x32_bf16 v[56:59], a[140:143], a[152:155], v[56:59]
    buffer_load_dwordx4 v120, s[32:35], s45 offen offset:0 lds
    v_mfma_f32_16x16x32_bf16 v[12:15], a[128:131], a[156:159], v[12:15]
    ds_read_b64_tr_b16 a[228:229], v81 offset:57344
    v_mfma_f32_16x16x32_bf16 v[12:15], a[160:163], a[188:191], v[12:15]
    ds_read_b64_tr_b16 a[230:231], v81 offset:59392
    buffer_load_dwordx4 v121, s[32:35], s45 offen offset:1024 lds
    v_mfma_f32_16x16x32_bf16 v[28:31], a[164:167], a[188:191], v[28:31]
    ds_read_b128 a[244:247], v69 offset:40960
    v_mfma_f32_16x16x32_bf16 v[28:31], a[132:135], a[156:159], v[28:31]
    v_mfma_f32_16x16x32_bf16 v[44:47], a[136:139], a[156:159], v[44:47]
    ds_read_b64_tr_b16 a[232:233], v82 offset:57344
    ds_read_b64_tr_b16 a[234:235], v82 offset:59392
    v_mfma_f32_16x16x32_bf16 v[44:47], a[168:171], a[188:191], v[44:47]
    ds_read_b128 a[248:251], v70 offset:40960
    buffer_load_dwordx4 v122, s[32:35], s45 offen offset:2048 lds
    v_mfma_f32_16x16x32_bf16 v[60:63], a[172:175], a[188:191], v[60:63]
    ds_read_b64_tr_b16 a[236:237], v83 offset:57344
    v_mfma_f32_16x16x32_bf16 v[60:63], a[140:143], a[156:159], v[60:63]
    buffer_load_dwordx4 v123, s[32:35], s45 offen offset:3072 lds
    v_mfma_f32_16x16x32_bf16 v[0:3], a[128:131], a[144:147], v[0:3]
    ds_read_b64_tr_b16 a[238:239], v83 offset:59392
    v_mfma_f32_16x16x32_bf16 v[0:3], a[160:163], a[176:179], v[0:3]
    ds_read_b128 a[252:255], v71 offset:40960
    s_xor_b32 s45, s48, 655360
    v_mfma_f32_16x16x32_bf16 v[16:19], a[164:167], a[176:179], v[16:19]
    v_mfma_f32_16x16x32_bf16 v[16:19], a[132:135], a[144:147], v[16:19]
    buffer_store_dwordx4 v[208:211], v89, s[88:91], s42 offen offset:2048 sc1
    v_mfma_f32_16x16x32_bf16 v[32:35], a[136:139], a[144:147], v[32:35]
    v_mfma_f32_16x16x32_bf16 v[32:35], a[168:171], a[176:179], v[32:35]
    buffer_store_dwordx4 v[212:215], v89, s[88:91], s42 offen offset:3072 sc1
    v_mfma_f32_16x16x32_bf16 v[48:51], a[172:175], a[176:179], v[48:51]
    v_mfma_f32_16x16x32_bf16 v[48:51], a[140:143], a[144:147], v[48:51]
    s_waitcnt vmcnt(26) lgkmcnt(0)
    s_barrier
    v_mfma_f32_16x16x32_bf16 v[4:7], a[192:195], a[212:215], v[4:7]
    ds_read_b64_tr_b16 a[128:129], v84 offset:0
    ds_read_b64_tr_b16 a[130:131], v84 offset:2048
    v_mfma_f32_16x16x32_bf16 v[4:7], a[224:227], a[244:247], v[4:7]
    ds_read_b128 a[144:147], v64 offset:0
    s_add_u32 m0, s52, 98304
    v_mfma_f32_16x16x32_bf16 v[20:23], a[228:231], a[244:247], v[20:23]
    ds_read_b64_tr_b16 a[132:133], v85 offset:0
    v_mfma_f32_16x16x32_bf16 v[20:23], a[196:199], a[212:215], v[20:23]
    buffer_load_dwordx4 v118, s[12:15], s44 offen offset:0 sc1 lds
    v_mfma_f32_16x16x32_bf16 v[36:39], a[200:203], a[212:215], v[36:39]
    ds_read_b64_tr_b16 a[134:135], v85 offset:2048
    v_mfma_f32_16x16x32_bf16 v[36:39], a[232:235], a[244:247], v[36:39]
    ds_read_b128 a[148:151], v65 offset:0
    buffer_load_dwordx4 v118, s[12:15], s44 offen offset:1024 sc1 lds
    v_mfma_f32_16x16x32_bf16 v[52:55], a[236:239], a[244:247], v[52:55]
    ds_read_b64_tr_b16 a[136:137], v86 offset:0
    ds_read_b64_tr_b16 a[138:139], v86 offset:2048
    v_mfma_f32_16x16x32_bf16 v[52:55], a[204:207], a[212:215], v[52:55]
    v_mfma_f32_16x16x32_bf16 v[8:11], a[192:195], a[216:219], v[8:11]
    ds_read_b128 a[152:155], v66 offset:0
    v_mfma_f32_16x16x32_bf16 v[8:11], a[224:227], a[248:251], v[8:11]
    ds_read_b64_tr_b16 a[140:141], v87 offset:0
    buffer_load_dwordx4 v118, s[12:15], s44 offen offset:2048 sc1 lds
    v_mfma_f32_16x16x32_bf16 v[24:27], a[228:231], a[248:251], v[24:27]
    ds_read_b64_tr_b16 a[142:143], v87 offset:2048
    v_mfma_f32_16x16x32_bf16 v[24:27], a[196:199], a[216:219], v[24:27]
    v_mfma_f32_16x16x32_bf16 v[40:43], a[200:203], a[216:219], v[40:43]
    ds_read_b128 a[156:159], v67 offset:0
    v_mfma_f32_16x16x32_bf16 v[40:43], a[232:235], a[248:251], v[40:43]
    ds_read_b64_tr_b16 a[160:161], v84 offset:8192
    ds_read_b64_tr_b16 a[162:163], v84 offset:10240
    buffer_load_dwordx4 v118, s[12:15], s44 offen offset:3072 sc1 lds
    v_mfma_f32_16x16x32_bf16 v[56:59], a[236:239], a[248:251], v[56:59]
    ds_read_b128 a[176:179], v64 offset:8192
    v_mfma_f32_16x16x32_bf16 v[56:59], a[204:207], a[216:219], v[56:59]
    s_xor_b32 s44, s53, 90112
    s_add_u32 m0, s52, 114688
    v_mfma_f32_16x16x32_bf16 v[12:15], a[192:195], a[220:223], v[12:15]
    ds_read_b64_tr_b16 a[164:165], v85 offset:8192
    v_mfma_f32_16x16x32_bf16 v[12:15], a[224:227], a[252:255], v[12:15]
    ds_read_b64_tr_b16 a[166:167], v85 offset:10240
    buffer_load_dwordx4 v120, s[32:35], s45 offen offset:0 lds
    v_mfma_f32_16x16x32_bf16 v[28:31], a[228:231], a[252:255], v[28:31]
    ds_read_b128 a[180:183], v65 offset:8192
    v_mfma_f32_16x16x32_bf16 v[28:31], a[196:199], a[220:223], v[28:31]
    v_mfma_f32_16x16x32_bf16 v[44:47], a[200:203], a[220:223], v[44:47]
    ds_read_b64_tr_b16 a[168:169], v86 offset:8192
    ds_read_b64_tr_b16 a[170:171], v86 offset:10240
    v_mfma_f32_16x16x32_bf16 v[44:47], a[232:235], a[252:255], v[44:47]
    ds_read_b128 a[184:187], v66 offset:8192
    buffer_load_dwordx4 v121, s[32:35], s45 offen offset:1024 lds
    v_mfma_f32_16x16x32_bf16 v[60:63], a[236:239], a[252:255], v[60:63]
    ds_read_b64_tr_b16 a[172:173], v87 offset:8192
    v_mfma_f32_16x16x32_bf16 v[60:63], a[204:207], a[220:223], v[60:63]
    v_mfma_f32_16x16x32_bf16 v[0:3], a[192:195], a[208:211], v[0:3]
    ds_read_b64_tr_b16 a[174:175], v87 offset:10240
    v_mfma_f32_16x16x32_bf16 v[0:3], a[224:227], a[240:243], v[0:3]
    ds_read_b128 a[188:191], v67 offset:8192
    buffer_load_dwordx4 v122, s[32:35], s45 offen offset:2048 lds
    v_mfma_f32_16x16x32_bf16 v[16:19], a[228:231], a[240:243], v[16:19]
    v_mfma_f32_16x16x32_bf16 v[16:19], a[196:199], a[208:211], v[16:19]
    v_mfma_f32_16x16x32_bf16 v[32:35], a[200:203], a[208:211], v[32:35]
    v_mfma_f32_16x16x32_bf16 v[32:35], a[232:235], a[240:243], v[32:35]
    buffer_load_dwordx4 v123, s[32:35], s45 offen offset:3072 lds
    v_mfma_f32_16x16x32_bf16 v[48:51], a[236:239], a[240:243], v[48:51]
    s_xor_b32 s45, s48, 720896
    v_mfma_f32_16x16x32_bf16 v[48:51], a[204:207], a[208:211], v[48:51]
    s_waitcnt vmcnt(30) lgkmcnt(0)
    s_barrier
    v_mfma_f32_16x16x32_bf16 v[4:7], a[128:131], a[148:151], v[4:7]
    ds_read_b64_tr_b16 a[192:193], v84 offset:16384
    ds_read_b64_tr_b16 a[194:195], v84 offset:18432
    v_mfma_f32_16x16x32_bf16 v[4:7], a[160:163], a[180:183], v[4:7]
    ds_read_b128 a[208:211], v68 offset:0
    s_add_u32 m0, s52, 0
    v_mfma_f32_16x16x32_bf16 v[20:23], a[164:167], a[180:183], v[20:23]
    ds_read_b64_tr_b16 a[196:197], v85 offset:16384
    v_mfma_f32_16x16x32_bf16 v[20:23], a[132:135], a[148:151], v[20:23]
    buffer_load_dwordx4 v118, s[12:15], s44 offen offset:0 sc1 lds
    v_mfma_f32_16x16x32_bf16 v[36:39], a[136:139], a[148:151], v[36:39]
    ds_read_b64_tr_b16 a[198:199], v85 offset:18432
    v_mfma_f32_16x16x32_bf16 v[36:39], a[168:171], a[180:183], v[36:39]
    ds_read_b128 a[212:215], v69 offset:0
    buffer_load_dwordx4 v118, s[12:15], s44 offen offset:1024 sc1 lds
    v_mfma_f32_16x16x32_bf16 v[52:55], a[172:175], a[180:183], v[52:55]
    ds_read_b64_tr_b16 a[200:201], v86 offset:16384
    ds_read_b64_tr_b16 a[202:203], v86 offset:18432
    v_mfma_f32_16x16x32_bf16 v[52:55], a[140:143], a[148:151], v[52:55]
    v_mfma_f32_16x16x32_bf16 v[8:11], a[128:131], a[152:155], v[8:11]
    ds_read_b128 a[216:219], v70 offset:0
    v_mfma_f32_16x16x32_bf16 v[8:11], a[160:163], a[184:187], v[8:11]
    ds_read_b64_tr_b16 a[204:205], v87 offset:16384
    buffer_load_dwordx4 v118, s[12:15], s44 offen offset:2048 sc1 lds
    v_mfma_f32_16x16x32_bf16 v[24:27], a[164:167], a[184:187], v[24:27]
    ds_read_b64_tr_b16 a[206:207], v87 offset:18432
    v_mfma_f32_16x16x32_bf16 v[24:27], a[132:135], a[152:155], v[24:27]
    v_mfma_f32_16x16x32_bf16 v[40:43], a[136:139], a[152:155], v[40:43]
    ds_read_b128 a[220:223], v71 offset:0
    v_mfma_f32_16x16x32_bf16 v[40:43], a[168:171], a[184:187], v[40:43]
    ds_read_b64_tr_b16 a[224:225], v84 offset:24576
    ds_read_b64_tr_b16 a[226:227], v84 offset:26624
    buffer_load_dwordx4 v118, s[12:15], s44 offen offset:3072 sc1 lds
    v_mfma_f32_16x16x32_bf16 v[56:59], a[172:175], a[184:187], v[56:59]
    ds_read_b128 a[240:243], v68 offset:8192
    v_mfma_f32_16x16x32_bf16 v[56:59], a[140:143], a[152:155], v[56:59]
    s_xor_b32 s44, s53, 98304
    s_add_u32 m0, s52, 131072
    v_mfma_f32_16x16x32_bf16 v[12:15], a[128:131], a[156:159], v[12:15]
    ds_read_b64_tr_b16 a[228:229], v85 offset:24576
    v_mfma_f32_16x16x32_bf16 v[12:15], a[160:163], a[188:191], v[12:15]
    ds_read_b64_tr_b16 a[230:231], v85 offset:26624
    buffer_load_dwordx4 v120, s[32:35], s45 offen offset:0 lds
    v_mfma_f32_16x16x32_bf16 v[28:31], a[164:167], a[188:191], v[28:31]
    ds_read_b128 a[244:247], v69 offset:8192
    v_mfma_f32_16x16x32_bf16 v[28:31], a[132:135], a[156:159], v[28:31]
    v_mfma_f32_16x16x32_bf16 v[44:47], a[136:139], a[156:159], v[44:47]
    ds_read_b64_tr_b16 a[232:233], v86 offset:24576
    ds_read_b64_tr_b16 a[234:235], v86 offset:26624
    v_mfma_f32_16x16x32_bf16 v[44:47], a[168:171], a[188:191], v[44:47]
    ds_read_b128 a[248:251], v70 offset:8192
    buffer_load_dwordx4 v121, s[32:35], s45 offen offset:1024 lds
    v_mfma_f32_16x16x32_bf16 v[60:63], a[172:175], a[188:191], v[60:63]
    ds_read_b64_tr_b16 a[236:237], v87 offset:24576
    v_mfma_f32_16x16x32_bf16 v[60:63], a[140:143], a[156:159], v[60:63]
    v_mfma_f32_16x16x32_bf16 v[0:3], a[128:131], a[144:147], v[0:3]
    ds_read_b64_tr_b16 a[238:239], v87 offset:26624
    v_mfma_f32_16x16x32_bf16 v[0:3], a[160:163], a[176:179], v[0:3]
    ds_read_b128 a[252:255], v71 offset:8192
    buffer_load_dwordx4 v122, s[32:35], s45 offen offset:2048 lds
    v_mfma_f32_16x16x32_bf16 v[16:19], a[164:167], a[176:179], v[16:19]
    v_mfma_f32_16x16x32_bf16 v[16:19], a[132:135], a[144:147], v[16:19]
    v_mfma_f32_16x16x32_bf16 v[32:35], a[136:139], a[144:147], v[32:35]
    v_mfma_f32_16x16x32_bf16 v[32:35], a[168:171], a[176:179], v[32:35]
    buffer_load_dwordx4 v123, s[32:35], s45 offen offset:3072 lds
    v_mfma_f32_16x16x32_bf16 v[48:51], a[172:175], a[176:179], v[48:51]
    s_xor_b32 s45, s48, 786432
    v_mfma_f32_16x16x32_bf16 v[48:51], a[140:143], a[144:147], v[48:51]
    s_waitcnt vmcnt(28) lgkmcnt(0)
    s_barrier
    v_mfma_f32_16x16x32_bf16 v[4:7], a[192:195], a[212:215], v[4:7]
    ds_read_b64_tr_b16 a[128:129], v80 offset:16384
    ds_read_b64_tr_b16 a[130:131], v80 offset:18432
    v_mfma_f32_16x16x32_bf16 v[4:7], a[224:227], a[244:247], v[4:7]
    ds_read_b128 a[144:147], v64 offset:16384
    s_add_u32 m0, s52, 65536
    v_mfma_f32_16x16x32_bf16 v[20:23], a[228:231], a[244:247], v[20:23]
    ds_read_b64_tr_b16 a[132:133], v81 offset:16384
    v_mfma_f32_16x16x32_bf16 v[20:23], a[196:199], a[212:215], v[20:23]
    buffer_load_dwordx4 v118, s[12:15], s44 offen offset:0 sc1 lds
    v_mfma_f32_16x16x32_bf16 v[36:39], a[200:203], a[212:215], v[36:39]
    ds_read_b64_tr_b16 a[134:135], v81 offset:18432
    v_mfma_f32_16x16x32_bf16 v[36:39], a[232:235], a[244:247], v[36:39]
    ds_read_b128 a[148:151], v65 offset:16384
    buffer_load_dwordx4 v118, s[12:15], s44 offen offset:1024 sc1 lds
    v_mfma_f32_16x16x32_bf16 v[52:55], a[236:239], a[244:247], v[52:55]
    ds_read_b64_tr_b16 a[136:137], v82 offset:16384
    ds_read_b64_tr_b16 a[138:139], v82 offset:18432
    v_mfma_f32_16x16x32_bf16 v[52:55], a[204:207], a[212:215], v[52:55]
    v_mfma_f32_16x16x32_bf16 v[8:11], a[192:195], a[216:219], v[8:11]
    ds_read_b128 a[152:155], v66 offset:16384
    v_mfma_f32_16x16x32_bf16 v[8:11], a[224:227], a[248:251], v[8:11]
    ds_read_b64_tr_b16 a[140:141], v83 offset:16384
    buffer_load_dwordx4 v118, s[12:15], s44 offen offset:2048 sc1 lds
    v_mfma_f32_16x16x32_bf16 v[24:27], a[228:231], a[248:251], v[24:27]
    ds_read_b64_tr_b16 a[142:143], v83 offset:18432
    v_mfma_f32_16x16x32_bf16 v[24:27], a[196:199], a[216:219], v[24:27]
    v_mfma_f32_16x16x32_bf16 v[40:43], a[200:203], a[216:219], v[40:43]
    ds_read_b128 a[156:159], v67 offset:16384
    v_mfma_f32_16x16x32_bf16 v[40:43], a[232:235], a[248:251], v[40:43]
    ds_read_b64_tr_b16 a[160:161], v80 offset:24576
    ds_read_b64_tr_b16 a[162:163], v80 offset:26624
    buffer_load_dwordx4 v118, s[12:15], s44 offen offset:3072 sc1 lds
    v_mfma_f32_16x16x32_bf16 v[56:59], a[236:239], a[248:251], v[56:59]
    ds_read_b128 a[176:179], v64 offset:24576
    v_mfma_f32_16x16x32_bf16 v[56:59], a[204:207], a[216:219], v[56:59]
    s_xor_b32 s44, s53, 106496
    s_add_u32 m0, s52, 147456
    v_mfma_f32_16x16x32_bf16 v[12:15], a[192:195], a[220:223], v[12:15]
    ds_read_b64_tr_b16 a[164:165], v81 offset:24576
    v_mfma_f32_16x16x32_bf16 v[12:15], a[224:227], a[252:255], v[12:15]
    ds_read_b64_tr_b16 a[166:167], v81 offset:26624
    buffer_load_dwordx4 v120, s[32:35], s45 offen offset:0 lds
    v_mfma_f32_16x16x32_bf16 v[28:31], a[228:231], a[252:255], v[28:31]
    ds_read_b128 a[180:183], v65 offset:24576
    v_mfma_f32_16x16x32_bf16 v[28:31], a[196:199], a[220:223], v[28:31]
    v_mfma_f32_16x16x32_bf16 v[44:47], a[200:203], a[220:223], v[44:47]
    ds_read_b64_tr_b16 a[168:169], v82 offset:24576
    ds_read_b64_tr_b16 a[170:171], v82 offset:26624
    v_mfma_f32_16x16x32_bf16 v[44:47], a[232:235], a[252:255], v[44:47]
    ds_read_b128 a[184:187], v66 offset:24576
    buffer_load_dwordx4 v121, s[32:35], s45 offen offset:1024 lds
    v_mfma_f32_16x16x32_bf16 v[60:63], a[236:239], a[252:255], v[60:63]
    ds_read_b64_tr_b16 a[172:173], v83 offset:24576
    v_mfma_f32_16x16x32_bf16 v[60:63], a[204:207], a[220:223], v[60:63]
    v_mfma_f32_16x16x32_bf16 v[0:3], a[192:195], a[208:211], v[0:3]
    ds_read_b64_tr_b16 a[174:175], v83 offset:26624
    v_mfma_f32_16x16x32_bf16 v[0:3], a[224:227], a[240:243], v[0:3]
    ds_read_b128 a[188:191], v67 offset:24576
    buffer_load_dwordx4 v122, s[32:35], s45 offen offset:2048 lds
    v_mfma_f32_16x16x32_bf16 v[16:19], a[228:231], a[240:243], v[16:19]
    v_mfma_f32_16x16x32_bf16 v[16:19], a[196:199], a[208:211], v[16:19]
    v_mfma_f32_16x16x32_bf16 v[32:35], a[200:203], a[208:211], v[32:35]
    v_mfma_f32_16x16x32_bf16 v[32:35], a[232:235], a[240:243], v[32:35]
    buffer_load_dwordx4 v123, s[32:35], s45 offen offset:3072 lds
    v_mfma_f32_16x16x32_bf16 v[48:51], a[236:239], a[240:243], v[48:51]
    s_xor_b32 s45, s48, 851968
    v_mfma_f32_16x16x32_bf16 v[48:51], a[204:207], a[208:211], v[48:51]
    s_waitcnt vmcnt(26) lgkmcnt(0)
    s_barrier
    v_mfma_f32_16x16x32_bf16 v[4:7], a[128:131], a[148:151], v[4:7]
    ds_read_b64_tr_b16 a[192:193], v76 offset:49152
    ds_read_b64_tr_b16 a[194:195], v76 offset:51200
    v_mfma_f32_16x16x32_bf16 v[4:7], a[160:163], a[180:183], v[4:7]
    ds_read_b128 a[208:211], v64 offset:32768
    s_add_u32 m0, s52, 16384
    v_mfma_f32_16x16x32_bf16 v[20:23], a[164:167], a[180:183], v[20:23]
    ds_read_b64_tr_b16 a[196:197], v77 offset:49152
    v_mfma_f32_16x16x32_bf16 v[20:23], a[132:135], a[148:151], v[20:23]
    buffer_load_dwordx4 v118, s[12:15], s44 offen offset:0 sc1 lds
    v_mfma_f32_16x16x32_bf16 v[36:39], a[136:139], a[148:151], v[36:39]
    ds_read_b64_tr_b16 a[198:199], v77 offset:51200
    v_mfma_f32_16x16x32_bf16 v[36:39], a[168:171], a[180:183], v[36:39]
    ds_read_b128 a[212:215], v65 offset:32768
    buffer_load_dwordx4 v118, s[12:15], s44 offen offset:1024 sc1 lds
    v_mfma_f32_16x16x32_bf16 v[52:55], a[172:175], a[180:183], v[52:55]
    ds_read_b64_tr_b16 a[200:201], v78 offset:49152
    ds_read_b64_tr_b16 a[202:203], v78 offset:51200
    v_mfma_f32_16x16x32_bf16 v[52:55], a[140:143], a[148:151], v[52:55]
    v_mfma_f32_16x16x32_bf16 v[8:11], a[128:131], a[152:155], v[8:11]
    ds_read_b128 a[216:219], v66 offset:32768
    v_mfma_f32_16x16x32_bf16 v[8:11], a[160:163], a[184:187], v[8:11]
    ds_read_b64_tr_b16 a[204:205], v79 offset:49152
    buffer_load_dwordx4 v118, s[12:15], s44 offen offset:2048 sc1 lds
    v_mfma_f32_16x16x32_bf16 v[24:27], a[164:167], a[184:187], v[24:27]
    ds_read_b64_tr_b16 a[206:207], v79 offset:51200
    v_mfma_f32_16x16x32_bf16 v[24:27], a[132:135], a[152:155], v[24:27]
    v_mfma_f32_16x16x32_bf16 v[40:43], a[136:139], a[152:155], v[40:43]
    ds_read_b128 a[220:223], v67 offset:32768
    v_mfma_f32_16x16x32_bf16 v[40:43], a[168:171], a[184:187], v[40:43]
    ds_read_b64_tr_b16 a[224:225], v76 offset:57344
    ds_read_b64_tr_b16 a[226:227], v76 offset:59392
    buffer_load_dwordx4 v118, s[12:15], s44 offen offset:3072 sc1 lds
    v_mfma_f32_16x16x32_bf16 v[56:59], a[172:175], a[184:187], v[56:59]
    ds_read_b128 a[240:243], v64 offset:40960
    v_mfma_f32_16x16x32_bf16 v[56:59], a[140:143], a[152:155], v[56:59]
    s_xor_b32 s44, s53, 114688
    s_add_u32 m0, s52, 81920
    v_mfma_f32_16x16x32_bf16 v[12:15], a[128:131], a[156:159], v[12:15]
    ds_read_b64_tr_b16 a[228:229], v77 offset:57344
    v_mfma_f32_16x16x32_bf16 v[12:15], a[160:163], a[188:191], v[12:15]
    ds_read_b64_tr_b16 a[230:231], v77 offset:59392
    buffer_load_dwordx4 v120, s[32:35], s45 offen offset:0 lds
    v_mfma_f32_16x16x32_bf16 v[28:31], a[164:167], a[188:191], v[28:31]
    ds_read_b128 a[244:247], v65 offset:40960
    v_mfma_f32_16x16x32_bf16 v[28:31], a[132:135], a[156:159], v[28:31]
    v_mfma_f32_16x16x32_bf16 v[44:47], a[136:139], a[156:159], v[44:47]
    ds_read_b64_tr_b16 a[232:233], v78 offset:57344
    ds_read_b64_tr_b16 a[234:235], v78 offset:59392
    v_mfma_f32_16x16x32_bf16 v[44:47], a[168:171], a[188:191], v[44:47]
    ds_read_b128 a[248:251], v66 offset:40960
    buffer_load_dwordx4 v121, s[32:35], s45 offen offset:1024 lds
    v_mfma_f32_16x16x32_bf16 v[60:63], a[172:175], a[188:191], v[60:63]
    ds_read_b64_tr_b16 a[236:237], v79 offset:57344
    v_mfma_f32_16x16x32_bf16 v[60:63], a[140:143], a[156:159], v[60:63]
    v_mfma_f32_16x16x32_bf16 v[0:3], a[128:131], a[144:147], v[0:3]
    ds_read_b64_tr_b16 a[238:239], v79 offset:59392
    v_mfma_f32_16x16x32_bf16 v[0:3], a[160:163], a[176:179], v[0:3]
    ds_read_b128 a[252:255], v67 offset:40960
    buffer_load_dwordx4 v122, s[32:35], s45 offen offset:2048 lds
    v_mfma_f32_16x16x32_bf16 v[16:19], a[164:167], a[176:179], v[16:19]
    v_mfma_f32_16x16x32_bf16 v[16:19], a[132:135], a[144:147], v[16:19]
    v_mfma_f32_16x16x32_bf16 v[32:35], a[136:139], a[144:147], v[32:35]
    v_mfma_f32_16x16x32_bf16 v[32:35], a[168:171], a[176:179], v[32:35]
    buffer_load_dwordx4 v123, s[32:35], s45 offen offset:3072 lds
    v_mfma_f32_16x16x32_bf16 v[48:51], a[172:175], a[176:179], v[48:51]
    s_xor_b32 s45, s48, 917504
    v_mfma_f32_16x16x32_bf16 v[48:51], a[140:143], a[144:147], v[48:51]
    s_waitcnt vmcnt(24) lgkmcnt(0)
    s_barrier
    v_mfma_f32_16x16x32_bf16 v[4:7], a[192:195], a[212:215], v[4:7]
    ds_read_b64_tr_b16 a[128:129], v80 offset:49152
    ds_read_b64_tr_b16 a[130:131], v80 offset:51200
    v_mfma_f32_16x16x32_bf16 v[4:7], a[224:227], a[244:247], v[4:7]
    ds_read_b128 a[144:147], v68 offset:32768
    s_add_u32 m0, s52, 32768
    v_mfma_f32_16x16x32_bf16 v[20:23], a[228:231], a[244:247], v[20:23]
    ds_read_b64_tr_b16 a[132:133], v81 offset:49152
    v_mfma_f32_16x16x32_bf16 v[20:23], a[196:199], a[212:215], v[20:23]
    buffer_load_dwordx4 v118, s[12:15], s44 offen offset:0 sc1 lds
    v_mfma_f32_16x16x32_bf16 v[36:39], a[200:203], a[212:215], v[36:39]
    ds_read_b64_tr_b16 a[134:135], v81 offset:51200
    v_mfma_f32_16x16x32_bf16 v[36:39], a[232:235], a[244:247], v[36:39]
    ds_read_b128 a[148:151], v69 offset:32768
    buffer_load_dwordx4 v118, s[12:15], s44 offen offset:1024 sc1 lds
    v_mfma_f32_16x16x32_bf16 v[52:55], a[236:239], a[244:247], v[52:55]
    ds_read_b64_tr_b16 a[136:137], v82 offset:49152
    ds_read_b64_tr_b16 a[138:139], v82 offset:51200
    v_mfma_f32_16x16x32_bf16 v[52:55], a[204:207], a[212:215], v[52:55]
    v_mfma_f32_16x16x32_bf16 v[8:11], a[192:195], a[216:219], v[8:11]
    ds_read_b128 a[152:155], v70 offset:32768
    v_mfma_f32_16x16x32_bf16 v[8:11], a[224:227], a[248:251], v[8:11]
    ds_read_b64_tr_b16 a[140:141], v83 offset:49152
    buffer_load_dwordx4 v118, s[12:15], s44 offen offset:2048 sc1 lds
    v_mfma_f32_16x16x32_bf16 v[24:27], a[228:231], a[248:251], v[24:27]
    ds_read_b64_tr_b16 a[142:143], v83 offset:51200
    v_mfma_f32_16x16x32_bf16 v[24:27], a[196:199], a[216:219], v[24:27]
    v_mfma_f32_16x16x32_bf16 v[40:43], a[200:203], a[216:219], v[40:43]
    ds_read_b128 a[156:159], v71 offset:32768
    v_mfma_f32_16x16x32_bf16 v[40:43], a[232:235], a[248:251], v[40:43]
    ds_read_b64_tr_b16 a[160:161], v80 offset:57344
    ds_read_b64_tr_b16 a[162:163], v80 offset:59392
    buffer_load_dwordx4 v118, s[12:15], s44 offen offset:3072 sc1 lds
    v_mfma_f32_16x16x32_bf16 v[56:59], a[236:239], a[248:251], v[56:59]
    ds_read_b128 a[176:179], v68 offset:40960
    v_mfma_f32_16x16x32_bf16 v[56:59], a[204:207], a[216:219], v[56:59]
    s_xor_b32 s44, s53, 122880
    s_add_u32 m0, s52, 49152
    v_mfma_f32_16x16x32_bf16 v[12:15], a[192:195], a[220:223], v[12:15]
    ds_read_b64_tr_b16 a[164:165], v81 offset:57344
    v_mfma_f32_16x16x32_bf16 v[12:15], a[224:227], a[252:255], v[12:15]
    ds_read_b64_tr_b16 a[166:167], v81 offset:59392
    buffer_load_dwordx4 v120, s[32:35], s45 offen offset:0 lds
    v_mfma_f32_16x16x32_bf16 v[28:31], a[228:231], a[252:255], v[28:31]
    ds_read_b128 a[180:183], v69 offset:40960
    v_mfma_f32_16x16x32_bf16 v[28:31], a[196:199], a[220:223], v[28:31]
    v_mfma_f32_16x16x32_bf16 v[44:47], a[200:203], a[220:223], v[44:47]
    ds_read_b64_tr_b16 a[168:169], v82 offset:57344
    ds_read_b64_tr_b16 a[170:171], v82 offset:59392
    v_mfma_f32_16x16x32_bf16 v[44:47], a[232:235], a[252:255], v[44:47]
    ds_read_b128 a[184:187], v70 offset:40960
    buffer_load_dwordx4 v121, s[32:35], s45 offen offset:1024 lds
    v_mfma_f32_16x16x32_bf16 v[60:63], a[236:239], a[252:255], v[60:63]
    ds_read_b64_tr_b16 a[172:173], v83 offset:57344
    v_mfma_f32_16x16x32_bf16 v[60:63], a[204:207], a[220:223], v[60:63]
    v_mfma_f32_16x16x32_bf16 v[0:3], a[192:195], a[208:211], v[0:3]
    ds_read_b64_tr_b16 a[174:175], v83 offset:59392
    v_mfma_f32_16x16x32_bf16 v[0:3], a[224:227], a[240:243], v[0:3]
    ds_read_b128 a[188:191], v71 offset:40960
    buffer_load_dwordx4 v122, s[32:35], s45 offen offset:2048 lds
    v_mfma_f32_16x16x32_bf16 v[16:19], a[228:231], a[240:243], v[16:19]
    v_mfma_f32_16x16x32_bf16 v[16:19], a[196:199], a[208:211], v[16:19]
    v_mfma_f32_16x16x32_bf16 v[32:35], a[200:203], a[208:211], v[32:35]
    v_mfma_f32_16x16x32_bf16 v[32:35], a[232:235], a[240:243], v[32:35]
    buffer_load_dwordx4 v123, s[32:35], s45 offen offset:3072 lds
    v_mfma_f32_16x16x32_bf16 v[48:51], a[236:239], a[240:243], v[48:51]
    s_xor_b32 s45, s48, 983040
    v_mfma_f32_16x16x32_bf16 v[48:51], a[204:207], a[208:211], v[48:51]
    s_waitcnt vmcnt(24) lgkmcnt(0)
    s_barrier
    v_mfma_f32_16x16x32_bf16 v[4:7], a[128:131], a[148:151], v[4:7]
    ds_read_b64_tr_b16 a[192:193], v84 offset:0
    ds_read_b64_tr_b16 a[194:195], v84 offset:2048
    v_mfma_f32_16x16x32_bf16 v[4:7], a[160:163], a[180:183], v[4:7]
    ds_read_b128 a[208:211], v64 offset:0
    s_add_u32 m0, s52, 98304
    v_mfma_f32_16x16x32_bf16 v[20:23], a[164:167], a[180:183], v[20:23]
    ds_read_b64_tr_b16 a[196:197], v85 offset:0
    v_mfma_f32_16x16x32_bf16 v[20:23], a[132:135], a[148:151], v[20:23]
    buffer_load_dwordx4 v118, s[12:15], s44 offen offset:0 sc1 lds
    v_mfma_f32_16x16x32_bf16 v[36:39], a[136:139], a[148:151], v[36:39]
    ds_read_b64_tr_b16 a[198:199], v85 offset:2048
    v_mfma_f32_16x16x32_bf16 v[36:39], a[168:171], a[180:183], v[36:39]
    ds_read_b128 a[212:215], v65 offset:0
    buffer_load_dwordx4 v118, s[12:15], s44 offen offset:1024 sc1 lds
    v_mfma_f32_16x16x32_bf16 v[52:55], a[172:175], a[180:183], v[52:55]
    ds_read_b64_tr_b16 a[200:201], v86 offset:0
    ds_read_b64_tr_b16 a[202:203], v86 offset:2048
    v_mfma_f32_16x16x32_bf16 v[52:55], a[140:143], a[148:151], v[52:55]
    v_mfma_f32_16x16x32_bf16 v[8:11], a[128:131], a[152:155], v[8:11]
    ds_read_b128 a[216:219], v66 offset:0
    v_mfma_f32_16x16x32_bf16 v[8:11], a[160:163], a[184:187], v[8:11]
    ds_read_b64_tr_b16 a[204:205], v87 offset:0
    buffer_load_dwordx4 v118, s[12:15], s44 offen offset:2048 sc1 lds
    v_mfma_f32_16x16x32_bf16 v[24:27], a[164:167], a[184:187], v[24:27]
    ds_read_b64_tr_b16 a[206:207], v87 offset:2048
    v_mfma_f32_16x16x32_bf16 v[24:27], a[132:135], a[152:155], v[24:27]
    v_mfma_f32_16x16x32_bf16 v[40:43], a[136:139], a[152:155], v[40:43]
    ds_read_b128 a[220:223], v67 offset:0
    v_mfma_f32_16x16x32_bf16 v[40:43], a[168:171], a[184:187], v[40:43]
    ds_read_b64_tr_b16 a[224:225], v84 offset:8192
    ds_read_b64_tr_b16 a[226:227], v84 offset:10240
    buffer_load_dwordx4 v118, s[12:15], s44 offen offset:3072 sc1 lds
    v_mfma_f32_16x16x32_bf16 v[56:59], a[172:175], a[184:187], v[56:59]
    ds_read_b128 a[240:243], v64 offset:8192
    s_xor_b32 s44, s53, 131072
    s_add_u32 m0, s52, 114688
    v_mfma_f32_16x16x32_bf16 v[56:59], a[140:143], a[152:155], v[56:59]
    buffer_load_dwordx4 v120, s[32:35], s45 offen offset:0 lds
    v_mfma_f32_16x16x32_bf16 v[12:15], a[128:131], a[156:159], v[12:15]
    ds_read_b64_tr_b16 a[228:229], v85 offset:8192
    v_mfma_f32_16x16x32_bf16 v[12:15], a[160:163], a[188:191], v[12:15]
    ds_read_b64_tr_b16 a[230:231], v85 offset:10240
    v_mfma_f32_16x16x32_bf16 v[28:31], a[164:167], a[188:191], v[28:31]
    ds_read_b128 a[244:247], v65 offset:8192
    v_mfma_f32_16x16x32_bf16 v[28:31], a[132:135], a[156:159], v[28:31]
    buffer_load_dwordx4 v121, s[32:35], s45 offen offset:1024 lds
    v_mfma_f32_16x16x32_bf16 v[44:47], a[136:139], a[156:159], v[44:47]
    ds_read_b64_tr_b16 a[232:233], v86 offset:8192
    ds_read_b64_tr_b16 a[234:235], v86 offset:10240
    v_mfma_f32_16x16x32_bf16 v[44:47], a[168:171], a[188:191], v[44:47]
    ds_read_b128 a[248:251], v66 offset:8192
    v_mfma_f32_16x16x32_bf16 v[60:63], a[172:175], a[188:191], v[60:63]
    ds_read_b64_tr_b16 a[236:237], v87 offset:8192
    v_mfma_f32_16x16x32_bf16 v[60:63], a[140:143], a[156:159], v[60:63]
    buffer_load_dwordx4 v122, s[32:35], s45 offen offset:2048 lds
    v_mfma_f32_16x16x32_bf16 v[0:3], a[128:131], a[144:147], v[0:3]
    ds_read_b64_tr_b16 a[238:239], v87 offset:10240
    v_mfma_f32_16x16x32_bf16 v[0:3], a[160:163], a[176:179], v[0:3]
    ds_read_b128 a[252:255], v67 offset:8192
    buffer_load_dwordx4 v123, s[32:35], s45 offen offset:3072 lds
    v_mfma_f32_16x16x32_bf16 v[16:19], a[164:167], a[176:179], v[16:19]
    v_mfma_f32_16x16x32_bf16 v[16:19], a[132:135], a[144:147], v[16:19]
    s_xor_b32 s45, s48, 1048576
    v_mfma_f32_16x16x32_bf16 v[32:35], a[136:139], a[144:147], v[32:35]
    v_mfma_f32_16x16x32_bf16 v[32:35], a[168:171], a[176:179], v[32:35]
    buffer_load_dword v115, v114, s[88:91], 0 offen offset:8 sc1
    v_mfma_f32_16x16x32_bf16 v[48:51], a[172:175], a[176:179], v[48:51]
    v_mfma_f32_16x16x32_bf16 v[48:51], a[140:143], a[144:147], v[48:51]
    s_waitcnt vmcnt(25) lgkmcnt(0)
    s_barrier
    v_mfma_f32_16x16x32_bf16 v[4:7], a[192:195], a[212:215], v[4:7]
    ds_read_b64_tr_b16 a[0:1], v84 offset:16384
    ds_read_b64_tr_b16 a[2:3], v84 offset:18432
    v_mfma_f32_16x16x32_bf16 v[4:7], a[224:227], a[244:247], v[4:7]
    ds_read_b128 a[16:19], v68 offset:0
    v_mfma_f32_16x16x32_bf16 v[20:23], a[228:231], a[244:247], v[20:23]
    ds_read_b64_tr_b16 a[4:5], v85 offset:16384
    v_mfma_f32_16x16x32_bf16 v[20:23], a[196:199], a[212:215], v[20:23]
    v_mfma_f32_16x16x32_bf16 v[36:39], a[200:203], a[212:215], v[36:39]
    ds_read_b64_tr_b16 a[6:7], v85 offset:18432
    v_mfma_f32_16x16x32_bf16 v[36:39], a[232:235], a[244:247], v[36:39]
    ds_read_b128 a[20:23], v69 offset:0
    v_mfma_f32_16x16x32_bf16 v[52:55], a[236:239], a[244:247], v[52:55]
    ds_read_b64_tr_b16 a[8:9], v86 offset:16384
    ds_read_b64_tr_b16 a[10:11], v86 offset:18432
    v_mfma_f32_16x16x32_bf16 v[52:55], a[204:207], a[212:215], v[52:55]
    v_mfma_f32_16x16x32_bf16 v[8:11], a[192:195], a[216:219], v[8:11]
    ds_read_b128 a[24:27], v70 offset:0
    v_mfma_f32_16x16x32_bf16 v[8:11], a[224:227], a[248:251], v[8:11]
    ds_read_b64_tr_b16 a[12:13], v87 offset:16384
    v_mfma_f32_16x16x32_bf16 v[24:27], a[228:231], a[248:251], v[24:27]
    ds_read_b64_tr_b16 a[14:15], v87 offset:18432
    v_mfma_f32_16x16x32_bf16 v[24:27], a[196:199], a[216:219], v[24:27]
    v_mfma_f32_16x16x32_bf16 v[40:43], a[200:203], a[216:219], v[40:43]
    ds_read_b128 a[28:31], v71 offset:0
    v_mfma_f32_16x16x32_bf16 v[40:43], a[232:235], a[248:251], v[40:43]
    ds_read_b64_tr_b16 a[32:33], v84 offset:24576
    ds_read_b64_tr_b16 a[34:35], v84 offset:26624
    v_mfma_f32_16x16x32_bf16 v[56:59], a[236:239], a[248:251], v[56:59]
    ds_read_b128 a[48:51], v68 offset:8192
    v_mfma_f32_16x16x32_bf16 v[56:59], a[204:207], a[216:219], v[56:59]
    v_mfma_f32_16x16x32_bf16 v[12:15], a[192:195], a[220:223], v[12:15]
    ds_read_b64_tr_b16 a[36:37], v85 offset:24576
    v_mfma_f32_16x16x32_bf16 v[12:15], a[224:227], a[252:255], v[12:15]
    ds_read_b64_tr_b16 a[38:39], v85 offset:26624
    v_mfma_f32_16x16x32_bf16 v[28:31], a[228:231], a[252:255], v[28:31]
    ds_read_b128 a[52:55], v69 offset:8192
    v_mfma_f32_16x16x32_bf16 v[28:31], a[196:199], a[220:223], v[28:31]
    v_mfma_f32_16x16x32_bf16 v[44:47], a[200:203], a[220:223], v[44:47]
    ds_read_b64_tr_b16 a[40:41], v86 offset:24576
    ds_read_b64_tr_b16 a[42:43], v86 offset:26624
    v_mfma_f32_16x16x32_bf16 v[44:47], a[232:235], a[252:255], v[44:47]
    ds_read_b128 a[56:59], v70 offset:8192
    v_mfma_f32_16x16x32_bf16 v[60:63], a[236:239], a[252:255], v[60:63]
    ds_read_b64_tr_b16 a[44:45], v87 offset:24576
    v_mfma_f32_16x16x32_bf16 v[60:63], a[204:207], a[220:223], v[60:63]
    v_mfma_f32_16x16x32_bf16 v[0:3], a[192:195], a[208:211], v[0:3]
    ds_read_b64_tr_b16 a[46:47], v87 offset:26624
    v_mfma_f32_16x16x32_bf16 v[0:3], a[224:227], a[240:243], v[0:3]
    ds_read_b128 a[60:63], v71 offset:8192
    v_mfma_f32_16x16x32_bf16 v[16:19], a[228:231], a[240:243], v[16:19]
    v_mfma_f32_16x16x32_bf16 v[16:19], a[196:199], a[208:211], v[16:19]
    v_mfma_f32_16x16x32_bf16 v[32:35], a[200:203], a[208:211], v[32:35]
    v_mfma_f32_16x16x32_bf16 v[32:35], a[232:235], a[240:243], v[32:35]
    v_mfma_f32_16x16x32_bf16 v[48:51], a[236:239], a[240:243], v[48:51]
    v_mfma_f32_16x16x32_bf16 v[48:51], a[204:207], a[208:211], v[48:51]
    s_waitcnt vmcnt(17) lgkmcnt(0)
    s_barrier
    v_mfma_f32_16x16x32_bf16 v[4:7], a[0:3], a[20:23], v[4:7]
    ds_read_b64_tr_b16 a[64:65], v80 offset:16384
    ds_read_b64_tr_b16 a[66:67], v80 offset:18432
    ds_read_b128 a[80:83], v64 offset:16384
    v_mfma_f32_16x16x32_bf16 v[4:7], a[32:35], a[52:55], v[4:7]
    v_mfma_f32_16x16x32_bf16 v[20:23], a[36:39], a[52:55], v[20:23]
    ds_read_b64_tr_b16 a[68:69], v81 offset:16384
    ds_read_b64_tr_b16 a[70:71], v81 offset:18432
    ds_read_b128 a[84:87], v65 offset:16384
    v_mfma_f32_16x16x32_bf16 v[20:23], a[4:7], a[20:23], v[20:23]
    buffer_load_dwordx2 v[100:101], v112, s[16:19], s76 offen offset:0
    v_mfma_f32_16x16x32_bf16 v[36:39], a[8:11], a[20:23], v[36:39]
    ds_read_b64_tr_b16 a[72:73], v82 offset:16384
    ds_read_b64_tr_b16 a[74:75], v82 offset:18432
    ds_read_b128 a[88:91], v66 offset:16384
    v_mfma_f32_16x16x32_bf16 v[36:39], a[40:43], a[52:55], v[36:39]
    v_mfma_f32_16x16x32_bf16 v[52:55], a[44:47], a[52:55], v[52:55]
    ds_read_b64_tr_b16 a[76:77], v83 offset:16384
    ds_read_b64_tr_b16 a[78:79], v83 offset:18432
    ds_read_b128 a[92:95], v67 offset:16384
    v_mfma_f32_16x16x32_bf16 v[52:55], a[12:15], a[20:23], v[52:55]
    buffer_load_dwordx2 v[102:103], v112, s[16:19], s76 offen offset:32
    v_mfma_f32_16x16x32_bf16 v[8:11], a[0:3], a[24:27], v[8:11]
    ds_read_b64_tr_b16 a[96:97], v80 offset:24576
    ds_read_b64_tr_b16 a[98:99], v80 offset:26624
    ds_read_b128 a[112:115], v64 offset:24576
    v_mfma_f32_16x16x32_bf16 v[8:11], a[32:35], a[56:59], v[8:11]
    v_mfma_f32_16x16x32_bf16 v[24:27], a[36:39], a[56:59], v[24:27]
    ds_read_b64_tr_b16 a[100:101], v81 offset:24576
    ds_read_b64_tr_b16 a[102:103], v81 offset:26624
    ds_read_b128 a[116:119], v65 offset:24576
    v_mfma_f32_16x16x32_bf16 v[24:27], a[4:7], a[24:27], v[24:27]
    v_mfma_f32_16x16x32_bf16 v[40:43], a[8:11], a[24:27], v[40:43]
    ds_read_b64_tr_b16 a[104:105], v82 offset:24576
    ds_read_b64_tr_b16 a[106:107], v82 offset:26624
    ds_read_b128 a[120:123], v66 offset:24576
    v_mfma_f32_16x16x32_bf16 v[40:43], a[40:43], a[56:59], v[40:43]
    buffer_load_dwordx2 v[104:105], v112, s[16:19], s76 offen offset:64
    v_mfma_f32_16x16x32_bf16 v[56:59], a[44:47], a[56:59], v[56:59]
    ds_read_b64_tr_b16 a[108:109], v83 offset:24576
    ds_read_b64_tr_b16 a[110:111], v83 offset:26624
    ds_read_b128 a[124:127], v67 offset:24576
    v_mfma_f32_16x16x32_bf16 v[56:59], a[12:15], a[24:27], v[56:59]
    v_mfma_f32_16x16x32_bf16 v[12:15], a[0:3], a[28:31], v[12:15]
    v_mfma_f32_16x16x32_bf16 v[12:15], a[32:35], a[60:63], v[12:15]
    v_mfma_f32_16x16x32_bf16 v[28:31], a[36:39], a[60:63], v[28:31]
    v_mfma_f32_16x16x32_bf16 v[28:31], a[4:7], a[28:31], v[28:31]
    buffer_load_dwordx2 v[106:107], v112, s[16:19], s76 offen offset:96
    v_mfma_f32_16x16x32_bf16 v[44:47], a[8:11], a[28:31], v[44:47]
    v_mfma_f32_16x16x32_bf16 v[44:47], a[40:43], a[60:63], v[44:47]
    v_mfma_f32_16x16x32_bf16 v[60:63], a[44:47], a[60:63], v[60:63]
    v_mfma_f32_16x16x32_bf16 v[60:63], a[12:15], a[28:31], v[60:63]
    s_waitcnt vmcnt(4) lgkmcnt(0)
    s_barrier
    v_cmp_ne_u32 vcc, s62, v115
    s_mov_b32 s54, 0
    s_cbranch_vccnz P2_PFPOLL
P2_PFOK:
    v_mfma_f32_16x16x32_bf16 v[4:7], a[64:67], a[84:87], v[4:7]
    ds_read_b64_tr_b16 a[128:129], v76 offset:49152
    ds_read_b64_tr_b16 a[130:131], v76 offset:51200
    ds_read_b128 a[144:147], v64 offset:32768
    v_mfma_f32_16x16x32_bf16 v[4:7], a[96:99], a[116:119], v[4:7]
    v_mfma_f32_16x16x32_bf16 v[20:23], a[100:103], a[116:119], v[20:23]
    ds_read_b64_tr_b16 a[132:133], v77 offset:49152
    ds_read_b64_tr_b16 a[134:135], v77 offset:51200
    ds_read_b128 a[148:151], v65 offset:32768
    v_mfma_f32_16x16x32_bf16 v[20:23], a[68:71], a[84:87], v[20:23]
    buffer_load_dwordx4 v[216:219], v118, s[88:91], s49 offen offset:2048 sc1
    v_mfma_f32_16x16x32_bf16 v[36:39], a[72:75], a[84:87], v[36:39]
    ds_read_b64_tr_b16 a[136:137], v78 offset:49152
    ds_read_b64_tr_b16 a[138:139], v78 offset:51200
    ds_read_b128 a[152:155], v66 offset:32768
    v_mfma_f32_16x16x32_bf16 v[36:39], a[104:107], a[116:119], v[36:39]
    buffer_load_dwordx4 v[220:223], v118, s[88:91], s49 offen offset:3072 sc1
    v_mfma_f32_16x16x32_bf16 v[52:55], a[108:111], a[116:119], v[52:55]
    ds_read_b64_tr_b16 a[140:141], v79 offset:49152
    ds_read_b64_tr_b16 a[142:143], v79 offset:51200
    ds_read_b128 a[156:159], v67 offset:32768
    v_mfma_f32_16x16x32_bf16 v[52:55], a[76:79], a[84:87], v[52:55]
    v_mfma_f32_16x16x32_bf16 v[8:11], a[64:67], a[88:91], v[8:11]
    ds_read_b64_tr_b16 a[160:161], v76 offset:57344
    ds_read_b64_tr_b16 a[162:163], v76 offset:59392
    ds_read_b128 a[176:179], v64 offset:40960
    v_mfma_f32_16x16x32_bf16 v[8:11], a[96:99], a[120:123], v[8:11]
    buffer_load_dwordx4 v[224:227], v118, s[88:91], s50 offen offset:2048 sc1
    v_mfma_f32_16x16x32_bf16 v[24:27], a[100:103], a[120:123], v[24:27]
    ds_read_b64_tr_b16 a[164:165], v77 offset:57344
    ds_read_b64_tr_b16 a[166:167], v77 offset:59392
    ds_read_b128 a[180:183], v65 offset:40960
    v_mfma_f32_16x16x32_bf16 v[24:27], a[68:71], a[88:91], v[24:27]
    v_mfma_f32_16x16x32_bf16 v[40:43], a[72:75], a[88:91], v[40:43]
    ds_read_b64_tr_b16 a[168:169], v78 offset:57344
    ds_read_b64_tr_b16 a[170:171], v78 offset:59392
    ds_read_b128 a[184:187], v66 offset:40960
    v_mfma_f32_16x16x32_bf16 v[40:43], a[104:107], a[120:123], v[40:43]
    buffer_load_dwordx4 v[228:231], v118, s[88:91], s50 offen offset:3072 sc1
    v_mfma_f32_16x16x32_bf16 v[56:59], a[108:111], a[120:123], v[56:59]
    ds_read_b64_tr_b16 a[172:173], v79 offset:57344
    ds_read_b64_tr_b16 a[174:175], v79 offset:59392
    ds_read_b128 a[188:191], v67 offset:40960
    v_mfma_f32_16x16x32_bf16 v[56:59], a[76:79], a[88:91], v[56:59]
    v_mfma_f32_16x16x32_bf16 v[12:15], a[64:67], a[92:95], v[12:15]
    v_mfma_f32_16x16x32_bf16 v[12:15], a[96:99], a[124:127], v[12:15]
    buffer_load_dwordx4 v[232:235], v118, s[88:91], s51 offen offset:2048 sc1
    v_mfma_f32_16x16x32_bf16 v[28:31], a[100:103], a[124:127], v[28:31]
    v_mfma_f32_16x16x32_bf16 v[28:31], a[68:71], a[92:95], v[28:31]
    v_mfma_f32_16x16x32_bf16 v[44:47], a[72:75], a[92:95], v[44:47]
    v_mfma_f32_16x16x32_bf16 v[44:47], a[104:107], a[124:127], v[44:47]
    buffer_load_dwordx4 v[236:239], v118, s[88:91], s51 offen offset:3072 sc1
    v_mfma_f32_16x16x32_bf16 v[60:63], a[108:111], a[124:127], v[60:63]
    v_mfma_f32_16x16x32_bf16 v[60:63], a[76:79], a[92:95], v[60:63]
    s_waitcnt vmcnt(11) lgkmcnt(0)
    s_barrier
    v_mfma_f32_16x16x32_bf16 v[4:7], a[128:131], a[148:151], v[4:7]
    ds_read_b64_tr_b16 a[192:193], v80 offset:49152
    ds_read_b64_tr_b16 a[194:195], v80 offset:51200
    ds_read_b128 a[208:211], v68 offset:32768
    v_mfma_f32_16x16x32_bf16 v[4:7], a[160:163], a[180:183], v[4:7]
    v_mfma_f32_16x16x32_bf16 v[20:23], a[164:167], a[180:183], v[20:23]
    ds_read_b64_tr_b16 a[196:197], v81 offset:49152
    ds_read_b64_tr_b16 a[198:199], v81 offset:51200
    ds_read_b128 a[212:215], v69 offset:32768
    v_mfma_f32_16x16x32_bf16 v[20:23], a[132:135], a[148:151], v[20:23]
    v_mfma_f32_16x16x32_bf16 v[36:39], a[136:139], a[148:151], v[36:39]
    ds_read_b64_tr_b16 a[200:201], v82 offset:49152
    ds_read_b64_tr_b16 a[202:203], v82 offset:51200
    ds_read_b128 a[216:219], v70 offset:32768
    v_mfma_f32_16x16x32_bf16 v[36:39], a[168:171], a[180:183], v[36:39]
    v_mfma_f32_16x16x32_bf16 v[52:55], a[172:175], a[180:183], v[52:55]
    ds_read_b64_tr_b16 a[204:205], v83 offset:49152
    ds_read_b64_tr_b16 a[206:207], v83 offset:51200
    ds_read_b128 a[220:223], v71 offset:32768
    v_mfma_f32_16x16x32_bf16 v[52:55], a[140:143], a[148:151], v[52:55]
    v_mfma_f32_16x16x32_bf16 v[8:11], a[128:131], a[152:155], v[8:11]
    ds_read_b64_tr_b16 a[224:225], v80 offset:57344
    ds_read_b64_tr_b16 a[226:227], v80 offset:59392
    ds_read_b128 a[240:243], v68 offset:40960
    v_mfma_f32_16x16x32_bf16 v[8:11], a[160:163], a[184:187], v[8:11]
    v_mfma_f32_16x16x32_bf16 v[24:27], a[164:167], a[184:187], v[24:27]
    ds_read_b64_tr_b16 a[228:229], v81 offset:57344
    ds_read_b64_tr_b16 a[230:231], v81 offset:59392
    ds_read_b128 a[244:247], v69 offset:40960
    v_mfma_f32_16x16x32_bf16 v[24:27], a[132:135], a[152:155], v[24:27]
    v_mfma_f32_16x16x32_bf16 v[40:43], a[136:139], a[152:155], v[40:43]
    ds_read_b64_tr_b16 a[232:233], v82 offset:57344
    ds_read_b64_tr_b16 a[234:235], v82 offset:59392
    ds_read_b128 a[248:251], v70 offset:40960
    v_mfma_f32_16x16x32_bf16 v[40:43], a[168:171], a[184:187], v[40:43]
    v_mfma_f32_16x16x32_bf16 v[56:59], a[172:175], a[184:187], v[56:59]
    ds_read_b64_tr_b16 a[236:237], v83 offset:57344
    ds_read_b64_tr_b16 a[238:239], v83 offset:59392
    ds_read_b128 a[252:255], v71 offset:40960
    v_mfma_f32_16x16x32_bf16 v[56:59], a[140:143], a[152:155], v[56:59]
    v_mfma_f32_16x16x32_bf16 v[12:15], a[128:131], a[156:159], v[12:15]
    v_mfma_f32_16x16x32_bf16 v[12:15], a[160:163], a[188:191], v[12:15]
    v_mfma_f32_16x16x32_bf16 v[28:31], a[164:167], a[188:191], v[28:31]
    v_mfma_f32_16x16x32_bf16 v[28:31], a[132:135], a[156:159], v[28:31]
    v_mfma_f32_16x16x32_bf16 v[44:47], a[136:139], a[156:159], v[44:47]
    v_mfma_f32_16x16x32_bf16 v[44:47], a[168:171], a[188:191], v[44:47]
    v_mfma_f32_16x16x32_bf16 v[60:63], a[172:175], a[188:191], v[60:63]
    v_mfma_f32_16x16x32_bf16 v[60:63], a[140:143], a[156:159], v[60:63]
    s_waitcnt lgkmcnt(0)
    v_mfma_f32_16x16x32_bf16 v[4:7], a[192:195], a[212:215], v[4:7]
    v_mfma_f32_16x16x32_bf16 v[4:7], a[224:227], a[244:247], v[4:7]
    v_mfma_f32_16x16x32_bf16 v[20:23], a[228:231], a[244:247], v[20:23]
    v_mfma_f32_16x16x32_bf16 v[20:23], a[196:199], a[212:215], v[20:23]
    v_mfma_f32_16x16x32_bf16 v[36:39], a[200:203], a[212:215], v[36:39]
    v_mfma_f32_16x16x32_bf16 v[36:39], a[232:235], a[244:247], v[36:39]
    v_mfma_f32_16x16x32_bf16 v[52:55], a[236:239], a[244:247], v[52:55]
    v_mfma_f32_16x16x32_bf16 v[52:55], a[204:207], a[212:215], v[52:55]
    v_mfma_f32_16x16x32_bf16 v[8:11], a[192:195], a[216:219], v[8:11]
    v_mfma_f32_16x16x32_bf16 v[8:11], a[224:227], a[248:251], v[8:11]
    v_mfma_f32_16x16x32_bf16 v[24:27], a[228:231], a[248:251], v[24:27]
    v_mfma_f32_16x16x32_bf16 v[24:27], a[196:199], a[216:219], v[24:27]
    v_mfma_f32_16x16x32_bf16 v[40:43], a[200:203], a[216:219], v[40:43]
    v_cvt_pk_bf16_f32 v192, v4, v5
    v_cvt_pk_bf16_f32 v193, v6, v7
    v_mfma_f32_16x16x32_bf16 v[40:43], a[232:235], a[248:251], v[40:43]
    v_cvt_pk_bf16_f32 v194, v20, v21
    v_cvt_pk_bf16_f32 v195, v22, v23
    v_mfma_f32_16x16x32_bf16 v[56:59], a[236:239], a[248:251], v[56:59]
    v_cvt_pk_bf16_f32 v196, v36, v37
    v_cvt_pk_bf16_f32 v197, v38, v39
    v_mfma_f32_16x16x32_bf16 v[56:59], a[204:207], a[216:219], v[56:59]
    v_cvt_pk_bf16_f32 v198, v52, v53
    v_cvt_pk_bf16_f32 v199, v54, v55
    v_mfma_f32_16x16x32_bf16 v[12:15], a[192:195], a[220:223], v[12:15]
    buffer_store_dwordx4 v[192:195], v118, s[88:91], s40 offen offset:0 sc1
    v_mfma_f32_16x16x32_bf16 v[12:15], a[224:227], a[252:255], v[12:15]
    buffer_store_dwordx4 v[196:199], v118, s[88:91], s40 offen offset:1024 sc1
    v_mfma_f32_16x16x32_bf16 v[28:31], a[228:231], a[252:255], v[28:31]
    v_mfma_f32_16x16x32_bf16 v[28:31], a[196:199], a[220:223], v[28:31]
    v_mfma_f32_16x16x32_bf16 v[44:47], a[200:203], a[220:223], v[44:47]
    v_cvt_pk_bf16_f32 v200, v8, v9
    v_cvt_pk_bf16_f32 v201, v10, v11
    v_mfma_f32_16x16x32_bf16 v[44:47], a[232:235], a[252:255], v[44:47]
    v_cvt_pk_bf16_f32 v202, v24, v25
    v_cvt_pk_bf16_f32 v203, v26, v27
    v_mfma_f32_16x16x32_bf16 v[60:63], a[236:239], a[252:255], v[60:63]
    v_cvt_pk_bf16_f32 v204, v40, v41
    v_cvt_pk_bf16_f32 v205, v42, v43
    v_mfma_f32_16x16x32_bf16 v[60:63], a[204:207], a[220:223], v[60:63]
    v_cvt_pk_bf16_f32 v206, v56, v57
    v_cvt_pk_bf16_f32 v207, v58, v59
    v_mfma_f32_16x16x32_bf16 v[0:3], a[0:3], a[16:19], v[0:3]
    buffer_store_dwordx4 v[200:203], v118, s[88:91], s41 offen offset:0 sc1
    v_mfma_f32_16x16x32_bf16 v[0:3], a[32:35], a[48:51], v[0:3]
    buffer_store_dwordx4 v[204:207], v118, s[88:91], s41 offen offset:1024 sc1
    v_mfma_f32_16x16x32_bf16 v[16:19], a[36:39], a[48:51], v[16:19]
    v_mfma_f32_16x16x32_bf16 v[16:19], a[4:7], a[16:19], v[16:19]
    v_mfma_f32_16x16x32_bf16 v[32:35], a[8:11], a[16:19], v[32:35]
    v_cvt_pk_bf16_f32 v208, v12, v13
    v_cvt_pk_bf16_f32 v209, v14, v15
    v_mfma_f32_16x16x32_bf16 v[32:35], a[40:43], a[48:51], v[32:35]
    v_cvt_pk_bf16_f32 v210, v28, v29
    v_cvt_pk_bf16_f32 v211, v30, v31
    v_mfma_f32_16x16x32_bf16 v[48:51], a[44:47], a[48:51], v[48:51]
    v_cvt_pk_bf16_f32 v212, v44, v45
    v_cvt_pk_bf16_f32 v213, v46, v47
    v_mfma_f32_16x16x32_bf16 v[48:51], a[12:15], a[16:19], v[48:51]
    v_cvt_pk_bf16_f32 v214, v60, v61
    v_cvt_pk_bf16_f32 v215, v62, v63
    v_mfma_f32_16x16x32_bf16 v[0:3], a[64:67], a[80:83], v[0:3]
    buffer_store_dwordx4 v[208:211], v118, s[88:91], s42 offen offset:0 sc1
    v_mfma_f32_16x16x32_bf16 v[0:3], a[96:99], a[112:115], v[0:3]
    buffer_store_dwordx4 v[212:215], v118, s[88:91], s42 offen offset:1024 sc1
    v_mfma_f32_16x16x32_bf16 v[16:19], a[100:103], a[112:115], v[16:19]
    v_mfma_f32_16x16x32_bf16 v[16:19], a[68:71], a[80:83], v[16:19]
    v_mfma_f32_16x16x32_bf16 v[32:35], a[72:75], a[80:83], v[32:35]
    v_mfma_f32_16x16x32_bf16 v[32:35], a[104:107], a[112:115], v[32:35]
    v_mfma_f32_16x16x32_bf16 v[48:51], a[108:111], a[112:115], v[48:51]
    v_mfma_f32_16x16x32_bf16 v[48:51], a[76:79], a[80:83], v[48:51]
    v_mfma_f32_16x16x32_bf16 v[0:3], a[128:131], a[144:147], v[0:3]
    v_mfma_f32_16x16x32_bf16 v[0:3], a[160:163], a[176:179], v[0:3]
    v_mfma_f32_16x16x32_bf16 v[16:19], a[164:167], a[176:179], v[16:19]
    v_mfma_f32_16x16x32_bf16 v[16:19], a[132:135], a[144:147], v[16:19]
    v_mfma_f32_16x16x32_bf16 v[32:35], a[136:139], a[144:147], v[32:35]
    v_mfma_f32_16x16x32_bf16 v[32:35], a[168:171], a[176:179], v[32:35]
    v_mfma_f32_16x16x32_bf16 v[48:51], a[172:175], a[176:179], v[48:51]
    v_mfma_f32_16x16x32_bf16 v[48:51], a[140:143], a[144:147], v[48:51]
    v_mfma_f32_16x16x32_bf16 v[0:3], a[192:195], a[208:211], v[0:3]
    v_mfma_f32_16x16x32_bf16 v[0:3], a[224:227], a[240:243], v[0:3]
    v_mfma_f32_16x16x32_bf16 v[16:19], a[228:231], a[240:243], v[16:19]
    v_mfma_f32_16x16x32_bf16 v[16:19], a[196:199], a[208:211], v[16:19]
    v_mfma_f32_16x16x32_bf16 v[32:35], a[200:203], a[208:211], v[32:35]
    v_mfma_f32_16x16x32_bf16 v[32:35], a[232:235], a[240:243], v[32:35]
    v_mfma_f32_16x16x32_bf16 v[48:51], a[236:239], a[240:243], v[48:51]
    v_mfma_f32_16x16x32_bf16 v[48:51], a[204:207], a[208:211], v[48:51]
    s_mov_b32 s54, 0
    s_waitcnt vmcnt(6)
    v_max3_u32 v88, v216, v217, v218
    v_max3_u32 v89, v219, v220, v221
    v_max3_u32 v89, v89, v222, v223
    v_max3_u32 v88, v88, v224, v225
    v_max3_u32 v89, v89, v226, v227
    v_max3_u32 v88, v88, v228, v229
    v_max3_u32 v89, v89, v230, v231
    v_max3_u32 v88, v88, v232, v233
    v_max3_u32 v89, v89, v234, v235
    v_max3_u32 v88, v88, v236, v237
    v_max3_u32 v89, v89, v238, v239
    v_max_u32 v88, v88, v89
    v_cmp_eq_u32 vcc, -1, v88
    s_cbranch_vccz P2_DOK
P2_DPOLL:
    buffer_load_dwordx4 v[216:219], v118, s[88:91], s49 offen offset:2048 sc1
    buffer_load_dwordx4 v[220:223], v118, s[88:91], s49 offen offset:3072 sc1
    buffer_load_dwordx4 v[224:227], v118, s[88:91], s50 offen offset:2048 sc1
    buffer_load_dwordx4 v[228:231], v118, s[88:91], s50 offen offset:3072 sc1
    buffer_load_dwordx4 v[232:235], v118, s[88:91], s51 offen offset:2048 sc1
    buffer_load_dwordx4 v[236:239], v118, s[88:91], s51 offen offset:3072 sc1
    s_add_u32 s54, s54, 1
    s_waitcnt vmcnt(0)
    v_max3_u32 v88, v216, v217, v218
    v_max3_u32 v89, v219, v220, v221
    v_max3_u32 v89, v89, v222, v223
    v_max3_u32 v88, v88, v224, v225
    v_max3_u32 v89, v89, v226, v227
    v_max3_u32 v88, v88, v228, v229
    v_max3_u32 v89, v89, v230, v231
    v_max3_u32 v88, v88, v232, v233
    v_max3_u32 v89, v89, v234, v235
    v_max3_u32 v88, v88, v236, v237
    v_max3_u32 v89, v89, v238, v239
    v_max_u32 v88, v88, v89
    v_cmp_eq_u32 vcc, -1, v88
    s_cmp_gt_u32 s54, 131072
    s_cbranch_scc1 P2_DOK
    s_cbranch_vccnz P2_DPOLL
P2_DOK:
    v_lshlrev_b32 v88, 16, v216
    v_and_b32 v89, s55, v216
    v_lshlrev_b32 v90, 16, v217
    v_and_b32 v91, s55, v217
    v_pk_add_f32 v[128:129], v[128:129], v[88:89]
    v_pk_add_f32 v[130:131], v[130:131], v[90:91]
    v_lshlrev_b32 v88, 16, v224
    v_and_b32 v89, s55, v224
    v_lshlrev_b32 v90, 16, v225
    v_and_b32 v91, s55, v225
    v_pk_add_f32 v[128:129], v[128:129], v[88:89]
    v_pk_add_f32 v[130:131], v[130:131], v[90:91]
    v_lshlrev_b32 v88, 16, v232
    v_and_b32 v89, s55, v232
    v_lshlrev_b32 v90, 16, v233
    v_and_b32 v91, s55, v233
    v_pk_add_f32 v[128:129], v[128:129], v[88:89]
    v_pk_add_f32 v[130:131], v[130:131], v[90:91]
    v_lshlrev_b32 v88, 16, v218
    v_and_b32 v89, s55, v218
    v_lshlrev_b32 v90, 16, v219
    v_and_b32 v91, s55, v219
    v_pk_add_f32 v[144:145], v[144:145], v[88:89]
    v_pk_add_f32 v[146:147], v[146:147], v[90:91]
    v_lshlrev_b32 v88, 16, v226
    v_and_b32 v89, s55, v226
    v_lshlrev_b32 v90, 16, v227
    v_and_b32 v91, s55, v227
    v_pk_add_f32 v[144:145], v[144:145], v[88:89]
    v_pk_add_f32 v[146:147], v[146:147], v[90:91]
    v_lshlrev_b32 v88, 16, v234
    v_and_b32 v89, s55, v234
    v_lshlrev_b32 v90, 16, v235
    v_and_b32 v91, s55, v235
    v_pk_add_f32 v[144:145], v[144:145], v[88:89]
    v_pk_add_f32 v[146:147], v[146:147], v[90:91]
    v_lshlrev_b32 v88, 16, v220
    v_and_b32 v89, s55, v220
    v_lshlrev_b32 v90, 16, v221
    v_and_b32 v91, s55, v221
    v_pk_add_f32 v[160:161], v[160:161], v[88:89]
    v_pk_add_f32 v[162:163], v[162:163], v[90:91]
    v_lshlrev_b32 v88, 16, v228
    v_and_b32 v89, s55, v228
    v_lshlrev_b32 v90, 16, v229
    v_and_b32 v91, s55, v229
    v_pk_add_f32 v[160:161], v[160:161], v[88:89]
    v_pk_add_f32 v[162:163], v[162:163], v[90:91]
    v_lshlrev_b32 v88, 16, v236
    v_and_b32 v89, s55, v236
    v_lshlrev_b32 v90, 16, v237
    v_and_b32 v91, s55, v237
    v_pk_add_f32 v[160:161], v[160:161], v[88:89]
    v_pk_add_f32 v[162:163], v[162:163], v[90:91]
    v_lshlrev_b32 v88, 16, v222
    v_and_b32 v89, s55, v222
    v_lshlrev_b32 v90, 16, v223
    v_and_b32 v91, s55, v223
    v_pk_add_f32 v[176:177], v[176:177], v[88:89]
    v_pk_add_f32 v[178:179], v[178:179], v[90:91]
    v_lshlrev_b32 v88, 16, v230
    v_and_b32 v89, s55, v230
    v_lshlrev_b32 v90, 16, v231
    v_and_b32 v91, s55, v231
    v_pk_add_f32 v[176:177], v[176:177], v[88:89]
    v_pk_add_f32 v[178:179], v[178:179], v[90:91]
    v_lshlrev_b32 v88, 16, v238
    v_and_b32 v89, s55, v238
    v_lshlrev_b32 v90, 16, v239
    v_and_b32 v91, s55, v239
    v_pk_add_f32 v[176:177], v[176:177], v[88:89]
    v_pk_add_f32 v[178:179], v[178:179], v[90:91]
    buffer_load_dword v240, v113, s[88:91], 0 offen offset:2044 sc1
    v_mul_f32 v132, 0xbfb8aa3b, v128
    v_mul_f32 v133, 0xbfb8aa3b, v129
    v_mul_f32 v134, 0xbfb8aa3b, v130
    v_mul_f32 v135, 0xbfb8aa3b, v131
    v_exp_f32 v132, v132
    v_exp_f32 v133, v133
    v_exp_f32 v134, v134
    v_exp_f32 v135, v135
    v_lshlrev_b32 v136, 16, v100
    v_and_b32 v137, s55, v100
    v_add_f32 v132, 1.0, v132
    v_add_f32 v133, 1.0, v133
    v_add_f32 v134, 1.0, v134
    v_add_f32 v135, 1.0, v135
    v_rcp_f32 v132, v132
    v_rcp_f32 v133, v133
    v_rcp_f32 v134, v134
    v_rcp_f32 v135, v135
    v_lshlrev_b32 v138, 16, v101
    v_and_b32 v139, s55, v101
    v_pk_mul_f32 v[132:133], v[132:133], v[128:129]
    v_pk_mul_f32 v[134:135], v[134:135], v[130:131]
    buffer_load_dword v241, v113, s[88:91], 0 offen offset:2044 sc1
    v_mul_f32 v148, 0xbfb8aa3b, v144
    v_mul_f32 v149, 0xbfb8aa3b, v145
    v_mul_f32 v150, 0xbfb8aa3b, v146
    v_mul_f32 v151, 0xbfb8aa3b, v147
    v_exp_f32 v148, v148
    v_exp_f32 v149, v149
    v_exp_f32 v150, v150
    v_exp_f32 v151, v151
    v_lshlrev_b32 v152, 16, v102
    v_and_b32 v153, s55, v102
    v_add_f32 v148, 1.0, v148
    v_add_f32 v149, 1.0, v149
    v_add_f32 v150, 1.0, v150
    v_add_f32 v151, 1.0, v151
    v_rcp_f32 v148, v148
    v_rcp_f32 v149, v149
    v_rcp_f32 v150, v150
    v_rcp_f32 v151, v151
    v_lshlrev_b32 v154, 16, v103
    v_and_b32 v155, s55, v103
    v_pk_mul_f32 v[148:149], v[148:149], v[144:145]
    v_pk_mul_f32 v[150:151], v[150:151], v[146:147]
    buffer_load_dword v242, v113, s[88:91], 0 offen offset:2044 sc1
    v_mul_f32 v164, 0xbfb8aa3b, v160
    v_mul_f32 v165, 0xbfb8aa3b, v161
    v_mul_f32 v166, 0xbfb8aa3b, v162
    v_mul_f32 v167, 0xbfb8aa3b, v163
    v_exp_f32 v164, v164
    v_exp_f32 v165, v165
    v_exp_f32 v166, v166
    v_exp_f32 v167, v167
    v_lshlrev_b32 v168, 16, v104
    v_and_b32 v169, s55, v104
    v_add_f32 v164, 1.0, v164
    v_add_f32 v165, 1.0, v165
    v_add_f32 v166, 1.0, v166
    v_add_f32 v167, 1.0, v167
    v_rcp_f32 v164, v164
    v_rcp_f32 v165, v165
    v_rcp_f32 v166, v166
    v_rcp_f32 v167, v167
    v_lshlrev_b32 v170, 16, v105
    v_and_b32 v171, s55, v105
    v_pk_mul_f32 v[164:165], v[164:165], v[160:161]
    v_pk_mul_f32 v[166:167], v[166:167], v[162:163]
    buffer_load_dword v243, v113, s[88:91], 0 offen offset:2044 sc1
    v_mul_f32 v180, 0xbfb8aa3b, v176
    v_mul_f32 v181, 0xbfb8aa3b, v177
    v_mul_f32 v182, 0xbfb8aa3b, v178
    v_mul_f32 v183, 0xbfb8aa3b, v179
    v_exp_f32 v180, v180
    v_exp_f32 v181, v181
    v_exp_f32 v182, v182
    v_exp_f32 v183, v183
    v_lshlrev_b32 v184, 16, v106
    v_and_b32 v185, s55, v106
    v_add_f32 v180, 1.0, v180
    v_add_f32 v181, 1.0, v181
    v_add_f32 v182, 1.0, v182
    v_add_f32 v183, 1.0, v183
    v_rcp_f32 v180, v180
    v_rcp_f32 v181, v181
    v_rcp_f32 v182, v182
    v_rcp_f32 v183, v183
    v_lshlrev_b32 v186, 16, v107
    v_and_b32 v187, s55, v107
    v_pk_mul_f32 v[180:181], v[180:181], v[176:177]
    v_pk_mul_f32 v[182:183], v[182:183], v[178:179]
    s_mov_b32 s54, 0
P2_LPOLL:
    s_waitcnt vmcnt(3)
    v_cmp_eq_u32 vcc, -1, v240
    s_cbranch_vccz P2_SPOLL
    buffer_load_dword v240, v113, s[88:91], 0 offen offset:2044 sc1
    s_waitcnt vmcnt(3)
    v_cmp_eq_u32 vcc, -1, v241
    s_cbranch_vccz P2_SPOLL
    buffer_load_dword v241, v113, s[88:91], 0 offen offset:2044 sc1
    s_waitcnt vmcnt(3)
    v_cmp_eq_u32 vcc, -1, v242
    s_cbranch_vccz P2_SPOLL
    buffer_load_dword v242, v113, s[88:91], 0 offen offset:2044 sc1
    s_waitcnt vmcnt(3)
    v_cmp_eq_u32 vcc, -1, v243
    s_cbranch_vccz P2_SPOLL
    buffer_load_dword v243, v113, s[88:91], 0 offen offset:2044 sc1
    s_add_u32 s54, s54, 1
    s_cmp_gt_u32 s54, 131072
    s_cbranch_scc0 P2_LPOLL
P2_SPOLL:
    buffer_load_dwordx4 v[4:7], v118, s[88:91], s49 offen offset:0 sc1
    buffer_load_dwordx4 v[20:23], v118, s[88:91], s49 offen offset:1024 sc1
    buffer_load_dwordx4 v[8:11], v118, s[88:91], s50 offen offset:0 sc1
    buffer_load_dwordx4 v[24:27], v118, s[88:91], s50 offen offset:1024 sc1
    buffer_load_dwordx4 v[12:15], v118, s[88:91], s51 offen offset:0 sc1
    buffer_load_dwordx4 v[28:31], v118, s[88:91], s51 offen offset:1024 sc1
    s_add_u32 s54, s54, 1
    s_waitcnt vmcnt(0)
    v_max3_u32 v88, v4, v5, v6
    v_max3_u32 v89, v7, v20, v21
    v_max3_u32 v89, v89, v22, v23
    v_max3_u32 v88, v88, v8, v9
    v_max3_u32 v89, v89, v10, v11
    v_max3_u32 v88, v88, v24, v25
    v_max3_u32 v89, v89, v26, v27
    v_max3_u32 v88, v88, v12, v13
    v_max3_u32 v89, v89, v14, v15
    v_max3_u32 v88, v88, v28, v29
    v_max3_u32 v89, v89, v30, v31
    v_max_u32 v88, v88, v89
    v_cmp_eq_u32 vcc, -1, v88
    s_cmp_gt_u32 s54, 131072
    s_cbranch_scc1 P2_FIN
    s_cbranch_vccnz P2_SPOLL
P2_FIN:
    v_lshlrev_b32 v88, 16, v4
    v_and_b32 v89, s55, v4
    v_lshlrev_b32 v90, 16, v5
    v_and_b32 v91, s55, v5
    v_pk_add_f32 v[0:1], v[0:1], v[88:89]
    v_pk_add_f32 v[2:3], v[2:3], v[90:91]
    v_lshlrev_b32 v88, 16, v8
    v_and_b32 v89, s55, v8
    v_lshlrev_b32 v90, 16, v9
    v_and_b32 v91, s55, v9
    v_pk_add_f32 v[0:1], v[0:1], v[88:89]
    v_pk_add_f32 v[2:3], v[2:3], v[90:91]
    v_lshlrev_b32 v88, 16, v12
    v_and_b32 v89, s55, v12
    v_lshlrev_b32 v90, 16, v13
    v_and_b32 v91, s55, v13
    v_pk_add_f32 v[0:1], v[0:1], v[88:89]
    v_pk_add_f32 v[2:3], v[2:3], v[90:91]
    v_pk_fma_f32 v[136:137], v[0:1], v[132:133], v[136:137]
    v_pk_fma_f32 v[138:139], v[2:3], v[134:135], v[138:139]
    v_cvt_pk_bf16_f32 v0, v136, v137
    v_cvt_pk_bf16_f32 v1, v138, v139
    buffer_store_dwordx2 v[0:1], v112, s[20:23], s76 offen offset:0
    v_lshlrev_b32 v88, 16, v6
    v_and_b32 v89, s55, v6
    v_lshlrev_b32 v90, 16, v7
    v_and_b32 v91, s55, v7
    v_pk_add_f32 v[16:17], v[16:17], v[88:89]
    v_pk_add_f32 v[18:19], v[18:19], v[90:91]
    v_lshlrev_b32 v88, 16, v10
    v_and_b32 v89, s55, v10
    v_lshlrev_b32 v90, 16, v11
    v_and_b32 v91, s55, v11
    v_pk_add_f32 v[16:17], v[16:17], v[88:89]
    v_pk_add_f32 v[18:19], v[18:19], v[90:91]
    v_lshlrev_b32 v88, 16, v14
    v_and_b32 v89, s55, v14
    v_lshlrev_b32 v90, 16, v15
    v_and_b32 v91, s55, v15
    v_pk_add_f32 v[16:17], v[16:17], v[88:89]
    v_pk_add_f32 v[18:19], v[18:19], v[90:91]
    v_pk_fma_f32 v[152:153], v[16:17], v[148:149], v[152:153]
    v_pk_fma_f32 v[154:155], v[18:19], v[150:151], v[154:155]
    v_cvt_pk_bf16_f32 v16, v152, v153
    v_cvt_pk_bf16_f32 v17, v154, v155
    buffer_store_dwordx2 v[16:17], v112, s[20:23], s76 offen offset:32
    v_lshlrev_b32 v88, 16, v20
    v_and_b32 v89, s55, v20
    v_lshlrev_b32 v90, 16, v21
    v_and_b32 v91, s55, v21
    v_pk_add_f32 v[32:33], v[32:33], v[88:89]
    v_pk_add_f32 v[34:35], v[34:35], v[90:91]
    v_lshlrev_b32 v88, 16, v24
    v_and_b32 v89, s55, v24
    v_lshlrev_b32 v90, 16, v25
    v_and_b32 v91, s55, v25
    v_pk_add_f32 v[32:33], v[32:33], v[88:89]
    v_pk_add_f32 v[34:35], v[34:35], v[90:91]
    v_lshlrev_b32 v88, 16, v28
    v_and_b32 v89, s55, v28
    v_lshlrev_b32 v90, 16, v29
    v_and_b32 v91, s55, v29
    v_pk_add_f32 v[32:33], v[32:33], v[88:89]
    v_pk_add_f32 v[34:35], v[34:35], v[90:91]
    v_pk_fma_f32 v[168:169], v[32:33], v[164:165], v[168:169]
    v_pk_fma_f32 v[170:171], v[34:35], v[166:167], v[170:171]
    v_cvt_pk_bf16_f32 v32, v168, v169
    v_cvt_pk_bf16_f32 v33, v170, v171
    buffer_store_dwordx2 v[32:33], v112, s[20:23], s76 offen offset:64
    v_lshlrev_b32 v88, 16, v22
    v_and_b32 v89, s55, v22
    v_lshlrev_b32 v90, 16, v23
    v_and_b32 v91, s55, v23
    v_pk_add_f32 v[48:49], v[48:49], v[88:89]
    v_pk_add_f32 v[50:51], v[50:51], v[90:91]
    v_lshlrev_b32 v88, 16, v26
    v_and_b32 v89, s55, v26
    v_lshlrev_b32 v90, 16, v27
    v_and_b32 v91, s55, v27
    v_pk_add_f32 v[48:49], v[48:49], v[88:89]
    v_pk_add_f32 v[50:51], v[50:51], v[90:91]
    v_lshlrev_b32 v88, 16, v30
    v_and_b32 v89, s55, v30
    v_lshlrev_b32 v90, 16, v31
    v_and_b32 v91, s55, v31
    v_pk_add_f32 v[48:49], v[48:49], v[88:89]
    v_pk_add_f32 v[50:51], v[50:51], v[90:91]
    v_pk_fma_f32 v[184:185], v[48:49], v[180:181], v[184:185]
    v_pk_fma_f32 v[186:187], v[50:51], v[182:183], v[186:187]
    v_cvt_pk_bf16_f32 v48, v184, v185
    v_cvt_pk_bf16_f32 v49, v186, v187
    buffer_store_dwordx2 v[48:49], v112, s[20:23], s76 offen offset:96
    s_endpgm
P2_PFPOLL:
    buffer_load_dword v115, v114, s[88:91], 0 offen offset:8 sc1
    s_add_u32 s54, s54, 1
    s_waitcnt vmcnt(0)
    v_cmp_ne_u32 vcc, s62, v115
    s_cmp_gt_u32 s54, 131072
    s_cbranch_scc1 P2_PFOK
    s_cbranch_vccnz P2_PFPOLL
    s_branch P2_PFOK
K1_END:
    s_endpgm
.section .rodata,"a"
.p2align 6
.amdhsa_kernel recurrent_scan__gqa_block_cached__glu_gated_glu__prompt_kernel
  .amdhsa_next_free_vgpr 512
  .amdhsa_next_free_sgpr 102
  .amdhsa_accum_offset 256
  .amdhsa_group_segment_fixed_size 0
  .amdhsa_kernarg_size 96
  .amdhsa_user_sgpr_count 2
  .amdhsa_user_sgpr_kernarg_segment_ptr 1
  .amdhsa_system_sgpr_workgroup_id_x 1
.end_amdhsa_kernel
```
